```python
import torch

def _softmax(x, axis=-1):
    return torch.softmax(x, dim=axis)
def _gelu(x):
    return torch.nn.functional.gelu(x, approximate="tanh")
def _silu(x):
    return torch.nn.functional.silu(x)
def _sigmoid(x):
    return torch.sigmoid(x)
def _layernorm(x, axis=-1, eps=1e-5):
    m = x.mean(dim=axis, keepdim=True)
    v = x.var(dim=axis, keepdim=True, unbiased=False)
    return (x - m) / torch.sqrt(v + eps)
def _scatter_add(tgt, idx, src, axis=0):
    return tgt.clone().index_add_(axis, idx, src)
def _segment_sum(src, seg, n):
    out = torch.zeros((n,) + src.shape[1:], dtype=src.dtype)
    return out.index_add_(0, seg, src)
def _pad(x, pw):
    flat = tuple(v for pair in reversed(pw) for v in pair)
    return torch.nn.functional.pad(x, flat)

kernel_name = 'sequential_preLN__mha_block__dense_activation_relu__prompt'

def setup_inputs():

    _w = (lambda a: (lambda t: t.to(torch.bfloat16) if t.is_floating_point() else t)(torch.as_tensor(a)))
    def _A_setup():
        B, S, D, H = 1, 2048, 640, 32
        return {
            "x": _w((lambda *s: torch.randn(*s, dtype=torch.bfloat16) * 0.05)(B, S, D)),
            "wqkv": _w((lambda *s: torch.randn(*s, dtype=torch.bfloat16) * 0.05)(D, 3 * D)),
            "wo": _w((lambda *s: torch.randn(*s, dtype=torch.bfloat16) * 0.05)(D, D)),
        }
    _A_in = _A_setup()

    def _B_setup():
        B, S, D, Dff = 1, 2048, 640, 1728
        return {
            "x": _w((lambda *s: torch.randn(*s, dtype=torch.bfloat16) * 0.05)(B, S, D)),
            "w1": _w((lambda *s: torch.randn(*s, dtype=torch.bfloat16) * 0.05)(D, Dff)),
            "w2": _w((lambda *s: torch.randn(*s, dtype=torch.bfloat16) * 0.05)(Dff, D)),
        }
    _B_in = _B_setup()

    return {
        "A_x": _A_in["x"],
        "A_wqkv": _A_in["wqkv"],
        "A_wo": _A_in["wo"],
        "B_x": _B_in["x"],
        "B_w1": _B_in["w1"],
        "B_w2": _B_in["w2"],
    }

def reference(A_x, A_wqkv, A_wo, B_x, B_w1, B_w2):
    def _A_ref(x, wqkv, wo):
        B, S, D = x.shape
        H = 32
        Dh = D // H
        qkv = (lambda x, *d: x.permute(*d))((x @ wqkv).reshape(B, S, 3, H, Dh), 2, 0, 3, 1, 4)
        q, k, v = qkv[0], qkv[1], qkv[2]
        scores = torch.einsum("bhqd,bhkd->bhqk", q, k) * (Dh ** -0.5)
        p = _softmax(scores, axis=-1)
        o = torch.einsum("bhqk,bhkd->bhqd", p, v)
        return (lambda x, *d: x.permute(*d))(o, 0, 2, 1, 3).reshape(B, S, D) @ wo

    def _B_ref(x, w1, w2):
        h = torch.einsum("bsd,df->bsf", x, w1)
        zero = torch.zeros_like(h)
        h = torch.maximum(h, zero)
        return torch.einsum("bsf,fd->bsd", h, w2)

    x = A_x
    h = x + _A_ref(_layernorm(x, axis=-1), A_wqkv, A_wo)
    h2 = h + _B_ref(_layernorm(h, axis=-1), B_w1, B_w2)
    return h2
```

```asm
; @launch grid=(256,1,1) block=(512,1,1) lds=163840
.amdgcn_target "amdgcn-amd-amdhsa--gfx950"
.text
.globl sequential_preLN__mha_block__dense_activation_relu__prompt_kernel
.p2align 8
.type sequential_preLN__mha_block__dense_activation_relu__prompt_kernel,@function
sequential_preLN__mha_block__dense_activation_relu__prompt_kernel:
    s_cmp_ge_u32 s2, 256
    s_cbranch_scc1 L_end
    s_load_dwordx16 s[48:63], s[0:1], 0
    s_load_dwordx2 s[64:65], s[0:1], 64
    s_getpc_b64 s[4:5]
    s_lshr_b32 s41, s2, 3
    s_mul_i32 s6, s41, 20
    v_add_u32 v2, s6, v0
    v_lshlrev_b32 v2, 7, v2
    v_min_u32 v2, CODE_BYTES-64, v2
    v_cmp_gt_u32 vcc, 20, v0
    s_nop 0
    s_and_saveexec_b64 s[6:7], vcc
    s_cbranch_execz L_cpf
    global_load_dword v63, v2, s[4:5]
L_cpf:
    s_mov_b64 exec, -1
    v_lshrrev_b32 v2, 6, v0
    v_and_b32 v1, 63, v0
    v_readfirstlane_b32 s3, v2
    s_and_b32 s40, s2, 7
    s_lshr_b32 s41, s2, 3
    s_getreg_b32 s95, hwreg(HW_REG_XCC_ID)
    s_and_b32 s95, s95, 15
    s_lshl_b32 s95, s95, 1
    s_mov_b32 s10, 2621440
    s_mov_b32 s11, 0x20000
    s_mov_b32 s14, 2457600
    s_mov_b32 s15, 0x20000
    s_mov_b32 s18, 819200
    s_mov_b32 s19, 0x20000
    s_mov_b32 s22, 2211840
    s_mov_b32 s23, 0x20000
    s_mov_b32 s26, 2211840
    s_mov_b32 s27, 0x20000
    s_mov_b32 s30, 2621440
    s_mov_b32 s31, 0x20000
    s_mov_b32 s34, 27701248
    s_mov_b32 s35, 0x20000
    s_mov_b32 s38, 256
    s_mov_b32 s39, 0x20000
    s_lshr_b32 s7, s3, 2
    s_and_b32 s3, s3, 3
    s_bfe_u32 s74, s40, 0x10001
    s_xor_b32 s74, s74, 1
    s_and_b32 s66, s41, 1
    s_lshr_b32 s67, s41, 1
    s_lshl_b32 s70, s40, 1
    s_add_u32 s70, s70, s66
    s_lshl_b32 s70, s70, 1
    s_add_u32 s71, s70, 1
    s_mov_b32 s72, s67
    s_mul_i32 s75, s74, 5
    s_add_u32 s73, s67, s75
    s_cmp_ge_u32 s67, 5
    s_cselect_b32 s76, 15, 10
    s_add_u32 s73, s73, s76
    s_cmp_lt_u32 s41, 20
    s_cbranch_scc1 L_coords
    s_and_b32 s76, s40, 1
    s_lshr_b32 s70, s40, 2
    s_lshl_b32 s70, s70, 1
    s_add_u32 s70, s70, s76
    s_lshl_b32 s70, s70, 1
    s_add_u32 s70, s70, s66
    s_lshl_b32 s74, s74, 3
    s_add_u32 s70, s70, s74
    s_add_u32 s71, s70, 16
    s_add_u32 s72, s67, s75
    s_add_u32 s73, s72, 10
L_coords:
    s_cmp_eq_u32 s7, 0
    s_cbranch_scc1 L_compute
    s_lshl_b32 s67, s3, 4
    v_lshrrev_b32 v6, 3, v1
    v_add_u32 v6, s67, v6
    v_mul_u32_u24 v2, 1280, v6
    v_and_b32 v7, 7, v1
    v_lshrrev_b32 v4, 4, v1
    v_xor_b32 v3, v7, v4
    v_lshlrev_b32 v3, 4, v3
    v_xor_b32 v5, 64, v3
    v_add_u32 v160, v2, v3
    v_add_u32 v161, v2, v5
    v_add_u32 v161, 9216, v161
    v_mul_u32_u24 v2, 3840, v6
    v_and_b32 v4, 1, v4
    v_lshlrev_b32 v4, 2, v4
    v_xor_b32 v3, v7, v4
    v_lshl_add_u32 v162, v3, 4, v2
    v_add_u32 v163, 29696, v162
    s_lshl_b32 s78, s3, 11
    s_mul_i32 s70, s70, 81920
    s_mul_i32 s71, s71, 81920
    s_lshl_b32 s72, s72, 7
    s_lshl_b32 s73, s73, 7
    v_mov_b32 v34, 0
    s_mov_b32 s66, 245760
    s_cmp_lt_u32 s41, 20
    s_cselect_b64 vcc, -1, 0
    s_cselect_b32 s79, s71, s72
    s_cselect_b32 s80, s72, s73
    s_cselect_b32 s81, s73, s71
    s_cselect_b32 s82, 128, s66
    s_cselect_b32 s83, s66, 128
    s_cselect_b32 s86, s10, s14
    s_cselect_b32 s98, s14, s10
    s_mov_b32 s87, 0x20000
    s_mov_b32 s99, 0x20000
    v_cndmask_b32 v164, v162, v160, vcc
    v_cndmask_b32 v165, v163, v161, vcc
    v_cndmask_b32 v166, v160, v162, vcc
    v_cndmask_b32 v167, v161, v163, vcc
    s_waitcnt lgkmcnt(0)
    s_mov_b64 s[8:9], s[48:49]
    s_mov_b64 s[12:13], s[50:51]
    s_mov_b64 s[16:17], s[52:53]
    s_mov_b64 s[20:21], s[56:57]
    s_mov_b64 s[24:25], s[58:59]
    s_mov_b64 s[28:29], s[60:61]
    s_mov_b64 s[36:37], s[62:63]
    s_mov_b64 s[32:33], s[64:65]
    s_mov_b64 s[92:93], s[4:5]
    s_cmp_lt_u32 s41, 20
    s_cselect_b64 s[84:85], s[8:9], s[12:13]
    s_cselect_b64 s[96:97], s[12:13], s[8:9]
    s_cmp_ge_u32 s41, 30
    s_cbranch_scc1 L_h_idle
    s_add_u32 m0, s78, 0
    s_nop 0
    buffer_load_dwordx4 v160, s[8:11], s70 offen offset:0 lds
    buffer_load_dwordx4 v161, s[8:11], s70 offen offset:1024 lds
    s_add_u32 s70, s70, 128
    s_add_u32 m0, s78, 8192
    s_nop 0
    buffer_load_dwordx4 v164, s[84:87], s79 offen offset:0 lds
    buffer_load_dwordx4 v165, s[84:87], s79 offen offset:1024 lds
    s_add_u32 s79, s79, s82
    s_add_u32 m0, s78, 16384
    s_nop 0
    buffer_load_dwordx4 v162, s[12:15], s80 offen offset:0 lds
    buffer_load_dwordx4 v163, s[12:15], s80 offen offset:1024 lds
    s_add_u32 s80, s80, 245760
    s_add_u32 m0, s78, 24576
    s_nop 0
    buffer_load_dwordx4 v160, s[8:11], s70 offen offset:0 lds
    buffer_load_dwordx4 v161, s[8:11], s70 offen offset:1024 lds
    s_add_u32 s70, s70, 128
    s_add_u32 m0, s78, 32768
    s_nop 0
    buffer_load_dwordx4 v164, s[84:87], s79 offen offset:0 lds
    buffer_load_dwordx4 v165, s[84:87], s79 offen offset:1024 lds
    s_add_u32 s79, s79, s82
    s_add_u32 m0, s78, 40960
    s_nop 0
    buffer_load_dwordx4 v162, s[12:15], s80 offen offset:0 lds
    buffer_load_dwordx4 v163, s[12:15], s80 offen offset:1024 lds
    s_add_u32 s80, s80, 245760
    s_add_u32 m0, s78, 49152
    s_nop 0
    buffer_load_dwordx4 v160, s[8:11], s70 offen offset:0 lds
    buffer_load_dwordx4 v161, s[8:11], s70 offen offset:1024 lds
    s_add_u32 s70, s70, 128
    s_add_u32 m0, s78, 57344
    s_nop 0
    buffer_load_dwordx4 v164, s[84:87], s79 offen offset:0 lds
    buffer_load_dwordx4 v165, s[84:87], s79 offen offset:1024 lds
    s_add_u32 s79, s79, s82
    s_add_u32 m0, s78, 65536
    s_nop 0
    buffer_load_dwordx4 v162, s[12:15], s80 offen offset:0 lds
    buffer_load_dwordx4 v163, s[12:15], s80 offen offset:1024 lds
    s_add_u32 s80, s80, 245760
    s_waitcnt vmcnt(12)
    s_barrier
    s_add_u32 m0, s78, 73728
    s_nop 0
    buffer_load_dwordx4 v160, s[8:11], s70 offen offset:0 lds
    buffer_load_dwordx4 v161, s[8:11], s70 offen offset:1024 lds
    s_add_u32 s70, s70, 128
    s_add_u32 m0, s78, 81920
    s_nop 0
    buffer_load_dwordx4 v164, s[84:87], s79 offen offset:0 lds
    buffer_load_dwordx4 v165, s[84:87], s79 offen offset:1024 lds
    s_add_u32 s79, s79, s82
    s_add_u32 m0, s78, 90112
    s_nop 0
    buffer_load_dwordx4 v162, s[12:15], s80 offen offset:0 lds
    buffer_load_dwordx4 v163, s[12:15], s80 offen offset:1024 lds
    s_add_u32 s80, s80, 245760
    s_waitcnt vmcnt(12)
    s_barrier
    s_add_u32 m0, s78, 98304
    s_nop 0
    buffer_load_dwordx4 v160, s[8:11], s70 offen offset:0 lds
    buffer_load_dwordx4 v161, s[8:11], s70 offen offset:1024 lds
    s_add_u32 s70, s70, 128
    s_add_u32 m0, s78, 106496
    s_nop 0
    buffer_load_dwordx4 v164, s[84:87], s79 offen offset:0 lds
    buffer_load_dwordx4 v165, s[84:87], s79 offen offset:1024 lds
    s_add_u32 s79, s79, s82
    s_add_u32 m0, s78, 114688
    s_nop 0
    buffer_load_dwordx4 v162, s[12:15], s80 offen offset:0 lds
    buffer_load_dwordx4 v163, s[12:15], s80 offen offset:1024 lds
    s_add_u32 s80, s80, 245760
    s_waitcnt vmcnt(12)
    s_barrier
    s_add_u32 m0, s78, 0
    s_nop 0
    buffer_load_dwordx4 v160, s[8:11], s70 offen offset:0 lds
    buffer_load_dwordx4 v161, s[8:11], s70 offen offset:1024 lds
    s_add_u32 s70, s70, 128
    s_add_u32 m0, s78, 8192
    s_nop 0
    buffer_load_dwordx4 v164, s[84:87], s79 offen offset:0 lds
    buffer_load_dwordx4 v165, s[84:87], s79 offen offset:1024 lds
    s_add_u32 s79, s79, s82
    s_add_u32 m0, s78, 16384
    s_nop 0
    buffer_load_dwordx4 v162, s[12:15], s80 offen offset:0 lds
    buffer_load_dwordx4 v163, s[12:15], s80 offen offset:1024 lds
    s_add_u32 s80, s80, 245760
    buffer_load_dword v35, v34, s[36:39], 0 offen sc1
    s_waitcnt vmcnt(13)
    s_barrier
    s_add_u32 m0, s78, 24576
    s_nop 0
    buffer_load_dwordx4 v160, s[8:11], s70 offen offset:0 lds
    buffer_load_dwordx4 v161, s[8:11], s70 offen offset:1024 lds
    s_add_u32 s70, s70, 128
    s_add_u32 m0, s78, 32768
    s_nop 0
    buffer_load_dwordx4 v164, s[84:87], s79 offen offset:0 lds
    buffer_load_dwordx4 v165, s[84:87], s79 offen offset:1024 lds
    s_add_u32 s79, s79, s82
    s_add_u32 m0, s78, 40960
    s_nop 0
    buffer_load_dwordx4 v162, s[12:15], s80 offen offset:0 lds
    buffer_load_dwordx4 v163, s[12:15], s80 offen offset:1024 lds
    s_add_u32 s80, s80, 245760
    s_waitcnt vmcnt(13)
    s_barrier
    s_add_u32 m0, s78, 49152
    s_nop 0
    buffer_load_dwordx4 v160, s[8:11], s70 offen offset:0 lds
    buffer_load_dwordx4 v161, s[8:11], s70 offen offset:1024 lds
    s_add_u32 s70, s70, 128
    s_add_u32 m0, s78, 57344
    s_nop 0
    buffer_load_dwordx4 v164, s[84:87], s79 offen offset:0 lds
    buffer_load_dwordx4 v165, s[84:87], s79 offen offset:1024 lds
    s_add_u32 s79, s79, s82
    s_add_u32 m0, s78, 65536
    s_nop 0
    buffer_load_dwordx4 v162, s[12:15], s80 offen offset:0 lds
    buffer_load_dwordx4 v163, s[12:15], s80 offen offset:1024 lds
    s_add_u32 s80, s80, 245760
    s_waitcnt vmcnt(13)
    s_barrier
    s_add_u32 m0, s78, 73728
    s_nop 0
    buffer_load_dwordx4 v160, s[8:11], s70 offen offset:0 lds
    buffer_load_dwordx4 v161, s[8:11], s70 offen offset:1024 lds
    s_add_u32 s70, s70, 128
    s_add_u32 m0, s78, 81920
    s_nop 0
    buffer_load_dwordx4 v164, s[84:87], s79 offen offset:0 lds
    buffer_load_dwordx4 v165, s[84:87], s79 offen offset:1024 lds
    s_add_u32 s79, s79, s82
    s_add_u32 m0, s78, 90112
    s_nop 0
    buffer_load_dwordx4 v162, s[12:15], s80 offen offset:0 lds
    buffer_load_dwordx4 v163, s[12:15], s80 offen offset:1024 lds
    s_add_u32 s80, s80, 245760
    s_waitcnt vmcnt(18)
    v_readfirstlane_b32 s42, v35
    s_nop 0
    s_cmp_eq_u32 s42, 0
    s_cbranch_scc1 L_nz_1
L_nzb_2:
    s_lshl_b32 s66, s2, 7
    s_add_u32 s66, s66, 22020096
    s_cmp_eq_u32 s42, 0
    s_cselect_b32 s66, 0x7f000000, s66
    s_cmp_lg_u32 s3, 0
    s_cselect_b32 s66, 0x7f000000, s66
    s_xor_b32 s67, s42, s95
    v_mov_b32 v2, s67
    v_mov_b32 v3, 0
    s_mov_b64 exec, 1
    buffer_store_dword v2, v3, s[32:35], s66 offen sc1
    s_mov_b64 exec, -1
    s_waitcnt vmcnt(13)
    s_barrier
    s_add_u32 m0, s78, 98304
    s_nop 0
    buffer_load_dwordx4 v160, s[8:11], s70 offen offset:0 lds
    buffer_load_dwordx4 v161, s[8:11], s70 offen offset:1024 lds
    s_add_u32 s70, s70, 128
    s_add_u32 m0, s78, 106496
    s_nop 0
    buffer_load_dwordx4 v164, s[84:87], s79 offen offset:0 lds
    buffer_load_dwordx4 v165, s[84:87], s79 offen offset:1024 lds
    s_add_u32 s79, s79, s82
    s_add_u32 m0, s78, 114688
    s_nop 0
    buffer_load_dwordx4 v162, s[12:15], s80 offen offset:0 lds
    buffer_load_dwordx4 v163, s[12:15], s80 offen offset:1024 lds
    s_add_u32 s80, s80, 245760
    s_mov_b64 exec, 0
    s_branch L_chain3
L_chain3_ret:
    s_mov_b64 exec, -1
    s_waitcnt vmcnt(13)
    s_barrier
    s_add_u32 m0, s78, 0
    s_nop 0
    buffer_load_dwordx4 v166, s[96:99], s81 offen offset:0 lds
    buffer_load_dwordx4 v167, s[96:99], s81 offen offset:1024 lds
    s_add_u32 s81, s81, s83
    s_add_u32 m0, s78, 8192
    s_nop 0
    buffer_load_dwordx4 v166, s[96:99], s81 offen offset:0 lds
    buffer_load_dwordx4 v167, s[96:99], s81 offen offset:1024 lds
    s_add_u32 s81, s81, s83
    s_add_u32 m0, s78, 16384
    s_nop 0
    buffer_load_dwordx4 v166, s[96:99], s81 offen offset:0 lds
    buffer_load_dwordx4 v167, s[96:99], s81 offen offset:1024 lds
    s_add_u32 s81, s81, s83
    s_waitcnt vmcnt(13)
    s_barrier
    s_add_u32 m0, s78, 24576
    s_nop 0
    buffer_load_dwordx4 v166, s[96:99], s81 offen offset:0 lds
    buffer_load_dwordx4 v167, s[96:99], s81 offen offset:1024 lds
    s_add_u32 s81, s81, s83
    s_add_u32 m0, s78, 32768
    s_nop 0
    buffer_load_dwordx4 v166, s[96:99], s81 offen offset:0 lds
    buffer_load_dwordx4 v167, s[96:99], s81 offen offset:1024 lds
    s_add_u32 s81, s81, s83
    s_add_u32 m0, s78, 40960
    s_nop 0
    buffer_load_dwordx4 v166, s[96:99], s81 offen offset:0 lds
    buffer_load_dwordx4 v167, s[96:99], s81 offen offset:1024 lds
    s_add_u32 s81, s81, s83
    s_waitcnt vmcnt(12)
    s_barrier
    s_add_u32 m0, s78, 49152
    s_nop 0
    buffer_load_dwordx4 v166, s[96:99], s81 offen offset:0 lds
    buffer_load_dwordx4 v167, s[96:99], s81 offen offset:1024 lds
    s_add_u32 s81, s81, s83
    s_add_u32 m0, s78, 57344
    s_nop 0
    buffer_load_dwordx4 v166, s[96:99], s81 offen offset:0 lds
    buffer_load_dwordx4 v167, s[96:99], s81 offen offset:1024 lds
    s_add_u32 s81, s81, s83
    s_add_u32 m0, s78, 65536
    s_nop 0
    buffer_load_dwordx4 v166, s[96:99], s81 offen offset:0 lds
    buffer_load_dwordx4 v167, s[96:99], s81 offen offset:1024 lds
    s_add_u32 s81, s81, s83
    s_waitcnt vmcnt(12)
    s_barrier
    s_add_u32 m0, s78, 73728
    s_nop 0
    buffer_load_dwordx4 v166, s[96:99], s81 offen offset:0 lds
    buffer_load_dwordx4 v167, s[96:99], s81 offen offset:1024 lds
    s_add_u32 s81, s81, s83
    s_mov_b64 exec, 0
    s_branch L_chain0
L_chain0_ret:
    s_mov_b64 exec, -1
    s_waitcnt vmcnt(8)
    s_barrier
    s_lshr_b32 s66, s41, 3
    s_lshl_b32 s52, s40, 2
    s_add_u32 s52, s52, s66
    s_mov_b32 s43, s52
    s_and_b32 s51, s41, 7
    s_mov_b32 s45, s51
    s_and_b32 s48, s43, 1
    s_lshr_b32 s66, s43, 1
    s_mul_i32 s66, s66, 5
    s_lshl_b32 s67, s48, 1
    s_add_u32 s49, s66, s67
    s_lshl_b32 s50, s45, 2
    s_add_u32 s50, s50, s3
    s_and_b32 s5, s41, 15
    s_add_u32 s6, s3, s51
    s_and_b32 s6, s6, 3
    v_lshlrev_b32 v16, 4, v1
    v_and_b32 v2, 31, v1
    v_lshrrev_b32 v3, 5, v1
    v_lshlrev_b32 v2, 4, v2
    v_add_u32 v4, s48, v3
    v_lshl_add_u32 v28, v4, 10, v2
    s_mul_i32 s66, s50, 80
    s_add_u32 s66, s66, s49
    s_lshl_b32 s66, s66, 10
    s_add_u32 s88, s66, 8388608
    s_cmp_eq_u32 s48, 0
    s_cselect_b32 s67, 2048, 8
    s_add_u32 s89, s67, s88
    s_lshl_b32 s4, s43, 5
    s_add_u32 s4, s4, s50
    s_lshl_b32 s4, s4, 7
    s_add_u32 s4, s4, 21364736
    s_lshr_b32 s61, s3, 1
    s_and_b32 s62, s3, 1
    s_lshr_b32 s66, s49, 2
    s_add_u32 s67, s49, 2
    s_lshr_b32 s67, s67, 2
    s_sub_u32 s67, s67, s66
    v_bfe_u32 v2, v1, 1, 1
    v_mul_u32_u24 v2, s67, v2
    v_add_u32 v2, s66, v2
    s_mul_i32 s63, s61, 20
    s_add_u32 s63, s63, 20
    v_add_u32 v3, s63, v2
    v_and_b32 v6, 1, v1
    v_lshrrev_b32 v4, 2, v1
    v_lshl_add_u32 v4, v4, 1, s62
    v_lshl_add_u32 v5, v4, 1, v6
    v_lshl_add_u32 v5, v3, 6, v5
    v_lshlrev_b32 v5, 7, v5
    v_add_u32 v19, 20840448, v5
    s_lshr_b32 s64, s43, 4
    s_lshl_b32 s63, s64, 3
    v_and_b32 v4, 7, v4
    v_add_u32 v4, s63, v4
    v_lshl_add_u32 v4, v4, 1, v6
    v_lshl_add_u32 v3, v3, 6, v4
    s_lshl_b32 s63, s50, 1
    v_add_u32 v6, s63, v6
    v_lshl_add_u32 v2, v2, 6, v6
    v_cmp_gt_u32 vcc, 32, v1
    s_nop 1
    v_cndmask_b32 v2, v2, v3, vcc
    v_lshlrev_b32 v2, 7, v2
    v_add_u32 v30, 20840448, v2
    s_lshl_b32 s66, s61, 2
    v_xor_b32 v2, s66, v1
    v_lshlrev_b32 v17, 4, v2
    s_lshl_b32 s66, s61, 3
    v_xor_b32 v2, s66, v1
    v_lshlrev_b32 v18, 4, v2
    s_mul_i32 s66, s61, 80
    s_add_u32 s66, s66, 80
    s_add_u32 s66, s66, s49
    s_lshl_b32 s67, s62, 8
    s_add_u32 s66, s66, s67
    s_and_b32 s67, s45, 3
    s_lshl_b32 s64, s64, 2
    s_add_u32 s67, s67, s64
    s_lshl_b32 s67, s67, 9
    s_add_u32 s66, s66, s67
    s_lshl_b32 s54, s66, 10
    s_mul_i32 s58, s62, 7168
    s_mul_i32 s66, s61, 3072
    s_add_u32 s58, s58, s66
    s_add_u32 s58, s58, 92160
    s_lshl_b32 s66, s3, 8
    s_add_u32 s66, s66, 98304
    v_lshl_add_u32 v21, v1, 2, s66
    s_lshl_b32 s55, s50, 8
    s_add_u32 s55, s55, s49
    s_lshl_b32 s55, s55, 10
    s_add_u32 s76, s4, 524288
    v_add_u32 v20, 4096, v16
    v_and_b32 v5, 3, v1
    v_mov_b32 v10, 0x3f80
    v_cmp_eq_u32 vcc, 0, v5
    s_nop 1
    v_cndmask_b32 v10, 0, v10, vcc
    s_waitcnt vmcnt(0)
    s_barrier
    s_mov_b32 s44, 0
    s_nop 1
L_pl_3:
    buffer_load_dword v2, v30, s[32:35], 0 offen sc1
    s_waitcnt vmcnt(0)
    v_cmp_ne_u32 vcc, s42, v2
    s_add_u32 s44, s44, 1
    s_cmp_gt_u32 s44, 1000000
    s_cbranch_scc1 L_pld_4
    s_cbranch_vccnz L_pl_3
L_pld_4:
    s_add_u32 m0, s58, 43008
    s_xor_b32 s56, s54, 0
    buffer_load_dwordx4 v16, s[32:35], s56 offen offset:0 sc1 lds
    buffer_load_dwordx4 v17, s[32:35], s56 offen offset:1024 sc1 lds
    buffer_load_dwordx4 v18, s[32:35], s56 offen offset:2048 sc1 lds
    s_mul_i32 s66, s3, 3072
    s_add_u32 m0, s66, 122880
    s_nop 0
    buffer_load_dwordx4 v16, s[32:35], s55 offen offset:0 sc1 lds
    buffer_load_dwordx4 v16, s[32:35], s55 offen offset:1024 sc1 lds
    buffer_load_dwordx4 v16, s[32:35], s55 offen offset:2048 sc1 lds
    s_add_u32 m0, s58, 57344
    s_xor_b32 s56, s54, 524288
    buffer_load_dwordx4 v16, s[32:35], s56 offen offset:0 sc1 lds
    buffer_load_dwordx4 v17, s[32:35], s56 offen offset:1024 sc1 lds
    buffer_load_dwordx4 v18, s[32:35], s56 offen offset:2048 sc1 lds
    ds_write_b32 v21, v10 offset:43008
    ds_write_b32 v21, v10 offset:50176
    ds_write_b32 v21, v10 offset:57344
    ds_write_b32 v21, v10 offset:64512
    s_branch L_h_p1_done
L_h_idle:
    s_sub_u32 s66, s41, 30
    s_lshl_b32 s66, s66, 3
    s_add_u32 s66, s66, s40
    s_lshl_b32 s66, s66, 2
    s_add_u32 s66, s66, s3
    s_lshl_b32 s66, s66, 13
    s_add_u32 s66, s66, 0
    v_lshlrev_b32 v2, 7, v1
    buffer_load_dword v4, v2, s[12:15], s66 offen
    s_add_u32 s66, s66, 524288
    buffer_load_dword v5, v2, s[12:15], s66 offen
    s_add_u32 s66, s66, 524288
    buffer_load_dword v6, v2, s[12:15], s66 offen
    s_add_u32 s66, s66, 524288
    buffer_load_dword v7, v2, s[12:15], s66 offen
    s_add_u32 s66, s66, 524288
    buffer_load_dword v8, v2, s[12:15], s66 offen
    s_add_u32 s66, s66, 524288
    buffer_load_dword v35, v34, s[36:39], 0 offen sc1
    s_waitcnt vmcnt(0)
    v_readfirstlane_b32 s42, v35
    s_nop 0
    s_cmp_eq_u32 s42, 0
    s_cbranch_scc1 L_nz_5
L_nzb_6:
    s_lshl_b32 s66, s2, 7
    s_add_u32 s66, s66, 22020096
    s_cmp_eq_u32 s42, 0
    s_cselect_b32 s66, 0x7f000000, s66
    s_cmp_lg_u32 s3, 0
    s_cselect_b32 s66, 0x7f000000, s66
    s_xor_b32 s67, s42, s95
    v_mov_b32 v2, s67
    v_mov_b32 v3, 0
    s_mov_b64 exec, 1
    buffer_store_dword v2, v3, s[32:35], s66 offen sc1
    s_mov_b64 exec, -1
    s_lshr_b32 s66, s41, 3
    s_lshl_b32 s52, s40, 2
    s_add_u32 s52, s52, s66
    s_mov_b32 s43, s52
    s_and_b32 s51, s41, 7
    s_mov_b32 s45, s51
    s_and_b32 s48, s43, 1
    s_lshr_b32 s66, s43, 1
    s_mul_i32 s66, s66, 5
    s_lshl_b32 s67, s48, 1
    s_add_u32 s49, s66, s67
    s_lshl_b32 s50, s45, 2
    s_add_u32 s50, s50, s3
    s_and_b32 s5, s41, 15
    s_add_u32 s6, s3, s51
    s_and_b32 s6, s6, 3
    v_lshlrev_b32 v16, 4, v1
    v_and_b32 v2, 31, v1
    v_lshrrev_b32 v3, 5, v1
    v_lshlrev_b32 v2, 4, v2
    v_add_u32 v4, s48, v3
    v_lshl_add_u32 v28, v4, 10, v2
    s_mul_i32 s66, s50, 80
    s_add_u32 s66, s66, s49
    s_lshl_b32 s66, s66, 10
    s_add_u32 s88, s66, 8388608
    s_cmp_eq_u32 s48, 0
    s_cselect_b32 s67, 2048, 8
    s_add_u32 s89, s67, s88
    s_lshl_b32 s4, s43, 5
    s_add_u32 s4, s4, s50
    s_lshl_b32 s4, s4, 7
    s_add_u32 s4, s4, 21364736
    s_lshr_b32 s61, s3, 1
    s_and_b32 s62, s3, 1
    s_lshr_b32 s66, s49, 2
    s_add_u32 s67, s49, 2
    s_lshr_b32 s67, s67, 2
    s_sub_u32 s67, s67, s66
    v_bfe_u32 v2, v1, 1, 1
    v_mul_u32_u24 v2, s67, v2
    v_add_u32 v2, s66, v2
    s_mul_i32 s63, s61, 20
    s_add_u32 s63, s63, 20
    v_add_u32 v3, s63, v2
    v_and_b32 v6, 1, v1
    v_lshrrev_b32 v4, 2, v1
    v_lshl_add_u32 v4, v4, 1, s62
    v_lshl_add_u32 v5, v4, 1, v6
    v_lshl_add_u32 v5, v3, 6, v5
    v_lshlrev_b32 v5, 7, v5
    v_add_u32 v19, 20840448, v5
    s_lshr_b32 s64, s43, 4
    s_lshl_b32 s63, s64, 3
    v_and_b32 v4, 7, v4
    v_add_u32 v4, s63, v4
    v_lshl_add_u32 v4, v4, 1, v6
    v_lshl_add_u32 v3, v3, 6, v4
    s_lshl_b32 s63, s50, 1
    v_add_u32 v6, s63, v6
    v_lshl_add_u32 v2, v2, 6, v6
    v_cmp_gt_u32 vcc, 32, v1
    s_nop 1
    v_cndmask_b32 v2, v2, v3, vcc
    v_lshlrev_b32 v2, 7, v2
    v_add_u32 v30, 20840448, v2
    s_lshl_b32 s66, s61, 2
    v_xor_b32 v2, s66, v1
    v_lshlrev_b32 v17, 4, v2
    s_lshl_b32 s66, s61, 3
    v_xor_b32 v2, s66, v1
    v_lshlrev_b32 v18, 4, v2
    s_mul_i32 s66, s61, 80
    s_add_u32 s66, s66, 80
    s_add_u32 s66, s66, s49
    s_lshl_b32 s67, s62, 8
    s_add_u32 s66, s66, s67
    s_and_b32 s67, s45, 3
    s_lshl_b32 s64, s64, 2
    s_add_u32 s67, s67, s64
    s_lshl_b32 s67, s67, 9
    s_add_u32 s66, s66, s67
    s_lshl_b32 s54, s66, 10
    s_mul_i32 s58, s62, 7168
    s_mul_i32 s66, s61, 3072
    s_add_u32 s58, s58, s66
    s_add_u32 s58, s58, 92160
    s_lshl_b32 s66, s3, 8
    s_add_u32 s66, s66, 98304
    v_lshl_add_u32 v21, v1, 2, s66
    s_lshl_b32 s55, s50, 8
    s_add_u32 s55, s55, s49
    s_lshl_b32 s55, s55, 10
    s_add_u32 s76, s4, 524288
    v_add_u32 v20, 4096, v16
    v_and_b32 v5, 3, v1
    v_mov_b32 v10, 0x3f80
    v_cmp_eq_u32 vcc, 0, v5
    s_nop 1
    v_cndmask_b32 v10, 0, v10, vcc
    s_mov_b32 s44, 0
    s_nop 3
L_pl_7:
    buffer_load_dword v2, v30, s[32:35], 0 offen sc1
    s_waitcnt vmcnt(0)
    v_cmp_ne_u32 vcc, s42, v2
    s_add_u32 s44, s44, 1
    s_cmp_gt_u32 s44, 1000000
    s_cbranch_scc1 L_pld_8
    s_cbranch_vccnz L_pl_7
L_pld_8:
    s_add_u32 m0, s58, 43008
    s_xor_b32 s56, s54, 0
    buffer_load_dwordx4 v16, s[32:35], s56 offen offset:0 sc1 lds
    buffer_load_dwordx4 v17, s[32:35], s56 offen offset:1024 sc1 lds
    buffer_load_dwordx4 v18, s[32:35], s56 offen offset:2048 sc1 lds
    s_mul_i32 s66, s3, 3072
    s_add_u32 m0, s66, 122880
    s_nop 0
    buffer_load_dwordx4 v16, s[32:35], s55 offen offset:0 sc1 lds
    buffer_load_dwordx4 v16, s[32:35], s55 offen offset:1024 sc1 lds
    buffer_load_dwordx4 v16, s[32:35], s55 offen offset:2048 sc1 lds
    s_add_u32 m0, s58, 57344
    s_xor_b32 s56, s54, 524288
    buffer_load_dwordx4 v16, s[32:35], s56 offen offset:0 sc1 lds
    buffer_load_dwordx4 v17, s[32:35], s56 offen offset:1024 sc1 lds
    buffer_load_dwordx4 v18, s[32:35], s56 offen offset:2048 sc1 lds
    ds_write_b32 v21, v10 offset:43008
    ds_write_b32 v21, v10 offset:50176
    ds_write_b32 v21, v10 offset:57344
    ds_write_b32 v21, v10 offset:64512
    s_nop 1
    s_branch L_h_p1_done
.p2align 12
L_h_p1_done:
L_chain0:
    s_cbranch_execz L_pad0_1
    s_mov_b32 s75, s89
    s_mul_i32 s83, s2, 3
    s_add_u32 s83, s83, s3
    s_cmp_eq_u32 s3, 3
    s_cselect_b32 s83, 1023, s83
    s_lshl_b32 s88, s83, 7
    s_add_u32 s88, s88, 21757952
    s_mov_b32 s85, 25489408
    s_movk_i32 s86, 1280
    s_movk_i32 s87, 13108
    s_cmp_lt_u32 s83, 270
    s_cselect_b64 s[96:97], s[24:25], s[16:17]
    s_cselect_b32 s98, s26, s18
    s_cselect_b32 s84, 0, 270
    s_cselect_b32 s85, s85, 22376448
    s_cmp_lt_u32 s83, 370
    s_cselect_b64 s[96:97], s[96:97], s[20:21]
    s_cselect_b32 s98, s98, 2211840
    s_cselect_b32 s84, s84, 370
    s_cselect_b32 s85, s85, 23195648
    s_cselect_b32 s86, s86, 3456
    s_cselect_b32 s87, s87, 4682
    s_cselect_b32 s89, 5, 14
    s_mov_b32 s99, 0x20000
    s_sub_u32 s84, s83, s84
    s_lshl_b32 s90, s84, 13
    s_add_u32 s85, s85, s90
    s_lshl_b32 s90, s84, 9
    s_add_u32 s90, s90, 22183936
    s_cmp_lt_u32 s83, 370
    s_cselect_b32 s90, 0x7f000000, s90
    s_mul_i32 s87, s87, s84
    s_lshr_b32 s87, s87, 16
    s_mul_i32 s89, s89, s87
    s_sub_u32 s84, s84, s89
    s_mul_i32 s87, s87, s86
    s_lshl_b32 s87, s87, 5
    s_lshl_b32 s84, s84, 8
    s_add_u32 s87, s87, s84
    s_cmp_ge_u32 s83, 650
    s_cselect_b32 s98, 0, s98
    s_cselect_b32 s100, 0x7f000000, s85
    s_cselect_b32 s101, 0x7f000000, s88
    s_cselect_b32 s90, 0x7f000000, s90
    s_lshl_b32 s89, s86, 2
    s_sub_u32 s89, s89, 1024
    s_lshl_b32 s83, s3, 13
    s_add_u32 s83, s83, 0
    v_lshrrev_b32 v2, 4, v1
    v_mul_u32_u24 v3, s86, v2
    v_and_b32 v4, 15, v1
    v_lshlrev_b32 v5, 1, v2
    v_xor_b32 v4, v4, v5
    v_lshlrev_b32 v4, 4, v4
    v_add_u32 v252, v3, v4
    v_xor_b32 v4, 128, v4
    v_add_u32 v253, v3, v4
    v_bfe_u32 v3, v1, 2, 2
    v_lshl_add_u32 v4, v2, 3, v3
    v_lshlrev_b32 v4, 8, v4
    v_bfe_u32 v5, v1, 2, 3
    v_lshl_add_u32 v4, v5, 5, v4
    v_and_b32 v5, 3, v1
    v_lshl_add_u32 v4, v5, 3, v4
    v_add_u32 v254, s83, v4
    s_waitcnt vmcnt(3)
    s_waitcnt lgkmcnt(0)
    s_barrier
    s_add_u32 m0, s58, 0
    s_xor_b32 s56, s54, 1048576
    buffer_load_dwordx4 v16, s[32:35], s56 offen offset:0 sc1 lds
    buffer_load_dwordx4 v17, s[32:35], s56 offen offset:1024 sc1 lds
    buffer_load_dwordx4 v18, s[32:35], s56 offen offset:2048 sc1 lds
    s_add_u32 m0, s58, 14336
    s_xor_b32 s56, s54, 1572864
    buffer_load_dwordx4 v16, s[32:35], s56 offen offset:0 sc1 lds
    buffer_load_dwordx4 v17, s[32:35], s56 offen offset:1024 sc1 lds
    buffer_load_dwordx4 v18, s[32:35], s56 offen offset:2048 sc1 lds
    ds_write_b32 v21, v10 offset:0
    ds_write_b32 v21, v10 offset:7168
    ds_write_b32 v21, v10 offset:14336
    ds_write_b32 v21, v10 offset:21504
    s_add_u32 m0, s83, 0
    s_nop 0
    buffer_load_dwordx4 v252, s[96:99], s87 offen offset:0 lds
    s_add_u32 s87, s87, s89
    buffer_load_dwordx4 v252, s[96:99], s87 offen offset:1024 lds
    s_add_u32 s87, s87, s89
    buffer_load_dwordx4 v253, s[96:99], s87 offen offset:2048 lds
    s_add_u32 s87, s87, s89
    buffer_load_dwordx4 v253, s[96:99], s87 offen offset:3072 lds
    s_add_u32 m0, s83, 4096
    s_add_u32 s87, s87, 4096
    s_add_u32 s87, s87, s89
    buffer_load_dwordx4 v252, s[96:99], s87 offen offset:0 lds
    s_add_u32 s87, s87, s89
    buffer_load_dwordx4 v252, s[96:99], s87 offen offset:1024 lds
    s_add_u32 s87, s87, s89
    buffer_load_dwordx4 v253, s[96:99], s87 offen offset:2048 lds
    s_add_u32 s87, s87, s89
    buffer_load_dwordx4 v253, s[96:99], s87 offen offset:3072 lds
    s_waitcnt vmcnt(14)
    s_barrier
    ds_write_b32 v21, v10 offset:28672
    ds_write_b32 v21, v10 offset:35840
    s_mul_i32 s66, s51, 5
    s_mul_i32 s67, s3, 560
    s_add_u32 s67, s67, s66
    s_lshl_b32 s67, s67, 10
    s_add_u32 s59, s67, 25489408
    s_mul_i32 s67, s3, 200
    s_add_u32 s67, s67, s66
    s_lshl_b32 s67, s67, 10
    s_add_u32 s60, s67, 22376448
    s_mul_i32 s63, s5, 7
    s_mul_i32 s67, s3, 112
    s_add_u32 s67, s67, s63
    s_lshl_b32 s67, s67, 10
    s_add_u32 s53, s67, 23195648
    s_mul_i32 s7, s3, 7168
    v_and_b32 v2, 1, v1
    v_lshrrev_b32 v3, 1, v1
    v_lshl_add_u32 v4, v2, 2, s66
    v_lshrrev_b32 v4, 3, v4
    v_mul_u32_u24 v5, 6, v2
    v_add_u32 v5, s63, v5
    v_lshrrev_b32 v5, 3, v5
    s_mul_i32 s67, s3, 14
    v_add_u32 v6, s67, v3
    v_min_u32 v6, 53, v6
    v_mad_u32_u24 v6, v6, 5, v4
    s_mul_i32 s67, s3, 5
    s_add_u32 s67, s67, 40
    v_add_u32 v7, s67, v3
    v_mad_u32_u24 v7, v7, 5, v4
    v_cmp_le_u32 vcc, 14, v3
    s_nop 1
    v_cndmask_b32 v6, v6, v7, vcc
    v_subrev_u32 v7, 19, v3
    v_min_u32 v7, 4, v7
    v_lshl_add_u32 v7, v7, 2, s3
    v_mad_u32_u24 v7, v7, 14, v5
    v_add_u32 v7, 370, v7
    v_cmp_le_u32 vcc, 19, v3
    s_nop 1
    v_cndmask_b32 v6, v6, v7, vcc
    v_lshlrev_b32 v6, 7, v6
    v_add_u32 v29, 21757952, v6
    s_lshl_b32 s66, s41, 2
    s_add_u32 s66, s66, s3
    s_mul_i32 s67, s66, 5
    v_add_u32 v11, s67, v1
    v_lshlrev_b32 v11, 7, v11
    v_min_u32 v11, CODE_BYTES-64, v11
    s_lshl_b32 s67, s40, 7
    s_add_u32 s66, s66, s67
    s_mul_i32 s67, s66, 6912
    s_add_u32 s67, s67, 13631488
    v_lshl_add_u32 v22, v1, 7, s67
    s_lshl_b32 s67, s66, 7
    s_add_u32 s67, s67, 20709376
    v_mov_b32 v2, s67
    v_cmp_le_u32 vcc, 54, v1
    s_nop 1
    v_cndmask_b32 v22, v22, v2, vcc
    s_mul_i32 s67, s66, 2560
    s_add_u32 s67, s67, 11010048
    v_lshl_add_u32 v23, v1, 7, s67
    s_and_b32 s67, s75, 0xfffffc00
    s_sub_u32 s67, s67, 2560
    v_lshl_add_u32 v2, v1, 7, s67
    v_cmp_le_u32 vcc, 20, v1
    s_nop 1
    v_cndmask_b32 v23, v23, v2, vcc
    s_lshl_b32 s67, s66, 7
    s_add_u32 s67, s67, 17694720
    v_lshlrev_b32 v2, 17, v1
    v_add_u32 v2, s67, v2
    v_cmp_le_u32 vcc, 28, v1
    s_nop 1
    v_cndmask_b32 v23, v23, v2, vcc
    v_and_b32 v2, 7, v1
    s_lshl_b32 s66, s3, 3
    v_add_u32 v2, s66, v2
    v_lshl_add_u32 v2, v2, 5, s52
    v_lshlrev_b32 v2, 7, v2
    v_add_u32 v2, 21889024, v2
    v_lshrrev_b32 v3, 3, v1
    v_cmp_eq_u32 vcc, 60, v3
    s_nop 1
    v_cndmask_b32 v29, v29, v2, vcc
    s_mov_b64 exec, 0x1f
    global_load_dword v12, v11, s[92:93]
    s_mov_b64 exec, -1
    s_waitcnt vmcnt(9)
    s_waitcnt lgkmcnt(0)
    s_barrier
    s_mov_b32 s44, 0
    s_nop 1
L_pl_9:
    buffer_load_dword v2, v19, s[32:35], 0 offen sc1
    s_waitcnt vmcnt(0)
    v_cmp_ne_u32 vcc, s42, v2
    s_add_u32 s44, s44, 1
    s_cmp_gt_u32 s44, 1000000
    s_cbranch_scc1 L_pld_10
    s_cbranch_vccnz L_pl_9
L_pld_10:
    s_add_u32 m0, s58, 28672
    s_xor_b32 s56, s54, 2097152
    buffer_load_dwordx4 v16, s[32:35], s56 offen offset:0 sc1 lds
    buffer_load_dwordx4 v17, s[32:35], s56 offen offset:1024 sc1 lds
    buffer_load_dwordx4 v18, s[32:35], s56 offen offset:2048 sc1 lds
    s_add_u32 m0, s58, 43008
    s_xor_b32 s56, s54, 2621440
    buffer_load_dwordx4 v16, s[32:35], s56 offen offset:0 sc1 lds
    buffer_load_dwordx4 v17, s[32:35], s56 offen offset:1024 sc1 lds
    buffer_load_dwordx4 v18, s[32:35], s56 offen offset:2048 sc1 lds
    v_xor_b32 v2, 0, v254
    ds_read_b64_tr_b16 v[208:209], v2 offset:0
    ds_read_b64_tr_b16 v[210:211], v2 offset:1024
    v_xor_b32 v2, 32, v254
    ds_read_b64_tr_b16 v[212:213], v2 offset:0
    ds_read_b64_tr_b16 v[214:215], v2 offset:1024
    v_xor_b32 v2, 64, v254
    ds_read_b64_tr_b16 v[216:217], v2 offset:0
    ds_read_b64_tr_b16 v[218:219], v2 offset:1024
    v_xor_b32 v2, 96, v254
    ds_read_b64_tr_b16 v[220:221], v2 offset:0
    ds_read_b64_tr_b16 v[222:223], v2 offset:1024
    v_xor_b32 v2, 128, v254
    ds_read_b64_tr_b16 v[224:225], v2 offset:0
    ds_read_b64_tr_b16 v[226:227], v2 offset:1024
    v_xor_b32 v2, 160, v254
    ds_read_b64_tr_b16 v[228:229], v2 offset:0
    ds_read_b64_tr_b16 v[230:231], v2 offset:1024
    v_xor_b32 v2, 192, v254
    ds_read_b64_tr_b16 v[232:233], v2 offset:0
    ds_read_b64_tr_b16 v[234:235], v2 offset:1024
    v_xor_b32 v2, 224, v254
    ds_read_b64_tr_b16 v[236:237], v2 offset:0
    ds_read_b64_tr_b16 v[238:239], v2 offset:1024
    s_waitcnt lgkmcnt(14)
    buffer_store_dwordx4 v[208:211], v16, s[32:35], s100 offen offset:0 sc1
    s_waitcnt lgkmcnt(12)
    buffer_store_dwordx4 v[212:215], v16, s[32:35], s100 offen offset:1024 sc1
    s_waitcnt lgkmcnt(10)
    buffer_store_dwordx4 v[216:219], v16, s[32:35], s100 offen offset:2048 sc1
    s_waitcnt lgkmcnt(8)
    buffer_store_dwordx4 v[220:223], v16, s[32:35], s100 offen offset:3072 sc1
    s_add_u32 s100, s100, 4096
    s_waitcnt lgkmcnt(6)
    buffer_store_dwordx4 v[224:227], v16, s[32:35], s100 offen offset:0 sc1
    s_waitcnt lgkmcnt(4)
    buffer_store_dwordx4 v[228:231], v16, s[32:35], s100 offen offset:1024 sc1
    s_waitcnt lgkmcnt(2)
    buffer_store_dwordx4 v[232:235], v16, s[32:35], s100 offen offset:2048 sc1
    s_waitcnt lgkmcnt(0)
    buffer_store_dwordx4 v[236:239], v16, s[32:35], s100 offen offset:3072 sc1
    v_mov_b32 v168, 0x3f803f80
    v_mov_b32 v169, 0x3f803f80
    v_mov_b32 v170, 0x3f803f80
    v_mov_b32 v171, 0x3f803f80
    s_nop 1
    v_mfma_f32_16x16x32_bf16 v[176:179], v[168:171], v[208:211], 0
    v_mfma_f32_16x16x32_bf16 v[180:183], v[168:171], v[212:215], 0
    v_mfma_f32_16x16x32_bf16 v[184:187], v[168:171], v[216:219], 0
    v_mfma_f32_16x16x32_bf16 v[188:191], v[168:171], v[220:223], 0
    v_mfma_f32_16x16x32_bf16 v[192:195], v[168:171], v[224:227], 0
    v_mfma_f32_16x16x32_bf16 v[196:199], v[168:171], v[228:231], 0
    v_mfma_f32_16x16x32_bf16 v[200:203], v[168:171], v[232:235], 0
    v_mfma_f32_16x16x32_bf16 v[204:207], v[168:171], v[236:239], 0
    v_lshrrev_b32 v3, 4, v1
    v_lshlrev_b32 v2, 2, v1
    v_cmp_eq_u32 vcc, 1, v3
    s_nop 1
    v_cndmask_b32 v176, v176, v180, vcc
    v_cndmask_b32 v192, v192, v196, vcc
    v_cmp_eq_u32 vcc, 2, v3
    s_nop 1
    v_cndmask_b32 v176, v176, v184, vcc
    v_cndmask_b32 v192, v192, v200, vcc
    v_cmp_eq_u32 vcc, 3, v3
    s_nop 1
    v_cndmask_b32 v176, v176, v188, vcc
    v_cndmask_b32 v192, v192, v204, vcc
    buffer_store_dword v176, v2, s[32:35], s90 offen offset:0 sc1
    buffer_store_dword v192, v2, s[32:35], s90 offen offset:256 sc1
    s_waitcnt vmcnt(10)
    s_barrier
    s_add_u32 m0, s58, 57344
    s_xor_b32 s56, s54, 3145728
    buffer_load_dwordx4 v16, s[32:35], s56 offen offset:0 sc1 lds
    buffer_load_dwordx4 v17, s[32:35], s56 offen offset:1024 sc1 lds
    buffer_load_dwordx4 v18, s[32:35], s56 offen offset:2048 sc1 lds
    s_add_u32 m0, s58, 0
    s_xor_b32 s56, s54, 3670016
    buffer_load_dwordx4 v16, s[32:35], s56 offen offset:0 sc1 lds
    buffer_load_dwordx4 v17, s[32:35], s56 offen offset:1024 sc1 lds
    buffer_load_dwordx4 v18, s[32:35], s56 offen offset:2048 sc1 lds
    s_waitcnt vmcnt(6)
    v_mov_b32 v2, s42
    v_lshlrev_b32 v3, 2, v1
    s_mov_b32 exec_hi, 0
    buffer_store_dword v2, v3, s[32:35], s101 offen sc1
    s_mov_b32 exec_hi, -1
    s_add_u32 s67, s6, 1
    s_and_b32 s67, s67, 3
    s_lshl_b32 s66, s52, 2
    s_add_u32 s66, s66, s67
    s_mul_i32 s66, s66, 20480
    s_mul_i32 s67, s51, 160
    s_add_u32 s66, s66, s67
    s_mul_i32 s67, s3, 2560
    v_add_u32 v13, 0, v1
    v_mul_u32_u24 v14, 6554, v13
    v_lshrrev_b32 v14, 16, v14
    v_mul_u32_u24 v14, 1120, v14
    v_lshl_add_u32 v13, v13, 4, v14
    s_add_u32 m0, s67, 81920
    s_nop 0
    buffer_load_dwordx4 v13, s[8:11], s66 offen lds
    v_add_u32 v13, 64, v1
    v_mul_u32_u24 v14, 6554, v13
    v_lshrrev_b32 v14, 16, v14
    v_mul_u32_u24 v14, 1120, v14
    v_lshl_add_u32 v13, v13, 4, v14
    s_add_u32 m0, s67, 82944
    s_nop 0
    buffer_load_dwordx4 v13, s[8:11], s66 offen lds
    v_add_u32 v13, 128, v1
    v_mul_u32_u24 v14, 6554, v13
    v_lshrrev_b32 v14, 16, v14
    v_mul_u32_u24 v14, 1120, v14
    v_lshl_add_u32 v13, v13, 4, v14
    s_add_u32 m0, s67, 83968
    s_mov_b32 exec_hi, 0
    buffer_load_dwordx4 v13, s[8:11], s66 offen lds
    s_mov_b32 exec_hi, -1
    s_mov_b32 exec_lo, 0x3fff
    s_mov_b32 exec_hi, 0x0
    buffer_load_dword v4, v22, s[32:35], 0 offen sc1
    s_mov_b64 exec, -1
    s_mov_b32 exec_lo, 0xfffc000
    s_mov_b32 exec_hi, 0x0
    buffer_load_dword v5, v22, s[32:35], 0 offen sc1
    s_mov_b64 exec, -1
    s_mov_b64 exec, 0
    s_branch L_chain1
L_chain1_ret:
    s_mov_b64 exec, -1
    s_waitcnt vmcnt(6)
    s_barrier
    s_mov_b32 s44, 0
    s_nop 1
L_pl_11:
    buffer_load_dword v2, v29, s[32:35], 0 offen sc1
    s_waitcnt vmcnt(0)
    v_cmp_ne_u32 vcc, s42, v2
    s_add_u32 s44, s44, 1
    s_cmp_gt_u32 s44, 1000000
    s_cbranch_scc1 L_pld_12
    s_cbranch_vccnz L_pl_11
L_pld_12:
    s_add_u32 m0, s58, 14336
    s_xor_b32 s56, s54, 4194304
    buffer_load_dwordx4 v16, s[32:35], s56 offen offset:0 sc1 lds
    buffer_load_dwordx4 v17, s[32:35], s56 offen offset:1024 sc1 lds
    buffer_load_dwordx4 v18, s[32:35], s56 offen offset:2048 sc1 lds
    s_add_u32 m0, s58, 28672
    s_xor_b32 s56, s54, 4718592
    buffer_load_dwordx4 v16, s[32:35], s56 offen offset:0 sc1 lds
    buffer_load_dwordx4 v17, s[32:35], s56 offen offset:1024 sc1 lds
    buffer_load_dwordx4 v18, s[32:35], s56 offen offset:2048 sc1 lds
    s_mul_i32 s66, s3, 20480
    s_add_u32 m0, s66, 0
    s_add_u32 s57, s60, 0
    buffer_load_dwordx4 v16, s[32:35], s57 offen offset:0 sc1 lds
    buffer_load_dwordx4 v16, s[32:35], s57 offen offset:1024 sc1 lds
    buffer_load_dwordx4 v16, s[32:35], s57 offen offset:2048 sc1 lds
    buffer_load_dwordx4 v16, s[32:35], s57 offen offset:3072 sc1 lds
    s_add_u32 m0, s66, 4096
    s_nop 0
    buffer_load_dwordx4 v20, s[32:35], s57 offen sc1 lds
    s_add_u32 m0, s66, 5120
    s_add_u32 s57, s60, 40960
    buffer_load_dwordx4 v16, s[32:35], s57 offen offset:0 sc1 lds
    buffer_load_dwordx4 v16, s[32:35], s57 offen offset:1024 sc1 lds
    buffer_load_dwordx4 v16, s[32:35], s57 offen offset:2048 sc1 lds
    buffer_load_dwordx4 v16, s[32:35], s57 offen offset:3072 sc1 lds
    s_add_u32 m0, s66, 9216
    s_nop 0
    buffer_load_dwordx4 v20, s[32:35], s57 offen sc1 lds
    s_add_u32 m0, s66, 10240
    s_add_u32 s57, s60, 81920
    buffer_load_dwordx4 v16, s[32:35], s57 offen offset:0 sc1 lds
    buffer_load_dwordx4 v16, s[32:35], s57 offen offset:1024 sc1 lds
    buffer_load_dwordx4 v16, s[32:35], s57 offen offset:2048 sc1 lds
    buffer_load_dwordx4 v16, s[32:35], s57 offen offset:3072 sc1 lds
    s_add_u32 m0, s66, 14336
    s_nop 0
    buffer_load_dwordx4 v20, s[32:35], s57 offen sc1 lds
    s_add_u32 m0, s66, 15360
    s_add_u32 s57, s60, 122880
    buffer_load_dwordx4 v16, s[32:35], s57 offen offset:0 sc1 lds
    buffer_load_dwordx4 v16, s[32:35], s57 offen offset:1024 sc1 lds
    buffer_load_dwordx4 v16, s[32:35], s57 offen offset:2048 sc1 lds
    buffer_load_dwordx4 v16, s[32:35], s57 offen offset:3072 sc1 lds
    s_add_u32 m0, s66, 19456
    s_nop 0
    buffer_load_dwordx4 v20, s[32:35], s57 offen sc1 lds
    s_add_u32 s57, s59, 0
    buffer_load_dwordx4 v[36:39], v16, s[32:35], s57 offen offset:0 sc1
    buffer_load_dwordx4 v[40:43], v16, s[32:35], s57 offen offset:1024 sc1
    buffer_load_dwordx4 v[44:47], v16, s[32:35], s57 offen offset:2048 sc1
    buffer_load_dwordx4 v[48:51], v16, s[32:35], s57 offen offset:3072 sc1
    buffer_load_dwordx4 v[52:55], v20, s[32:35], s57 offen offset:0 sc1
    s_waitcnt vmcnt(5)
    s_barrier
    s_add_u32 m0, s58, 43008
    s_xor_b32 s56, s54, 5242880
    buffer_load_dwordx4 v16, s[32:35], s56 offen offset:0 sc1 lds
    buffer_load_dwordx4 v17, s[32:35], s56 offen offset:1024 sc1 lds
    buffer_load_dwordx4 v18, s[32:35], s56 offen offset:2048 sc1 lds
    s_add_u32 m0, s58, 57344
    s_xor_b32 s56, s54, 5767168
    buffer_load_dwordx4 v16, s[32:35], s56 offen offset:0 sc1 lds
    buffer_load_dwordx4 v17, s[32:35], s56 offen offset:1024 sc1 lds
    buffer_load_dwordx4 v18, s[32:35], s56 offen offset:2048 sc1 lds
    s_add_u32 s57, s59, 40960
    buffer_load_dwordx4 v[56:59], v16, s[32:35], s57 offen offset:0 sc1
    buffer_load_dwordx4 v[60:63], v16, s[32:35], s57 offen offset:1024 sc1
    buffer_load_dwordx4 v[64:67], v16, s[32:35], s57 offen offset:2048 sc1
    buffer_load_dwordx4 v[68:71], v16, s[32:35], s57 offen offset:3072 sc1
    buffer_load_dwordx4 v[72:75], v20, s[32:35], s57 offen offset:0 sc1
    s_add_u32 s57, s59, 81920
    buffer_load_dwordx4 v[76:79], v16, s[32:35], s57 offen offset:0 sc1
    buffer_load_dwordx4 v[80:83], v16, s[32:35], s57 offen offset:1024 sc1
    buffer_load_dwordx4 v[84:87], v16, s[32:35], s57 offen offset:2048 sc1
    buffer_load_dwordx4 v[88:91], v16, s[32:35], s57 offen offset:3072 sc1
    buffer_load_dwordx4 v[92:95], v20, s[32:35], s57 offen offset:0 sc1
    s_add_u32 s57, s59, 122880
    buffer_load_dwordx4 v[96:99], v16, s[32:35], s57 offen offset:0 sc1
    buffer_load_dwordx4 v[100:103], v16, s[32:35], s57 offen offset:1024 sc1
    buffer_load_dwordx4 v[104:107], v16, s[32:35], s57 offen offset:2048 sc1
    buffer_load_dwordx4 v[108:111], v16, s[32:35], s57 offen offset:3072 sc1
    buffer_load_dwordx4 v[112:115], v20, s[32:35], s57 offen offset:0 sc1
    s_add_u32 s57, s59, 163840
    buffer_load_dwordx4 v[116:119], v16, s[32:35], s57 offen offset:0 sc1
    buffer_load_dwordx4 v[120:123], v16, s[32:35], s57 offen offset:1024 sc1
    buffer_load_dwordx4 v[124:127], v16, s[32:35], s57 offen offset:2048 sc1
    buffer_load_dwordx4 v[128:131], v16, s[32:35], s57 offen offset:3072 sc1
    buffer_load_dwordx4 v[132:135], v20, s[32:35], s57 offen offset:0 sc1
    s_mov_b32 exec_lo, 0xf0000000
    s_mov_b32 exec_hi, 0x3ff
    buffer_load_dword v6, v22, s[32:35], 0 offen sc1
    s_mov_b64 exec, -1
    s_mov_b64 exec, 0x1f
    global_load_dword v12, v11, s[92:93]
    s_mov_b64 exec, -1
    s_waitcnt vmcnt(22)
    s_barrier
    s_add_u32 m0, s58, 0
    s_xor_b32 s56, s54, 6291456
    buffer_load_dwordx4 v16, s[32:35], s56 offen offset:0 sc1 lds
    buffer_load_dwordx4 v17, s[32:35], s56 offen offset:1024 sc1 lds
    buffer_load_dwordx4 v18, s[32:35], s56 offen offset:2048 sc1 lds
    s_add_u32 m0, s58, 14336
    s_xor_b32 s56, s54, 6815744
    buffer_load_dwordx4 v16, s[32:35], s56 offen offset:0 sc1 lds
    buffer_load_dwordx4 v17, s[32:35], s56 offen offset:1024 sc1 lds
    buffer_load_dwordx4 v18, s[32:35], s56 offen offset:2048 sc1 lds
    s_add_u32 s57, s59, 204800
    buffer_load_dwordx4 v[136:139], v16, s[32:35], s57 offen offset:0 sc1
    buffer_load_dwordx4 v[140:143], v16, s[32:35], s57 offen offset:1024 sc1
    buffer_load_dwordx4 v[144:147], v16, s[32:35], s57 offen offset:2048 sc1
    buffer_load_dwordx4 v[148:151], v16, s[32:35], s57 offen offset:3072 sc1
    buffer_load_dwordx4 v[152:155], v20, s[32:35], s57 offen offset:0 sc1
    s_add_u32 s57, s59, 245760
    buffer_load_dwordx4 v[156:159], v16, s[32:35], s57 offen offset:0 sc1
    buffer_load_dwordx4 v[160:163], v16, s[32:35], s57 offen offset:1024 sc1
    buffer_load_dwordx4 v[164:167], v16, s[32:35], s57 offen offset:2048 sc1
    buffer_load_dwordx4 v[168:171], v16, s[32:35], s57 offen offset:3072 sc1
    buffer_load_dwordx4 v[172:175], v20, s[32:35], s57 offen offset:0 sc1
    s_add_u32 s57, s59, 286720
    buffer_load_dwordx4 v[176:179], v16, s[32:35], s57 offen offset:0 sc1
    buffer_load_dwordx4 v[180:183], v16, s[32:35], s57 offen offset:1024 sc1
    buffer_load_dwordx4 v[184:187], v16, s[32:35], s57 offen offset:2048 sc1
    buffer_load_dwordx4 v[188:191], v16, s[32:35], s57 offen offset:3072 sc1
    buffer_load_dwordx4 v[192:195], v20, s[32:35], s57 offen offset:0 sc1
    s_add_u32 m0, s7, 0
    s_add_u32 s57, s53, 0
    buffer_load_dwordx4 v16, s[32:35], s57 offen offset:0 sc1 lds
    buffer_load_dwordx4 v16, s[32:35], s57 offen offset:1024 sc1 lds
    buffer_load_dwordx4 v16, s[32:35], s57 offen offset:2048 sc1 lds
    buffer_load_dwordx4 v16, s[32:35], s57 offen offset:3072 sc1 lds
    s_add_u32 m0, s7, 4096
    s_add_u32 s57, s53, 4096
    buffer_load_dwordx4 v16, s[32:35], s57 offen offset:0 sc1 lds
    buffer_load_dwordx4 v16, s[32:35], s57 offen offset:1024 sc1 lds
    buffer_load_dwordx4 v16, s[32:35], s57 offen offset:2048 sc1 lds
    s_mov_b32 exec_lo, 0x0
    s_mov_b32 exec_hi, 0xfffc00
    buffer_load_dword v7, v22, s[32:35], 0 offen sc1
    s_mov_b64 exec, -1
    s_waitcnt vmcnt(23)
    s_barrier
    s_add_u32 m0, s58, 28672
    s_xor_b32 s56, s54, 7340032
    buffer_load_dwordx4 v16, s[32:35], s56 offen offset:0 sc1 lds
    buffer_load_dwordx4 v17, s[32:35], s56 offen offset:1024 sc1 lds
    buffer_load_dwordx4 v18, s[32:35], s56 offen offset:2048 sc1 lds
    s_add_u32 m0, s58, 43008
    s_xor_b32 s56, s54, 7864320
    buffer_load_dwordx4 v16, s[32:35], s56 offen offset:0 sc1 lds
    buffer_load_dwordx4 v17, s[32:35], s56 offen offset:1024 sc1 lds
    buffer_load_dwordx4 v18, s[32:35], s56 offen offset:2048 sc1 lds
    s_add_u32 s57, s59, 327680
    buffer_load_dwordx4 v[196:199], v16, s[32:35], s57 offen offset:0 sc1
    buffer_load_dwordx4 v[200:203], v16, s[32:35], s57 offen offset:1024 sc1
    buffer_load_dwordx4 v[204:207], v16, s[32:35], s57 offen offset:2048 sc1
    buffer_load_dwordx4 v[208:211], v16, s[32:35], s57 offen offset:3072 sc1
    buffer_load_dwordx4 v[212:215], v20, s[32:35], s57 offen offset:0 sc1
    s_add_u32 s57, s59, 368640
    buffer_load_dwordx4 v[216:219], v16, s[32:35], s57 offen offset:0 sc1
    buffer_load_dwordx4 v[220:223], v16, s[32:35], s57 offen offset:1024 sc1
    buffer_load_dwordx4 v[224:227], v16, s[32:35], s57 offen offset:2048 sc1
    buffer_load_dwordx4 v[228:231], v16, s[32:35], s57 offen offset:3072 sc1
    buffer_load_dwordx4 v[232:235], v20, s[32:35], s57 offen offset:0 sc1
    s_add_u32 s57, s59, 409600
    buffer_load_dwordx4 v[236:239], v16, s[32:35], s57 offen offset:0 sc1
    buffer_load_dwordx4 v[240:243], v16, s[32:35], s57 offen offset:1024 sc1
    buffer_load_dwordx4 v[244:247], v16, s[32:35], s57 offen offset:2048 sc1
    buffer_load_dwordx4 v[248:251], v16, s[32:35], s57 offen offset:3072 sc1
    buffer_load_dwordx4 v[252:255], v20, s[32:35], s57 offen offset:0 sc1
    s_add_u32 m0, s7, 28672
    s_add_u32 s57, s53, 458752
    buffer_load_dwordx4 v16, s[32:35], s57 offen offset:0 sc1 lds
    buffer_load_dwordx4 v16, s[32:35], s57 offen offset:1024 sc1 lds
    buffer_load_dwordx4 v16, s[32:35], s57 offen offset:2048 sc1 lds
    buffer_load_dwordx4 v16, s[32:35], s57 offen offset:3072 sc1 lds
    s_add_u32 m0, s7, 32768
    s_add_u32 s57, s53, 462848
    buffer_load_dwordx4 v16, s[32:35], s57 offen offset:0 sc1 lds
    buffer_load_dwordx4 v16, s[32:35], s57 offen offset:1024 sc1 lds
    buffer_load_dwordx4 v16, s[32:35], s57 offen offset:2048 sc1 lds
    s_add_u32 m0, s7, 57344
    s_add_u32 s57, s53, 917504
    buffer_load_dwordx4 v16, s[32:35], s57 offen offset:0 sc1 lds
    buffer_load_dwordx4 v16, s[32:35], s57 offen offset:1024 sc1 lds
    buffer_load_dwordx4 v16, s[32:35], s57 offen offset:2048 sc1 lds
    buffer_load_dwordx4 v16, s[32:35], s57 offen offset:3072 sc1 lds
    s_add_u32 m0, s7, 61440
    s_add_u32 s57, s53, 921600
    buffer_load_dwordx4 v16, s[32:35], s57 offen offset:0 sc1 lds
    buffer_load_dwordx4 v16, s[32:35], s57 offen offset:1024 sc1 lds
    buffer_load_dwordx4 v16, s[32:35], s57 offen offset:2048 sc1 lds
    s_mov_b32 exec_lo, 0x7fffffff
    s_mov_b32 exec_hi, 0x0
    buffer_load_dword v8, v23, s[32:35], 0 offen sc1
    s_mov_b64 exec, -1
    s_mov_b64 exec, 0
    s_branch L_chain2
L_chain2_ret:
    s_mov_b64 exec, -1
    s_waitcnt vmcnt(30)
    s_barrier
    s_mul_i32 s66, s3, 5120
    s_add_u32 m0, s66, 86016
    s_add_u32 s57, s60, 163840
    buffer_load_dwordx4 v16, s[32:35], s57 offen offset:0 sc1 lds
    buffer_load_dwordx4 v16, s[32:35], s57 offen offset:1024 sc1 lds
    buffer_load_dwordx4 v16, s[32:35], s57 offen offset:2048 sc1 lds
    buffer_load_dwordx4 v16, s[32:35], s57 offen offset:3072 sc1 lds
    s_add_u32 m0, s66, 90112
    s_nop 0
    buffer_load_dwordx4 v20, s[32:35], s57 offen sc1 lds
    v_lshrrev_b32 v2, 3, v1
    v_mul_u32_u24 v3, 7168, v2
    v_and_b32 v9, 7, v1
    v_lshl_add_u32 v3, v9, 4, v3
    v_lshrrev_b32 v2, 5, v1
    v_lshl_add_u32 v9, v2, 30, v3
    s_mul_i32 s66, s5, 448
    s_mul_i32 s67, s3, 112
    s_add_u32 s66, s66, s67
    s_add_u32 s66, s66, 22183936
    s_add_u32 s67, s66, 57344
    s_add_u32 s62, s66, 114688
    buffer_load_dwordx4 v[24:27], v3, s[32:35], s66 offen sc1
    buffer_load_dwordx4 v[28:31], v3, s[32:35], s67 offen sc1
    buffer_load_dwordx4 v[32:35], v9, s[32:35], s62 offen sc1
    s_mov_b32 exec_hi, 0
    buffer_load_dword v4, v23, s[32:35], 0 offen sc1
    s_mov_b32 exec_hi, -1
    buffer_load_dword v5, v22, s[32:35], 0 offen sc1
    v_min_u32 v2, 55, v1
    v_lshlrev_b32 v2, 7, v2
    s_lshr_b32 s67, s41, 4
    s_mul_i32 s67, s67, 458752
    s_add_u32 s66, s53, 1376256
    s_add_u32 s66, s66, s67
    buffer_load_dword v6, v2, s[32:35], s66 offen sc1
    s_waitcnt vmcnt(4)
    v_add_f32 v24, v24, v28
    v_add_f32 v25, v25, v29
    v_add_f32 v26, v26, v30
    v_add_f32 v27, v27, v31
    s_waitcnt vmcnt(3)
    v_add_f32 v24, v24, v32
    v_add_f32 v25, v25, v33
    v_add_f32 v26, v26, v34
    v_add_f32 v27, v27, v35
    v_add_f32_dpp v24, v24, v24 row_ror:8 row_mask:0xf bank_mask:0xf
    v_add_f32_dpp v25, v25, v25 row_ror:8 row_mask:0xf bank_mask:0xf
    v_add_f32_dpp v26, v26, v26 row_ror:8 row_mask:0xf bank_mask:0xf
    v_add_f32_dpp v27, v27, v27 row_ror:8 row_mask:0xf bank_mask:0xf
    v_mov_b32 v28, v24
    v_mov_b32 v29, v25
    v_mov_b32 v30, v26
    v_mov_b32 v31, v27
    v_permlane16_swap_b32 v24, v28
    v_permlane16_swap_b32 v25, v29
    v_permlane16_swap_b32 v26, v30
    v_permlane16_swap_b32 v27, v31
    v_add_f32 v24, v24, v28
    v_add_f32 v25, v25, v29
    v_add_f32 v26, v26, v30
    v_add_f32 v27, v27, v31
    v_mov_b32 v28, v24
    v_mov_b32 v29, v25
    v_mov_b32 v30, v26
    v_mov_b32 v31, v27
    v_permlane32_swap_b32 v24, v28
    v_permlane32_swap_b32 v25, v29
    v_permlane32_swap_b32 v26, v30
    v_permlane32_swap_b32 v27, v31
    v_add_f32 v24, v24, v28
    v_add_f32 v25, v25, v29
    v_add_f32 v26, v26, v30
    v_add_f32 v27, v27, v31
    s_waitcnt vmcnt(0)
    v_lshrrev_b32 v2, 4, v1
    v_and_b32 v3, 15, v1
    v_lshlrev_b32 v3, 4, v3
    v_lshl_add_u32 v3, v2, 10, v3
    s_mul_i32 s62, s52, 216
    s_mul_i32 s66, s3, 56
    s_add_u32 s63, s62, 212
    s_add_u32 s62, s62, s66
    s_lshl_b32 s62, s62, 10
L_pad2_3:
    s_cbranch_execz L_chain2_ret
    s_add_u32 s62, s62, 13631488
    s_lshl_b32 s63, s63, 10
    s_add_u32 s63, s63, 13631488
    s_add_u32 s66, s6, 1
    s_and_b32 s66, s66, 3
    s_lshl_b32 s67, s66, 8
    v_add_u32 v12, s67, v3
    s_mul_i32 s66, s66, 35840
    s_add_u32 s66, s66, 15360
    v_add_u32 v8, s66, v16
    s_add_u32 s66, s6, 2
    s_and_b32 s66, s66, 3
    s_lshl_b32 s67, s66, 8
    v_add_u32 v13, s67, v3
    s_mul_i32 s66, s66, 35840
    s_add_u32 s66, s66, 20480
    v_add_u32 v9, s66, v16
    s_add_u32 s66, s6, 3
    s_and_b32 s66, s66, 3
    s_lshl_b32 s67, s66, 8
    v_add_u32 v14, s67, v3
    s_mul_i32 s66, s66, 35840
    s_add_u32 s66, s66, 25600
    v_add_u32 v10, s66, v16
    s_add_u32 s66, s6, 4
    s_and_b32 s66, s66, 3
    s_lshl_b32 s67, s66, 8
    v_add_u32 v15, s67, v3
    s_mul_i32 s66, s66, 35840
    s_add_u32 s66, s66, 30720
    v_add_u32 v11, s66, v16
    s_add_u32 s70, s62, 0
    s_add_u32 s71, s62, 4096
    s_add_u32 s72, s62, 8192
    s_add_u32 s73, s62, 12288
    s_add_u32 s74, s62, 16384
    s_add_u32 s75, s62, 20480
    s_add_u32 s76, s62, 24576
    s_add_u32 s77, s62, 28672
    s_add_u32 s78, s62, 32768
    v_and_b32 v2, 3, v1
    s_lshl_b32 s67, s3, 2
    s_lshr_b32 s66, s52, 1
    s_lshl_b32 s66, s66, 4
    s_add_u32 s66, s66, s67
    v_add_u32 v2, s66, v2
    v_bfe_u32 v3, v1, 2, 1
    v_lshl_add_u32 v2, v2, 2, v3
    s_and_b32 s66, s52, 1
    s_lshl_b32 s66, s66, 1
    v_add_u32 v2, s66, v2
    v_lshlrev_b32 v2, 7, v2
    v_add_u32 v17, 21626880, v2
    s_mul_i32 s66, s3, 112
    s_add_u32 s66, s66, 143360
    v_add_u32 v6, s66, v16
    s_mul_i32 s66, s3, 5120
    s_add_u32 s67, s66, 61440
    v_add_u32 v7, s67, v16
    s_barrier
    s_add_u32 m0, s7, 114688
    s_add_u32 s57, s53, 1835008
    buffer_load_dwordx4 v16, s[32:35], s57 offen offset:0 sc1 lds
    buffer_load_dwordx4 v16, s[32:35], s57 offen offset:1024 sc1 lds
    buffer_load_dwordx4 v16, s[32:35], s57 offen offset:2048 sc1 lds
    buffer_load_dwordx4 v16, s[32:35], s57 offen offset:3072 sc1 lds
    s_add_u32 m0, s7, 118784
    s_add_u32 s57, s53, 1839104
    buffer_load_dwordx4 v16, s[32:35], s57 offen offset:0 sc1 lds
    buffer_load_dwordx4 v16, s[32:35], s57 offen offset:1024 sc1 lds
    buffer_load_dwordx4 v16, s[32:35], s57 offen offset:2048 sc1 lds
    s_barrier
    s_barrier
    s_barrier
    s_add_u32 m0, s7, 86016
    s_add_u32 s57, s53, 1376256
    buffer_load_dwordx4 v16, s[32:35], s57 offen offset:0 sc1 lds
    buffer_load_dwordx4 v16, s[32:35], s57 offen offset:1024 sc1 lds
    buffer_load_dwordx4 v16, s[32:35], s57 offen offset:2048 sc1 lds
    buffer_load_dwordx4 v16, s[32:35], s57 offen offset:3072 sc1 lds
    s_add_u32 m0, s7, 90112
    s_add_u32 s57, s53, 1380352
    buffer_load_dwordx4 v16, s[32:35], s57 offen offset:0 sc1 lds
    buffer_load_dwordx4 v16, s[32:35], s57 offen offset:1024 sc1 lds
    buffer_load_dwordx4 v16, s[32:35], s57 offen offset:2048 sc1 lds
    s_waitcnt vmcnt(0)
    s_barrier
    s_mov_b64 exec, 0x7f
    ds_write_b128 v6, v[24:27]
    s_mov_b64 exec, -1
    s_waitcnt lgkmcnt(0)
    s_barrier
    s_add_u32 m0, s66, 0
    s_add_u32 s57, s59, 450560
    buffer_load_dwordx4 v16, s[32:35], s57 offen offset:0 sc1 lds
    buffer_load_dwordx4 v16, s[32:35], s57 offen offset:1024 sc1 lds
    buffer_load_dwordx4 v16, s[32:35], s57 offen offset:2048 sc1 lds
    buffer_load_dwordx4 v16, s[32:35], s57 offen offset:3072 sc1 lds
    s_add_u32 m0, s66, 4096
    s_nop 0
    buffer_load_dwordx4 v20, s[32:35], s57 offen sc1 lds
    s_add_u32 m0, s66, 20480
    s_add_u32 s57, s59, 491520
    buffer_load_dwordx4 v16, s[32:35], s57 offen offset:0 sc1 lds
    buffer_load_dwordx4 v16, s[32:35], s57 offen offset:1024 sc1 lds
    buffer_load_dwordx4 v16, s[32:35], s57 offen offset:2048 sc1 lds
    buffer_load_dwordx4 v16, s[32:35], s57 offen offset:3072 sc1 lds
    s_add_u32 m0, s66, 24576
    s_nop 0
    buffer_load_dwordx4 v20, s[32:35], s57 offen sc1 lds
    s_add_u32 m0, s66, 40960
    s_add_u32 s57, s59, 532480
    buffer_load_dwordx4 v16, s[32:35], s57 offen offset:0 sc1 lds
    buffer_load_dwordx4 v16, s[32:35], s57 offen offset:1024 sc1 lds
    buffer_load_dwordx4 v16, s[32:35], s57 offen offset:2048 sc1 lds
    buffer_load_dwordx4 v16, s[32:35], s57 offen offset:3072 sc1 lds
    s_add_u32 m0, s66, 45056
    s_nop 0
    buffer_load_dwordx4 v20, s[32:35], s57 offen sc1 lds
    ds_write_b128 v7, v[216:219] offset:0
    ds_write_b128 v7, v[220:223] offset:1024
    ds_write_b128 v7, v[224:227] offset:2048
    ds_write_b128 v7, v[228:231] offset:3072
    ds_write_b128 v7, v[232:235] offset:4096
    ds_write_b128 v7, v[236:239] offset:20480
    ds_write_b128 v7, v[240:243] offset:21504
    ds_write_b128 v7, v[244:247] offset:22528
    ds_write_b128 v7, v[248:251] offset:23552
    ds_write_b128 v7, v[252:255] offset:24576
    s_waitcnt vmcnt(0) lgkmcnt(0)
    s_barrier
    s_mov_b32 s44, 0
    s_nop 1
L_pl_13:
    buffer_load_dword v2, v17, s[32:35], 0 offen sc1
    s_waitcnt vmcnt(0)
    v_cmp_ne_u32 vcc, s42, v2
    s_add_u32 s44, s44, 1
    s_cmp_gt_u32 s44, 1000000
    s_cbranch_scc1 L_pld_14
    s_cbranch_vccnz L_pl_13
L_pld_14:
    buffer_load_dwordx4 v[20:23], v12, s[32:35], s70 offen sc1
    buffer_load_dwordx4 v[24:27], v12, s[32:35], s71 offen sc1
    buffer_load_dwordx4 v[28:31], v12, s[32:35], s72 offen sc1
    s_barrier
    s_waitcnt vmcnt(2)
    v_mfma_f32_16x16x32_bf16 v[216:219], v[36:39], v[20:23], 0
    buffer_load_dwordx4 v[32:35], v12, s[32:35], s73 offen sc1
    v_mfma_f32_16x16x32_bf16 v[220:223], v[40:43], v[20:23], 0
    v_mfma_f32_16x16x32_bf16 v[224:227], v[44:47], v[20:23], 0
    v_mfma_f32_16x16x32_bf16 v[228:231], v[48:51], v[20:23], 0
    v_mfma_f32_16x16x32_bf16 v[232:235], v[52:55], v[20:23], 0
    s_waitcnt vmcnt(2)
    v_mfma_f32_16x16x32_bf16 v[216:219], v[56:59], v[24:27], v[216:219]
    buffer_load_dwordx4 v[20:23], v12, s[32:35], s74 offen sc1
    v_mfma_f32_16x16x32_bf16 v[220:223], v[60:63], v[24:27], v[220:223]
    v_mfma_f32_16x16x32_bf16 v[224:227], v[64:67], v[24:27], v[224:227]
    v_mfma_f32_16x16x32_bf16 v[228:231], v[68:71], v[24:27], v[228:231]
    v_mfma_f32_16x16x32_bf16 v[232:235], v[72:75], v[24:27], v[232:235]
    s_waitcnt vmcnt(2)
    v_mfma_f32_16x16x32_bf16 v[216:219], v[76:79], v[28:31], v[216:219]
    buffer_load_dwordx4 v[24:27], v12, s[32:35], s75 offen sc1
    v_mfma_f32_16x16x32_bf16 v[220:223], v[80:83], v[28:31], v[220:223]
    v_mfma_f32_16x16x32_bf16 v[224:227], v[84:87], v[28:31], v[224:227]
    v_mfma_f32_16x16x32_bf16 v[228:231], v[88:91], v[28:31], v[228:231]
    v_mfma_f32_16x16x32_bf16 v[232:235], v[92:95], v[28:31], v[232:235]
    s_waitcnt vmcnt(2)
    v_mfma_f32_16x16x32_bf16 v[216:219], v[96:99], v[32:35], v[216:219]
    buffer_load_dwordx4 v[28:31], v12, s[32:35], s76 offen sc1
    v_mfma_f32_16x16x32_bf16 v[220:223], v[100:103], v[32:35], v[220:223]
    v_mfma_f32_16x16x32_bf16 v[224:227], v[104:107], v[32:35], v[224:227]
    v_mfma_f32_16x16x32_bf16 v[228:231], v[108:111], v[32:35], v[228:231]
    v_mfma_f32_16x16x32_bf16 v[232:235], v[112:115], v[32:35], v[232:235]
    s_waitcnt vmcnt(2)
    v_mfma_f32_16x16x32_bf16 v[216:219], v[116:119], v[20:23], v[216:219]
    buffer_load_dwordx4 v[32:35], v12, s[32:35], s77 offen sc1
    v_mfma_f32_16x16x32_bf16 v[220:223], v[120:123], v[20:23], v[220:223]
    v_mfma_f32_16x16x32_bf16 v[224:227], v[124:127], v[20:23], v[224:227]
    v_mfma_f32_16x16x32_bf16 v[228:231], v[128:131], v[20:23], v[228:231]
    v_mfma_f32_16x16x32_bf16 v[232:235], v[132:135], v[20:23], v[232:235]
    s_waitcnt vmcnt(2)
    v_mfma_f32_16x16x32_bf16 v[216:219], v[136:139], v[24:27], v[216:219]
    buffer_load_dwordx4 v[20:23], v12, s[32:35], s78 offen sc1
    v_mfma_f32_16x16x32_bf16 v[220:223], v[140:143], v[24:27], v[220:223]
    v_mfma_f32_16x16x32_bf16 v[224:227], v[144:147], v[24:27], v[224:227]
    v_mfma_f32_16x16x32_bf16 v[228:231], v[148:151], v[24:27], v[228:231]
    v_mfma_f32_16x16x32_bf16 v[232:235], v[152:155], v[24:27], v[232:235]
    s_waitcnt vmcnt(2)
    v_mfma_f32_16x16x32_bf16 v[216:219], v[156:159], v[28:31], v[216:219]
    buffer_load_dwordx4 v[24:27], v13, s[32:35], s70 offen sc1
    v_mfma_f32_16x16x32_bf16 v[220:223], v[160:163], v[28:31], v[220:223]
    v_mfma_f32_16x16x32_bf16 v[224:227], v[164:167], v[28:31], v[224:227]
    v_mfma_f32_16x16x32_bf16 v[228:231], v[168:171], v[28:31], v[228:231]
    v_mfma_f32_16x16x32_bf16 v[232:235], v[172:175], v[28:31], v[232:235]
    s_waitcnt vmcnt(2)
    v_mfma_f32_16x16x32_bf16 v[216:219], v[176:179], v[32:35], v[216:219]
    buffer_load_dwordx4 v[28:31], v13, s[32:35], s71 offen sc1
    v_mfma_f32_16x16x32_bf16 v[220:223], v[180:183], v[32:35], v[220:223]
    v_mfma_f32_16x16x32_bf16 v[224:227], v[184:187], v[32:35], v[224:227]
    v_mfma_f32_16x16x32_bf16 v[228:231], v[188:191], v[32:35], v[228:231]
    v_mfma_f32_16x16x32_bf16 v[232:235], v[192:195], v[32:35], v[232:235]
    s_waitcnt vmcnt(2)
    v_mfma_f32_16x16x32_bf16 v[216:219], v[196:199], v[20:23], v[216:219]
    buffer_load_dwordx4 v[32:35], v13, s[32:35], s72 offen sc1
    v_mfma_f32_16x16x32_bf16 v[220:223], v[200:203], v[20:23], v[220:223]
    v_mfma_f32_16x16x32_bf16 v[224:227], v[204:207], v[20:23], v[224:227]
    v_mfma_f32_16x16x32_bf16 v[228:231], v[208:211], v[20:23], v[228:231]
    v_mfma_f32_16x16x32_bf16 v[232:235], v[212:215], v[20:23], v[232:235]
    s_waitcnt vmcnt(2)
    v_mfma_f32_16x16x32_bf16 v[236:239], v[36:39], v[24:27], 0
    buffer_load_dwordx4 v[20:23], v13, s[32:35], s73 offen sc1
    v_mfma_f32_16x16x32_bf16 v[240:243], v[40:43], v[24:27], 0
    v_mfma_f32_16x16x32_bf16 v[244:247], v[44:47], v[24:27], 0
    v_mfma_f32_16x16x32_bf16 v[248:251], v[48:51], v[24:27], 0
    ds_write_b128 v8, v[216:219] offset:0
    v_mfma_f32_16x16x32_bf16 v[252:255], v[52:55], v[24:27], 0
    ds_write_b128 v8, v[220:223] offset:1024
    s_waitcnt vmcnt(2)
    v_mfma_f32_16x16x32_bf16 v[236:239], v[56:59], v[28:31], v[236:239]
    buffer_load_dwordx4 v[24:27], v13, s[32:35], s74 offen sc1
    v_mfma_f32_16x16x32_bf16 v[240:243], v[60:63], v[28:31], v[240:243]
    ds_write_b128 v8, v[224:227] offset:2048
    v_mfma_f32_16x16x32_bf16 v[244:247], v[64:67], v[28:31], v[244:247]
    ds_write_b128 v8, v[228:231] offset:3072
    v_mfma_f32_16x16x32_bf16 v[248:251], v[68:71], v[28:31], v[248:251]
    ds_write_b128 v8, v[232:235] offset:4096
    v_mfma_f32_16x16x32_bf16 v[252:255], v[72:75], v[28:31], v[252:255]
    s_waitcnt vmcnt(2)
    v_mfma_f32_16x16x32_bf16 v[236:239], v[76:79], v[32:35], v[236:239]
    buffer_load_dwordx4 v[28:31], v13, s[32:35], s75 offen sc1
    v_mfma_f32_16x16x32_bf16 v[240:243], v[80:83], v[32:35], v[240:243]
    v_mfma_f32_16x16x32_bf16 v[244:247], v[84:87], v[32:35], v[244:247]
    v_mfma_f32_16x16x32_bf16 v[248:251], v[88:91], v[32:35], v[248:251]
    v_mfma_f32_16x16x32_bf16 v[252:255], v[92:95], v[32:35], v[252:255]
    s_waitcnt vmcnt(2)
    v_mfma_f32_16x16x32_bf16 v[236:239], v[96:99], v[20:23], v[236:239]
    buffer_load_dwordx4 v[32:35], v13, s[32:35], s76 offen sc1
    v_mfma_f32_16x16x32_bf16 v[240:243], v[100:103], v[20:23], v[240:243]
    v_mfma_f32_16x16x32_bf16 v[244:247], v[104:107], v[20:23], v[244:247]
    v_mfma_f32_16x16x32_bf16 v[248:251], v[108:111], v[20:23], v[248:251]
    v_mfma_f32_16x16x32_bf16 v[252:255], v[112:115], v[20:23], v[252:255]
    s_waitcnt vmcnt(2)
    v_mfma_f32_16x16x32_bf16 v[236:239], v[116:119], v[24:27], v[236:239]
    buffer_load_dwordx4 v[20:23], v13, s[32:35], s77 offen sc1
    v_mfma_f32_16x16x32_bf16 v[240:243], v[120:123], v[24:27], v[240:243]
    v_mfma_f32_16x16x32_bf16 v[244:247], v[124:127], v[24:27], v[244:247]
    v_mfma_f32_16x16x32_bf16 v[248:251], v[128:131], v[24:27], v[248:251]
    v_mfma_f32_16x16x32_bf16 v[252:255], v[132:135], v[24:27], v[252:255]
    s_waitcnt vmcnt(2)
    v_mfma_f32_16x16x32_bf16 v[236:239], v[136:139], v[28:31], v[236:239]
    buffer_load_dwordx4 v[24:27], v13, s[32:35], s78 offen sc1
    v_mfma_f32_16x16x32_bf16 v[240:243], v[140:143], v[28:31], v[240:243]
    v_mfma_f32_16x16x32_bf16 v[244:247], v[144:147], v[28:31], v[244:247]
    v_mfma_f32_16x16x32_bf16 v[248:251], v[148:151], v[28:31], v[248:251]
    v_mfma_f32_16x16x32_bf16 v[252:255], v[152:155], v[28:31], v[252:255]
    s_waitcnt vmcnt(2)
    v_mfma_f32_16x16x32_bf16 v[236:239], v[156:159], v[32:35], v[236:239]
    buffer_load_dwordx4 v[28:31], v14, s[32:35], s70 offen sc1
    v_mfma_f32_16x16x32_bf16 v[240:243], v[160:163], v[32:35], v[240:243]
    v_mfma_f32_16x16x32_bf16 v[244:247], v[164:167], v[32:35], v[244:247]
    v_mfma_f32_16x16x32_bf16 v[248:251], v[168:171], v[32:35], v[248:251]
    v_mfma_f32_16x16x32_bf16 v[252:255], v[172:175], v[32:35], v[252:255]
    s_waitcnt vmcnt(2)
    v_mfma_f32_16x16x32_bf16 v[236:239], v[176:179], v[20:23], v[236:239]
    buffer_load_dwordx4 v[32:35], v14, s[32:35], s71 offen sc1
    v_mfma_f32_16x16x32_bf16 v[240:243], v[180:183], v[20:23], v[240:243]
    v_mfma_f32_16x16x32_bf16 v[244:247], v[184:187], v[20:23], v[244:247]
    v_mfma_f32_16x16x32_bf16 v[248:251], v[188:191], v[20:23], v[248:251]
    v_mfma_f32_16x16x32_bf16 v[252:255], v[192:195], v[20:23], v[252:255]
    s_waitcnt vmcnt(2)
    v_mfma_f32_16x16x32_bf16 v[236:239], v[196:199], v[24:27], v[236:239]
    buffer_load_dwordx4 v[20:23], v14, s[32:35], s72 offen sc1
    v_mfma_f32_16x16x32_bf16 v[240:243], v[200:203], v[24:27], v[240:243]
    v_mfma_f32_16x16x32_bf16 v[244:247], v[204:207], v[24:27], v[244:247]
    v_mfma_f32_16x16x32_bf16 v[248:251], v[208:211], v[24:27], v[248:251]
    v_mfma_f32_16x16x32_bf16 v[252:255], v[212:215], v[24:27], v[252:255]
    s_waitcnt vmcnt(2)
    v_mfma_f32_16x16x32_bf16 v[216:219], v[36:39], v[28:31], 0
    buffer_load_dwordx4 v[24:27], v14, s[32:35], s73 offen sc1
    v_mfma_f32_16x16x32_bf16 v[220:223], v[40:43], v[28:31], 0
    v_mfma_f32_16x16x32_bf16 v[224:227], v[44:47], v[28:31], 0
    v_mfma_f32_16x16x32_bf16 v[228:231], v[48:51], v[28:31], 0
    ds_write_b128 v9, v[236:239] offset:0
    v_mfma_f32_16x16x32_bf16 v[232:235], v[52:55], v[28:31], 0
    ds_write_b128 v9, v[240:243] offset:1024
    s_waitcnt vmcnt(2)
    v_mfma_f32_16x16x32_bf16 v[216:219], v[56:59], v[32:35], v[216:219]
    buffer_load_dwordx4 v[28:31], v14, s[32:35], s74 offen sc1
    v_mfma_f32_16x16x32_bf16 v[220:223], v[60:63], v[32:35], v[220:223]
    ds_write_b128 v9, v[244:247] offset:2048
    v_mfma_f32_16x16x32_bf16 v[224:227], v[64:67], v[32:35], v[224:227]
    ds_write_b128 v9, v[248:251] offset:3072
    v_mfma_f32_16x16x32_bf16 v[228:231], v[68:71], v[32:35], v[228:231]
    ds_write_b128 v9, v[252:255] offset:4096
    v_mfma_f32_16x16x32_bf16 v[232:235], v[72:75], v[32:35], v[232:235]
    s_waitcnt lgkmcnt(0)
    s_barrier
    s_waitcnt vmcnt(2)
    v_mfma_f32_16x16x32_bf16 v[216:219], v[76:79], v[20:23], v[216:219]
    buffer_load_dwordx4 v[32:35], v14, s[32:35], s75 offen sc1
    v_mfma_f32_16x16x32_bf16 v[220:223], v[80:83], v[20:23], v[220:223]
    v_mfma_f32_16x16x32_bf16 v[224:227], v[84:87], v[20:23], v[224:227]
    v_mfma_f32_16x16x32_bf16 v[228:231], v[88:91], v[20:23], v[228:231]
    v_mfma_f32_16x16x32_bf16 v[232:235], v[92:95], v[20:23], v[232:235]
    s_waitcnt vmcnt(2)
    v_mfma_f32_16x16x32_bf16 v[216:219], v[96:99], v[24:27], v[216:219]
    buffer_load_dwordx4 v[20:23], v14, s[32:35], s76 offen sc1
    v_mfma_f32_16x16x32_bf16 v[220:223], v[100:103], v[24:27], v[220:223]
    v_mfma_f32_16x16x32_bf16 v[224:227], v[104:107], v[24:27], v[224:227]
    v_mfma_f32_16x16x32_bf16 v[228:231], v[108:111], v[24:27], v[228:231]
    v_mfma_f32_16x16x32_bf16 v[232:235], v[112:115], v[24:27], v[232:235]
    s_waitcnt vmcnt(2)
    v_mfma_f32_16x16x32_bf16 v[216:219], v[116:119], v[28:31], v[216:219]
    buffer_load_dwordx4 v[24:27], v14, s[32:35], s77 offen sc1
    v_mfma_f32_16x16x32_bf16 v[220:223], v[120:123], v[28:31], v[220:223]
    v_mfma_f32_16x16x32_bf16 v[224:227], v[124:127], v[28:31], v[224:227]
    v_mfma_f32_16x16x32_bf16 v[228:231], v[128:131], v[28:31], v[228:231]
    v_mfma_f32_16x16x32_bf16 v[232:235], v[132:135], v[28:31], v[232:235]
    s_waitcnt vmcnt(2)
    v_mfma_f32_16x16x32_bf16 v[216:219], v[136:139], v[32:35], v[216:219]
    buffer_load_dwordx4 v[28:31], v14, s[32:35], s78 offen sc1
    v_mfma_f32_16x16x32_bf16 v[220:223], v[140:143], v[32:35], v[220:223]
    v_mfma_f32_16x16x32_bf16 v[224:227], v[144:147], v[32:35], v[224:227]
    v_mfma_f32_16x16x32_bf16 v[228:231], v[148:151], v[32:35], v[228:231]
    v_mfma_f32_16x16x32_bf16 v[232:235], v[152:155], v[32:35], v[232:235]
    s_waitcnt vmcnt(2)
    v_mfma_f32_16x16x32_bf16 v[216:219], v[156:159], v[20:23], v[216:219]
    buffer_load_dwordx4 v[32:35], v15, s[32:35], s70 offen sc1
    v_mfma_f32_16x16x32_bf16 v[220:223], v[160:163], v[20:23], v[220:223]
    v_mfma_f32_16x16x32_bf16 v[224:227], v[164:167], v[20:23], v[224:227]
    v_mfma_f32_16x16x32_bf16 v[228:231], v[168:171], v[20:23], v[228:231]
    v_mfma_f32_16x16x32_bf16 v[232:235], v[172:175], v[20:23], v[232:235]
    s_waitcnt vmcnt(2)
    v_mfma_f32_16x16x32_bf16 v[216:219], v[176:179], v[24:27], v[216:219]
    buffer_load_dwordx4 v[20:23], v15, s[32:35], s71 offen sc1
    v_mfma_f32_16x16x32_bf16 v[220:223], v[180:183], v[24:27], v[220:223]
    v_mfma_f32_16x16x32_bf16 v[224:227], v[184:187], v[24:27], v[224:227]
    v_mfma_f32_16x16x32_bf16 v[228:231], v[188:191], v[24:27], v[228:231]
    v_mfma_f32_16x16x32_bf16 v[232:235], v[192:195], v[24:27], v[232:235]
    s_waitcnt vmcnt(2)
    v_mfma_f32_16x16x32_bf16 v[216:219], v[196:199], v[28:31], v[216:219]
    buffer_load_dwordx4 v[24:27], v15, s[32:35], s72 offen sc1
    v_mfma_f32_16x16x32_bf16 v[220:223], v[200:203], v[28:31], v[220:223]
    v_mfma_f32_16x16x32_bf16 v[224:227], v[204:207], v[28:31], v[224:227]
    v_mfma_f32_16x16x32_bf16 v[228:231], v[208:211], v[28:31], v[228:231]
    v_mfma_f32_16x16x32_bf16 v[232:235], v[212:215], v[28:31], v[232:235]
    s_waitcnt vmcnt(2)
    v_mfma_f32_16x16x32_bf16 v[236:239], v[36:39], v[32:35], 0
    buffer_load_dwordx4 v[28:31], v15, s[32:35], s73 offen sc1
    v_mfma_f32_16x16x32_bf16 v[240:243], v[40:43], v[32:35], 0
    v_mfma_f32_16x16x32_bf16 v[244:247], v[44:47], v[32:35], 0
    v_mfma_f32_16x16x32_bf16 v[248:251], v[48:51], v[32:35], 0
    ds_write_b128 v10, v[216:219] offset:0
    v_mfma_f32_16x16x32_bf16 v[252:255], v[52:55], v[32:35], 0
    ds_write_b128 v10, v[220:223] offset:1024
    s_waitcnt vmcnt(2)
    v_mfma_f32_16x16x32_bf16 v[236:239], v[56:59], v[20:23], v[236:239]
    buffer_load_dwordx4 v[32:35], v15, s[32:35], s74 offen sc1
    v_mfma_f32_16x16x32_bf16 v[240:243], v[60:63], v[20:23], v[240:243]
    ds_write_b128 v10, v[224:227] offset:2048
    v_mfma_f32_16x16x32_bf16 v[244:247], v[64:67], v[20:23], v[244:247]
    ds_write_b128 v10, v[228:231] offset:3072
    v_mfma_f32_16x16x32_bf16 v[248:251], v[68:71], v[20:23], v[248:251]
    ds_write_b128 v10, v[232:235] offset:4096
    v_mfma_f32_16x16x32_bf16 v[252:255], v[72:75], v[20:23], v[252:255]
    s_waitcnt lgkmcnt(0)
    s_barrier
    s_waitcnt vmcnt(2)
    v_mfma_f32_16x16x32_bf16 v[236:239], v[76:79], v[24:27], v[236:239]
    buffer_load_dwordx4 v[20:23], v15, s[32:35], s75 offen sc1
    v_mfma_f32_16x16x32_bf16 v[240:243], v[80:83], v[24:27], v[240:243]
    v_mfma_f32_16x16x32_bf16 v[244:247], v[84:87], v[24:27], v[244:247]
    v_mfma_f32_16x16x32_bf16 v[248:251], v[88:91], v[24:27], v[248:251]
    v_mfma_f32_16x16x32_bf16 v[252:255], v[92:95], v[24:27], v[252:255]
    s_waitcnt vmcnt(2)
    v_mfma_f32_16x16x32_bf16 v[236:239], v[96:99], v[28:31], v[236:239]
    buffer_load_dwordx4 v[24:27], v15, s[32:35], s76 offen sc1
    v_mfma_f32_16x16x32_bf16 v[240:243], v[100:103], v[28:31], v[240:243]
    v_mfma_f32_16x16x32_bf16 v[244:247], v[104:107], v[28:31], v[244:247]
    v_mfma_f32_16x16x32_bf16 v[248:251], v[108:111], v[28:31], v[248:251]
    v_mfma_f32_16x16x32_bf16 v[252:255], v[112:115], v[28:31], v[252:255]
    s_waitcnt vmcnt(2)
    v_mfma_f32_16x16x32_bf16 v[236:239], v[116:119], v[32:35], v[236:239]
    buffer_load_dwordx4 v[28:31], v15, s[32:35], s77 offen sc1
    v_mfma_f32_16x16x32_bf16 v[240:243], v[120:123], v[32:35], v[240:243]
    v_mfma_f32_16x16x32_bf16 v[244:247], v[124:127], v[32:35], v[244:247]
    v_mfma_f32_16x16x32_bf16 v[248:251], v[128:131], v[32:35], v[248:251]
    v_mfma_f32_16x16x32_bf16 v[252:255], v[132:135], v[32:35], v[252:255]
    s_waitcnt vmcnt(2)
    v_mfma_f32_16x16x32_bf16 v[236:239], v[136:139], v[20:23], v[236:239]
    buffer_load_dwordx4 v[32:35], v15, s[32:35], s78 offen sc1
    v_mfma_f32_16x16x32_bf16 v[240:243], v[140:143], v[20:23], v[240:243]
    v_mfma_f32_16x16x32_bf16 v[244:247], v[144:147], v[20:23], v[244:247]
    v_mfma_f32_16x16x32_bf16 v[248:251], v[148:151], v[20:23], v[248:251]
    v_mfma_f32_16x16x32_bf16 v[252:255], v[152:155], v[20:23], v[252:255]
    s_waitcnt vmcnt(2)
    v_mfma_f32_16x16x32_bf16 v[236:239], v[156:159], v[24:27], v[236:239]
    v_mfma_f32_16x16x32_bf16 v[240:243], v[160:163], v[24:27], v[240:243]
    v_mfma_f32_16x16x32_bf16 v[244:247], v[164:167], v[24:27], v[244:247]
    v_mfma_f32_16x16x32_bf16 v[248:251], v[168:171], v[24:27], v[248:251]
    v_mfma_f32_16x16x32_bf16 v[252:255], v[172:175], v[24:27], v[252:255]
    s_waitcnt vmcnt(1)
    v_mfma_f32_16x16x32_bf16 v[236:239], v[176:179], v[28:31], v[236:239]
    v_mfma_f32_16x16x32_bf16 v[240:243], v[180:183], v[28:31], v[240:243]
    v_mfma_f32_16x16x32_bf16 v[244:247], v[184:187], v[28:31], v[244:247]
    v_mfma_f32_16x16x32_bf16 v[248:251], v[188:191], v[28:31], v[248:251]
    v_mfma_f32_16x16x32_bf16 v[252:255], v[192:195], v[28:31], v[252:255]
    s_waitcnt vmcnt(0)
    v_mfma_f32_16x16x32_bf16 v[236:239], v[196:199], v[32:35], v[236:239]
    v_mfma_f32_16x16x32_bf16 v[240:243], v[200:203], v[32:35], v[240:243]
    v_mfma_f32_16x16x32_bf16 v[244:247], v[204:207], v[32:35], v[244:247]
    v_mfma_f32_16x16x32_bf16 v[248:251], v[208:211], v[32:35], v[248:251]
    v_mfma_f32_16x16x32_bf16 v[252:255], v[212:215], v[32:35], v[252:255]
    s_nop 3
    ds_write_b128 v11, v[236:239] offset:0
    ds_write_b128 v11, v[240:243] offset:1024
    ds_write_b128 v11, v[244:247] offset:2048
    ds_write_b128 v11, v[248:251] offset:3072
    ds_write_b128 v11, v[252:255] offset:4096
    s_waitcnt lgkmcnt(0)
    s_barrier
    s_endpgm
.p2align 12
L_compute:
    s_nop 0
    s_lshl_b32 s66, s40, 5
    s_add_u32 s66, s66, s41
    s_lshl_b32 s66, s66, 2
    s_add_u32 s66, s66, s3
    s_lshl_b32 s66, s66, 1
    v_lshrrev_b32 v2, 5, v1
    v_add_u32 v12, s66, v2
    v_mul_u32_u24 v6, 1280, v12
    v_and_b32 v2, 31, v1
    v_lshl_add_u32 v6, v2, 4, v6
    v_bfe_u32 v2, v1, 4, 1
    v_lshl_add_u32 v7, v2, 30, v6
    v_lshlrev_b32 v12, 4, v12
    s_waitcnt lgkmcnt(0)
    s_mov_b64 s[8:9], s[48:49]
    s_mov_b64 s[12:13], s[50:51]
    s_mov_b64 s[16:17], s[52:53]
    s_mov_b64 s[20:21], s[56:57]
    s_mov_b64 s[24:25], s[58:59]
    s_mov_b64 s[28:29], s[60:61]
    s_mov_b64 s[36:37], s[62:63]
    s_mov_b64 s[32:33], s[64:65]
    s_mov_b64 s[92:93], s[4:5]
    s_or_b32 s44, s2, s3
    s_cmp_lg_u32 s44, 0
    s_cbranch_scc1 L_nn_15
    s_memrealtime s[68:69]
    s_waitcnt lgkmcnt(0)
    s_or_b32 s44, s68, 1
    v_mov_b32 v2, s44
    v_mov_b32 v3, 0
    s_mov_b64 exec, 1
    buffer_store_dword v2, v3, s[36:39], 0 offen sc1
    s_mov_b64 exec, -1
L_nn_15:
    s_cmp_ge_u32 s41, 30
    s_cbranch_scc1 L_c_idle
    s_cmp_ge_u32 s41, 20
    s_cbranch_scc1 L_c_typew
    v_and_b32 v2, 31, v1
    v_lshrrev_b32 v3, 5, v1
    v_bfe_u32 v4, v1, 1, 3
    v_xor_b32 v4, v4, v3
    v_lshlrev_b32 v4, 4, v4
    v_lshl_add_u32 v28, v2, 7, v4
    v_lshlrev_b32 v36, 4, v2
    v_lshl_add_u32 v34, v3, 10, v36
    v_lshlrev_b32 v35, 2, v2
    v_lshl_add_u32 v35, v3, 13, v35
    v_bfe_u32 v4, v1, 2, 2
    v_lshl_add_u32 v5, v3, 3, v4
    v_lshlrev_b32 v5, 7, v5
    v_lshrrev_b32 v4, 1, v4
    v_lshl_add_u32 v5, v4, 6, v5
    v_bfe_u32 v4, v1, 4, 1
    v_lshl_add_u32 v5, v4, 5, v5
    v_and_b32 v37, 3, v1
    v_lshl_add_u32 v32, v37, 3, v5
    v_and_b32 v37, 15, v1
    v_lshlrev_b32 v4, 2, v4
    v_cmp_eq_u32 vcc, v37, v4
    v_mov_b32 v37, 0x3f803f80
    s_nop 0
    v_cndmask_b32 v16, 0, v37, vcc
    v_cndmask_b32 v17, 0, v37, vcc
    v_cndmask_b32 v18, 0, v37, vcc
    v_cndmask_b32 v19, 0, v37, vcc
    s_lshr_b32 s75, s3, 1
    s_and_b32 s76, s3, 1
    s_lshl_b32 s66, s3, 12
    v_add_u32 v28, s66, v28
    s_add_u32 s74, s70, s75
    s_lshl_b32 s80, s74, 10
    s_lshl_b32 s66, s76, 9
    s_add_u32 s80, s80, s66
    s_add_u32 s80, s80, 22327296
    s_lshl_b32 s77, s74, 1
    s_add_u32 s77, s77, s76
    s_lshl_b32 s67, s74, 5
    s_add_u32 s67, s67, s72
    s_lshl_b32 s67, s67, 13
    s_add_u32 s78, s67, s66
    s_add_u32 s84, s78, 4096
    s_lshl_b32 s67, s72, 7
    s_add_u32 s67, s67, s77
    s_lshl_b32 s67, s67, 7
    s_add_u32 s82, s67, 20840448
    s_lshl_b32 s67, s74, 5
    s_add_u32 s67, s67, s73
    s_lshl_b32 s67, s67, 13
    s_add_u32 s79, s67, s66
    s_add_u32 s85, s79, 4096
    s_lshl_b32 s67, s73, 7
    s_add_u32 s67, s67, s77
    s_lshl_b32 s67, s67, 7
    s_add_u32 s83, s67, 20840448
    v_lshrrev_b32 v37, 1, v36
    s_lshl_b32 s81, s73, 9
    s_add_u32 s81, s81, 22360064
    v_xor_b32 v29, 32, v28
    v_xor_b32 v30, 64, v28
    v_xor_b32 v31, 96, v28
    v_xor_b32 v33, 64, v32
    s_setprio 1
    s_barrier
    ds_read_b128 v[96:99], v28 offset:0
    ds_read_b64_tr_b16 v[40:41], v32 offset:16384
    ds_read_b64_tr_b16 v[42:43], v32 offset:16896
    ds_read_b64_tr_b16 v[44:45], v33 offset:16384
    ds_read_b64_tr_b16 v[46:47], v33 offset:16896
    ds_read_b128 v[100:103], v29 offset:0
    ds_read_b64_tr_b16 v[48:49], v32 offset:18432
    ds_read_b64_tr_b16 v[50:51], v32 offset:18944
    ds_read_b64_tr_b16 v[52:53], v33 offset:18432
    ds_read_b64_tr_b16 v[54:55], v33 offset:18944
    s_waitcnt lgkmcnt(5)
    v_mfma_f32_16x16x32_bf16 v[20:23], v[16:19], v[40:43], 0
    v_mfma_f32_16x16x32_bf16 v[24:27], v[16:19], v[44:47], 0
    v_mfma_f32_32x32x16_bf16 v[64:79], v[40:43], v[96:99], 0
    ds_read_b128 v[104:107], v30 offset:0
    ds_read_b64_tr_b16 v[56:57], v32 offset:20480
    ds_read_b64_tr_b16 v[58:59], v32 offset:20992
    ds_read_b64_tr_b16 v[60:61], v33 offset:20480
    ds_read_b64_tr_b16 v[62:63], v33 offset:20992
    v_mfma_f32_32x32x16_bf16 v[80:95], v[44:47], v[96:99], 0
    buffer_load_dwordx4 v[244:247], v6, s[8:11], 0 offen offset:0
    buffer_load_dwordx4 v[248:251], v6, s[8:11], 0 offen offset:512
    buffer_load_dwordx4 v[252:255], v7, s[8:11], 0 offen offset:1024
    v_mov_b32 v6, 0
    s_waitcnt lgkmcnt(5)
    v_mfma_f32_16x16x32_bf16 v[20:23], v[16:19], v[48:51], v[20:23]
    v_mfma_f32_16x16x32_bf16 v[24:27], v[16:19], v[52:55], v[24:27]
    v_mfma_f32_32x32x16_bf16 v[64:79], v[48:51], v[100:103], v[64:79]
    ds_read_b128 v[108:111], v31 offset:0
    ds_read_b64_tr_b16 v[40:41], v32 offset:22528
    ds_read_b64_tr_b16 v[42:43], v32 offset:23040
    ds_read_b64_tr_b16 v[44:45], v33 offset:22528
    ds_read_b64_tr_b16 v[46:47], v33 offset:23040
    v_mfma_f32_32x32x16_bf16 v[80:95], v[52:55], v[100:103], v[80:95]
    s_waitcnt lgkmcnt(5)
    v_mfma_f32_16x16x32_bf16 v[20:23], v[16:19], v[56:59], v[20:23]
    v_mfma_f32_16x16x32_bf16 v[24:27], v[16:19], v[60:63], v[24:27]
    v_mfma_f32_32x32x16_bf16 v[64:79], v[56:59], v[104:107], v[64:79]
    s_barrier
    ds_read_b128 v[112:115], v28 offset:24576
    ds_read_b64_tr_b16 v[48:49], v32 offset:40960
    ds_read_b64_tr_b16 v[50:51], v32 offset:41472
    ds_read_b64_tr_b16 v[52:53], v33 offset:40960
    ds_read_b64_tr_b16 v[54:55], v33 offset:41472
    v_mfma_f32_32x32x16_bf16 v[80:95], v[60:63], v[104:107], v[80:95]
    s_waitcnt lgkmcnt(5)
    v_mfma_f32_16x16x32_bf16 v[20:23], v[16:19], v[40:43], v[20:23]
    v_mfma_f32_16x16x32_bf16 v[24:27], v[16:19], v[44:47], v[24:27]
    v_mfma_f32_32x32x16_bf16 v[64:79], v[40:43], v[108:111], v[64:79]
    ds_read_b128 v[116:119], v29 offset:24576
    ds_read_b64_tr_b16 v[56:57], v32 offset:43008
    ds_read_b64_tr_b16 v[58:59], v32 offset:43520
    ds_read_b64_tr_b16 v[60:61], v33 offset:43008
    ds_read_b64_tr_b16 v[62:63], v33 offset:43520
    v_mfma_f32_32x32x16_bf16 v[80:95], v[44:47], v[108:111], v[80:95]
    buffer_load_dword v7, v6, s[36:39], 0 offen sc1
    s_waitcnt lgkmcnt(5)
    v_mfma_f32_16x16x32_bf16 v[20:23], v[16:19], v[48:51], v[20:23]
    v_mfma_f32_16x16x32_bf16 v[24:27], v[16:19], v[52:55], v[24:27]
    v_mfma_f32_32x32x16_bf16 v[64:79], v[48:51], v[112:115], v[64:79]
    ds_read_b128 v[120:123], v30 offset:24576
    ds_read_b64_tr_b16 v[40:41], v32 offset:45056
    ds_read_b64_tr_b16 v[42:43], v32 offset:45568
    ds_read_b64_tr_b16 v[44:45], v33 offset:45056
    ds_read_b64_tr_b16 v[46:47], v33 offset:45568
    v_mfma_f32_32x32x16_bf16 v[80:95], v[52:55], v[112:115], v[80:95]
    s_waitcnt lgkmcnt(5)
    v_mfma_f32_16x16x32_bf16 v[20:23], v[16:19], v[56:59], v[20:23]
    v_mfma_f32_16x16x32_bf16 v[24:27], v[16:19], v[60:63], v[24:27]
    v_mfma_f32_32x32x16_bf16 v[64:79], v[56:59], v[116:119], v[64:79]
    ds_read_b128 v[124:127], v31 offset:24576
    ds_read_b64_tr_b16 v[48:49], v32 offset:47104
    ds_read_b64_tr_b16 v[50:51], v32 offset:47616
    ds_read_b64_tr_b16 v[52:53], v33 offset:47104
    ds_read_b64_tr_b16 v[54:55], v33 offset:47616
    v_mfma_f32_32x32x16_bf16 v[80:95], v[60:63], v[116:119], v[80:95]
    s_waitcnt lgkmcnt(5)
    v_mfma_f32_16x16x32_bf16 v[20:23], v[16:19], v[40:43], v[20:23]
    v_mfma_f32_16x16x32_bf16 v[24:27], v[16:19], v[44:47], v[24:27]
    v_mfma_f32_32x32x16_bf16 v[64:79], v[40:43], v[120:123], v[64:79]
    s_barrier
    ds_read_b128 v[128:131], v28 offset:49152
    v_add_u32 v32, 57344, v32
    v_add_u32 v33, 57344, v33
    ds_read_b64_tr_b16 v[56:57], v32 offset:8192
    ds_read_b64_tr_b16 v[58:59], v32 offset:8704
    ds_read_b64_tr_b16 v[60:61], v33 offset:8192
    ds_read_b64_tr_b16 v[62:63], v33 offset:8704
    v_mfma_f32_32x32x16_bf16 v[80:95], v[44:47], v[120:123], v[80:95]
    s_waitcnt lgkmcnt(5)
    v_mfma_f32_16x16x32_bf16 v[20:23], v[16:19], v[48:51], v[20:23]
    v_mfma_f32_16x16x32_bf16 v[24:27], v[16:19], v[52:55], v[24:27]
    v_mfma_f32_32x32x16_bf16 v[64:79], v[48:51], v[124:127], v[64:79]
    ds_read_b128 v[132:135], v29 offset:49152
    ds_read_b64_tr_b16 v[40:41], v32 offset:10240
    ds_read_b64_tr_b16 v[42:43], v32 offset:10752
    ds_read_b64_tr_b16 v[44:45], v33 offset:10240
    ds_read_b64_tr_b16 v[46:47], v33 offset:10752
    v_mfma_f32_32x32x16_bf16 v[80:95], v[52:55], v[124:127], v[80:95]
    s_waitcnt lgkmcnt(5)
    v_mfma_f32_16x16x32_bf16 v[20:23], v[16:19], v[56:59], v[20:23]
    v_mfma_f32_16x16x32_bf16 v[24:27], v[16:19], v[60:63], v[24:27]
    v_mfma_f32_32x32x16_bf16 v[64:79], v[56:59], v[128:131], v[64:79]
    ds_read_b128 v[136:139], v30 offset:49152
    ds_read_b64_tr_b16 v[48:49], v32 offset:12288
    ds_read_b64_tr_b16 v[50:51], v32 offset:12800
    ds_read_b64_tr_b16 v[52:53], v33 offset:12288
    ds_read_b64_tr_b16 v[54:55], v33 offset:12800
    v_mfma_f32_32x32x16_bf16 v[80:95], v[60:63], v[128:131], v[80:95]
    s_waitcnt lgkmcnt(5)
    v_mfma_f32_16x16x32_bf16 v[20:23], v[16:19], v[40:43], v[20:23]
    v_mfma_f32_16x16x32_bf16 v[24:27], v[16:19], v[44:47], v[24:27]
    v_mfma_f32_32x32x16_bf16 v[64:79], v[40:43], v[132:135], v[64:79]
    ds_read_b128 v[140:143], v31 offset:49152
    ds_read_b64_tr_b16 v[56:57], v32 offset:14336
    ds_read_b64_tr_b16 v[58:59], v32 offset:14848
    ds_read_b64_tr_b16 v[60:61], v33 offset:14336
    ds_read_b64_tr_b16 v[62:63], v33 offset:14848
    v_mfma_f32_32x32x16_bf16 v[80:95], v[44:47], v[132:135], v[80:95]
    s_waitcnt lgkmcnt(5)
    v_mfma_f32_16x16x32_bf16 v[20:23], v[16:19], v[48:51], v[20:23]
    v_mfma_f32_16x16x32_bf16 v[24:27], v[16:19], v[52:55], v[24:27]
    v_mfma_f32_32x32x16_bf16 v[64:79], v[48:51], v[136:139], v[64:79]
    v_mov_b32 v4, 0x3f803f80
    s_waitcnt vmcnt(3)
    v_dot2_f32_bf16 v2, v244, v4, 0
    v_dot2_f32_bf16 v3, v244, v244, 0
    v_dot2_f32_bf16 v2, v245, v4, v2
    v_dot2_f32_bf16 v3, v245, v245, v3
    v_dot2_f32_bf16 v2, v246, v4, v2
    v_dot2_f32_bf16 v3, v246, v246, v3
    v_dot2_f32_bf16 v2, v247, v4, v2
    v_dot2_f32_bf16 v3, v247, v247, v3
    s_waitcnt vmcnt(2)
    v_dot2_f32_bf16 v2, v248, v4, v2
    v_dot2_f32_bf16 v3, v248, v248, v3
    v_dot2_f32_bf16 v2, v249, v4, v2
    v_dot2_f32_bf16 v3, v249, v249, v3
    v_dot2_f32_bf16 v2, v250, v4, v2
    v_dot2_f32_bf16 v3, v250, v250, v3
    v_dot2_f32_bf16 v2, v251, v4, v2
    v_dot2_f32_bf16 v3, v251, v251, v3
    s_waitcnt vmcnt(1)
    v_dot2_f32_bf16 v2, v252, v4, v2
    v_dot2_f32_bf16 v3, v252, v252, v3
    v_dot2_f32_bf16 v2, v253, v4, v2
    v_dot2_f32_bf16 v3, v253, v253, v3
    v_dot2_f32_bf16 v2, v254, v4, v2
    v_dot2_f32_bf16 v3, v254, v254, v3
    v_dot2_f32_bf16 v2, v255, v4, v2
    v_dot2_f32_bf16 v3, v255, v255, v3
    s_nop 1
    v_add_f32_dpp v2, v2, v2 row_ror:8 row_mask:0xf bank_mask:0xf
    v_add_f32_dpp v3, v3, v3 row_ror:8 row_mask:0xf bank_mask:0xf
    s_nop 0
    v_add_f32_dpp v2, v2, v2 row_ror:4 row_mask:0xf bank_mask:0xf
    v_add_f32_dpp v3, v3, v3 row_ror:4 row_mask:0xf bank_mask:0xf
    s_nop 0
    v_add_f32_dpp v2, v2, v2 row_ror:2 row_mask:0xf bank_mask:0xf
    v_add_f32_dpp v3, v3, v3 row_ror:2 row_mask:0xf bank_mask:0xf
    s_nop 0
    v_add_f32_dpp v2, v2, v2 row_ror:1 row_mask:0xf bank_mask:0xf
    v_add_f32_dpp v3, v3, v3 row_ror:1 row_mask:0xf bank_mask:0xf
    v_mov_b32 v4, v2
    v_mov_b32 v5, v3
    s_nop 0
    v_permlane16_swap_b32 v2, v4
    v_permlane16_swap_b32 v3, v5
    v_add_f32 v2, v2, v4
    v_add_f32 v3, v3, v5
    v_mul_f32 v9, 0x3acccccd, v2
    v_mul_f32 v4, 0x3acccccd, v3
    v_fma_f32 v4, -v9, v9, v4
    v_max_f32 v4, 0, v4
    v_cvt_pk_bf16_f32 v4, v4, v4
    v_and_b32 v4, 0xffff0000, v4
    v_add_f32 v4, 0x3727c5ac, v4
    v_cvt_pk_bf16_f32 v4, v4, v4
    v_and_b32 v4, 0xffff0000, v4
    v_sqrt_f32 v4, v4
    s_nop 0
    v_cvt_pk_bf16_f32 v4, v4, v4
    v_and_b32 v4, 0xffff0000, v4
    v_rcp_f32 v8, v4
    v_cvt_pk_bf16_f32 v9, v9, v9
    v_and_b32 v9, 0xffff0000, v9
    s_barrier
    v_add_u32 v28, 57344, v28
    v_add_u32 v29, 57344, v29
    v_add_u32 v30, 57344, v30
    v_add_u32 v31, 57344, v31
    ds_read_b128 v[144:147], v28 offset:16384
    ds_read_b64_tr_b16 v[40:41], v32 offset:32768
    ds_read_b64_tr_b16 v[42:43], v32 offset:33280
    ds_read_b64_tr_b16 v[44:45], v33 offset:32768
    ds_read_b64_tr_b16 v[46:47], v33 offset:33280
    v_mfma_f32_32x32x16_bf16 v[80:95], v[52:55], v[136:139], v[80:95]
    s_waitcnt lgkmcnt(5)
    v_mfma_f32_16x16x32_bf16 v[20:23], v[16:19], v[56:59], v[20:23]
    v_mfma_f32_16x16x32_bf16 v[24:27], v[16:19], v[60:63], v[24:27]
    v_mfma_f32_32x32x16_bf16 v[64:79], v[56:59], v[140:143], v[64:79]
    ds_read_b128 v[148:151], v29 offset:16384
    ds_read_b64_tr_b16 v[48:49], v32 offset:34816
    ds_read_b64_tr_b16 v[50:51], v32 offset:35328
    ds_read_b64_tr_b16 v[52:53], v33 offset:34816
    ds_read_b64_tr_b16 v[54:55], v33 offset:35328
    v_mfma_f32_32x32x16_bf16 v[80:95], v[60:63], v[140:143], v[80:95]
    s_waitcnt vmcnt(0)
    v_readfirstlane_b32 s42, v7
    s_nop 0
    s_cmp_eq_u32 s42, 0
    s_cbranch_scc1 L_nz_16
L_nzb_17:
    s_mov_b32 s46, 22327296
    v_mov_b32 v10, s42
    v_mov_b32 v11, s42
    s_mov_b32 exec_lo, 1
    s_mov_b32 exec_hi, 1
    buffer_store_dwordx4 v[8:11], v12, s[32:35], s46 offen sc1
    s_mov_b64 exec, -1
    s_waitcnt lgkmcnt(5)
    v_mfma_f32_16x16x32_bf16 v[20:23], v[16:19], v[40:43], v[20:23]
    v_mfma_f32_16x16x32_bf16 v[24:27], v[16:19], v[44:47], v[24:27]
    v_mfma_f32_32x32x16_bf16 v[64:79], v[40:43], v[144:147], v[64:79]
    ds_read_b128 v[152:155], v30 offset:16384
    ds_read_b64_tr_b16 v[56:57], v32 offset:36864
    ds_read_b64_tr_b16 v[58:59], v32 offset:37376
    ds_read_b64_tr_b16 v[60:61], v33 offset:36864
    ds_read_b64_tr_b16 v[62:63], v33 offset:37376
    v_mfma_f32_32x32x16_bf16 v[80:95], v[44:47], v[144:147], v[80:95]
    s_waitcnt lgkmcnt(5)
    v_mfma_f32_16x16x32_bf16 v[20:23], v[16:19], v[48:51], v[20:23]
    v_mfma_f32_16x16x32_bf16 v[24:27], v[16:19], v[52:55], v[24:27]
    v_mfma_f32_32x32x16_bf16 v[64:79], v[48:51], v[148:151], v[64:79]
    ds_read_b128 v[156:159], v31 offset:16384
    ds_read_b64_tr_b16 v[40:41], v32 offset:38912
    ds_read_b64_tr_b16 v[42:43], v32 offset:39424
    ds_read_b64_tr_b16 v[44:45], v33 offset:38912
    ds_read_b64_tr_b16 v[46:47], v33 offset:39424
    v_mfma_f32_32x32x16_bf16 v[80:95], v[52:55], v[148:151], v[80:95]
    s_waitcnt lgkmcnt(5)
    v_mfma_f32_16x16x32_bf16 v[20:23], v[16:19], v[56:59], v[20:23]
    v_mfma_f32_16x16x32_bf16 v[24:27], v[16:19], v[60:63], v[24:27]
    v_mfma_f32_32x32x16_bf16 v[64:79], v[56:59], v[152:155], v[64:79]
    s_barrier
    ds_read_b128 v[160:163], v28 offset:40960
    ds_read_b64_tr_b16 v[48:49], v32 offset:57344
    ds_read_b64_tr_b16 v[50:51], v32 offset:57856
    ds_read_b64_tr_b16 v[52:53], v33 offset:57344
    ds_read_b64_tr_b16 v[54:55], v33 offset:57856
    v_mfma_f32_32x32x16_bf16 v[80:95], v[60:63], v[152:155], v[80:95]
    s_waitcnt lgkmcnt(5)
    v_mfma_f32_16x16x32_bf16 v[20:23], v[16:19], v[40:43], v[20:23]
    v_mfma_f32_16x16x32_bf16 v[24:27], v[16:19], v[44:47], v[24:27]
    v_mfma_f32_32x32x16_bf16 v[64:79], v[40:43], v[156:159], v[64:79]
    ds_read_b128 v[164:167], v29 offset:40960
    ds_read_b64_tr_b16 v[56:57], v32 offset:59392
    ds_read_b64_tr_b16 v[58:59], v32 offset:59904
    ds_read_b64_tr_b16 v[60:61], v33 offset:59392
    ds_read_b64_tr_b16 v[62:63], v33 offset:59904
    v_mfma_f32_32x32x16_bf16 v[80:95], v[44:47], v[156:159], v[80:95]
    s_waitcnt lgkmcnt(5)
    v_mfma_f32_16x16x32_bf16 v[20:23], v[16:19], v[48:51], v[20:23]
    v_mfma_f32_16x16x32_bf16 v[24:27], v[16:19], v[52:55], v[24:27]
    v_mfma_f32_32x32x16_bf16 v[64:79], v[48:51], v[160:163], v[64:79]
    ds_read_b128 v[168:171], v30 offset:40960
    ds_read_b64_tr_b16 v[40:41], v32 offset:61440
    ds_read_b64_tr_b16 v[42:43], v32 offset:61952
    ds_read_b64_tr_b16 v[44:45], v33 offset:61440
    ds_read_b64_tr_b16 v[46:47], v33 offset:61952
    v_mfma_f32_32x32x16_bf16 v[80:95], v[52:55], v[160:163], v[80:95]
    s_waitcnt lgkmcnt(5)
    v_mfma_f32_16x16x32_bf16 v[20:23], v[16:19], v[56:59], v[20:23]
    v_mfma_f32_16x16x32_bf16 v[24:27], v[16:19], v[60:63], v[24:27]
    v_mfma_f32_32x32x16_bf16 v[64:79], v[56:59], v[164:167], v[64:79]
    ds_read_b128 v[172:175], v31 offset:40960
    ds_read_b64_tr_b16 v[48:49], v32 offset:63488
    ds_read_b64_tr_b16 v[50:51], v32 offset:64000
    ds_read_b64_tr_b16 v[52:53], v33 offset:63488
    ds_read_b64_tr_b16 v[54:55], v33 offset:64000
    v_mfma_f32_32x32x16_bf16 v[80:95], v[60:63], v[164:167], v[80:95]
    s_waitcnt lgkmcnt(5)
    v_mfma_f32_16x16x32_bf16 v[20:23], v[16:19], v[40:43], v[20:23]
    v_mfma_f32_16x16x32_bf16 v[24:27], v[16:19], v[44:47], v[24:27]
    v_mfma_f32_32x32x16_bf16 v[64:79], v[40:43], v[168:171], v[64:79]
    s_barrier
    v_subrev_u32 v28, 57344, v28
    v_subrev_u32 v29, 57344, v29
    v_subrev_u32 v30, 57344, v30
    v_subrev_u32 v31, 57344, v31
    ds_read_b128 v[176:179], v28 offset:0
    v_subrev_u32 v32, 57344, v32
    v_subrev_u32 v33, 57344, v33
    ds_read_b64_tr_b16 v[56:57], v32 offset:16384
    ds_read_b64_tr_b16 v[58:59], v32 offset:16896
    ds_read_b64_tr_b16 v[60:61], v33 offset:16384
    ds_read_b64_tr_b16 v[62:63], v33 offset:16896
    v_mfma_f32_32x32x16_bf16 v[80:95], v[44:47], v[168:171], v[80:95]
    s_waitcnt lgkmcnt(5)
    v_mfma_f32_16x16x32_bf16 v[20:23], v[16:19], v[48:51], v[20:23]
    v_mfma_f32_16x16x32_bf16 v[24:27], v[16:19], v[52:55], v[24:27]
    v_mfma_f32_32x32x16_bf16 v[64:79], v[48:51], v[172:175], v[64:79]
    ds_read_b128 v[180:183], v29 offset:0
    ds_read_b64_tr_b16 v[40:41], v32 offset:18432
    ds_read_b64_tr_b16 v[42:43], v32 offset:18944
    ds_read_b64_tr_b16 v[44:45], v33 offset:18432
    ds_read_b64_tr_b16 v[46:47], v33 offset:18944
    v_mfma_f32_32x32x16_bf16 v[80:95], v[52:55], v[172:175], v[80:95]
    s_waitcnt lgkmcnt(5)
    v_mfma_f32_16x16x32_bf16 v[20:23], v[16:19], v[56:59], v[20:23]
    v_mfma_f32_16x16x32_bf16 v[24:27], v[16:19], v[60:63], v[24:27]
    v_mfma_f32_32x32x16_bf16 v[64:79], v[56:59], v[176:179], v[64:79]
    ds_read_b128 v[184:187], v30 offset:0
    ds_read_b64_tr_b16 v[48:49], v32 offset:20480
    ds_read_b64_tr_b16 v[50:51], v32 offset:20992
    ds_read_b64_tr_b16 v[52:53], v33 offset:20480
    ds_read_b64_tr_b16 v[54:55], v33 offset:20992
    v_mfma_f32_32x32x16_bf16 v[80:95], v[60:63], v[176:179], v[80:95]
    s_waitcnt lgkmcnt(5)
    v_mfma_f32_16x16x32_bf16 v[20:23], v[16:19], v[40:43], v[20:23]
    v_mfma_f32_16x16x32_bf16 v[24:27], v[16:19], v[44:47], v[24:27]
    v_mfma_f32_32x32x16_bf16 v[64:79], v[40:43], v[180:183], v[64:79]
    ds_read_b128 v[188:191], v31 offset:0
    ds_read_b64_tr_b16 v[56:57], v32 offset:22528
    ds_read_b64_tr_b16 v[58:59], v32 offset:23040
    ds_read_b64_tr_b16 v[60:61], v33 offset:22528
    ds_read_b64_tr_b16 v[62:63], v33 offset:23040
    v_mfma_f32_32x32x16_bf16 v[80:95], v[44:47], v[180:183], v[80:95]
    s_waitcnt lgkmcnt(5)
    v_mfma_f32_16x16x32_bf16 v[20:23], v[16:19], v[48:51], v[20:23]
    v_mfma_f32_16x16x32_bf16 v[24:27], v[16:19], v[52:55], v[24:27]
    v_mfma_f32_32x32x16_bf16 v[64:79], v[48:51], v[184:187], v[64:79]
    s_barrier
    ds_read_b128 v[192:195], v28 offset:24576
    ds_read_b64_tr_b16 v[40:41], v32 offset:40960
    ds_read_b64_tr_b16 v[42:43], v32 offset:41472
    ds_read_b64_tr_b16 v[44:45], v33 offset:40960
    ds_read_b64_tr_b16 v[46:47], v33 offset:41472
    v_mfma_f32_32x32x16_bf16 v[80:95], v[52:55], v[184:187], v[80:95]
    s_waitcnt lgkmcnt(5)
    v_mfma_f32_16x16x32_bf16 v[20:23], v[16:19], v[56:59], v[20:23]
    v_mfma_f32_16x16x32_bf16 v[24:27], v[16:19], v[60:63], v[24:27]
    v_mfma_f32_32x32x16_bf16 v[64:79], v[56:59], v[188:191], v[64:79]
    ds_read_b128 v[196:199], v29 offset:24576
    ds_read_b64_tr_b16 v[48:49], v32 offset:43008
    ds_read_b64_tr_b16 v[50:51], v32 offset:43520
    ds_read_b64_tr_b16 v[52:53], v33 offset:43008
    ds_read_b64_tr_b16 v[54:55], v33 offset:43520
    v_mfma_f32_32x32x16_bf16 v[80:95], v[60:63], v[188:191], v[80:95]
    s_waitcnt lgkmcnt(5)
    v_mfma_f32_16x16x32_bf16 v[20:23], v[16:19], v[40:43], v[20:23]
    v_mfma_f32_16x16x32_bf16 v[24:27], v[16:19], v[44:47], v[24:27]
    v_mfma_f32_32x32x16_bf16 v[64:79], v[40:43], v[192:195], v[64:79]
    ds_read_b128 v[200:203], v30 offset:24576
    ds_read_b64_tr_b16 v[56:57], v32 offset:45056
    ds_read_b64_tr_b16 v[58:59], v32 offset:45568
    ds_read_b64_tr_b16 v[60:61], v33 offset:45056
    ds_read_b64_tr_b16 v[62:63], v33 offset:45568
    v_mfma_f32_32x32x16_bf16 v[80:95], v[44:47], v[192:195], v[80:95]
    s_waitcnt lgkmcnt(5)
    v_mfma_f32_16x16x32_bf16 v[20:23], v[16:19], v[48:51], v[20:23]
    v_mfma_f32_16x16x32_bf16 v[24:27], v[16:19], v[52:55], v[24:27]
    v_mfma_f32_32x32x16_bf16 v[64:79], v[48:51], v[196:199], v[64:79]
    ds_read_b128 v[204:207], v31 offset:24576
    ds_read_b64_tr_b16 v[40:41], v32 offset:47104
    ds_read_b64_tr_b16 v[42:43], v32 offset:47616
    ds_read_b64_tr_b16 v[44:45], v33 offset:47104
    ds_read_b64_tr_b16 v[46:47], v33 offset:47616
    v_mfma_f32_32x32x16_bf16 v[80:95], v[52:55], v[196:199], v[80:95]
    s_waitcnt lgkmcnt(5)
    v_mfma_f32_16x16x32_bf16 v[20:23], v[16:19], v[56:59], v[20:23]
    v_mfma_f32_16x16x32_bf16 v[24:27], v[16:19], v[60:63], v[24:27]
    v_mfma_f32_32x32x16_bf16 v[64:79], v[56:59], v[200:203], v[64:79]
    s_barrier
    ds_read_b128 v[208:211], v28 offset:49152
    v_add_u32 v32, 57344, v32
    v_add_u32 v33, 57344, v33
    ds_read_b64_tr_b16 v[48:49], v32 offset:8192
    ds_read_b64_tr_b16 v[50:51], v32 offset:8704
    ds_read_b64_tr_b16 v[52:53], v33 offset:8192
    ds_read_b64_tr_b16 v[54:55], v33 offset:8704
    v_mfma_f32_32x32x16_bf16 v[80:95], v[60:63], v[200:203], v[80:95]
    s_waitcnt lgkmcnt(5)
    v_mfma_f32_16x16x32_bf16 v[20:23], v[16:19], v[40:43], v[20:23]
    v_mfma_f32_16x16x32_bf16 v[24:27], v[16:19], v[44:47], v[24:27]
    v_mfma_f32_32x32x16_bf16 v[64:79], v[40:43], v[204:207], v[64:79]
    ds_read_b128 v[212:215], v29 offset:49152
    ds_read_b64_tr_b16 v[56:57], v32 offset:10240
    ds_read_b64_tr_b16 v[58:59], v32 offset:10752
    ds_read_b64_tr_b16 v[60:61], v33 offset:10240
    ds_read_b64_tr_b16 v[62:63], v33 offset:10752
    v_mfma_f32_32x32x16_bf16 v[80:95], v[44:47], v[204:207], v[80:95]
    s_waitcnt lgkmcnt(5)
    v_mfma_f32_16x16x32_bf16 v[20:23], v[16:19], v[48:51], v[20:23]
    v_mfma_f32_16x16x32_bf16 v[24:27], v[16:19], v[52:55], v[24:27]
    v_mfma_f32_32x32x16_bf16 v[64:79], v[48:51], v[208:211], v[64:79]
    ds_read_b128 v[216:219], v30 offset:49152
    ds_read_b64_tr_b16 v[40:41], v32 offset:12288
    ds_read_b64_tr_b16 v[42:43], v32 offset:12800
    ds_read_b64_tr_b16 v[44:45], v33 offset:12288
    ds_read_b64_tr_b16 v[46:47], v33 offset:12800
    v_mfma_f32_32x32x16_bf16 v[80:95], v[52:55], v[208:211], v[80:95]
    s_waitcnt lgkmcnt(5)
    v_mfma_f32_16x16x32_bf16 v[20:23], v[16:19], v[56:59], v[20:23]
    v_mfma_f32_16x16x32_bf16 v[24:27], v[16:19], v[60:63], v[24:27]
    v_mfma_f32_32x32x16_bf16 v[64:79], v[56:59], v[212:215], v[64:79]
    ds_read_b128 v[220:223], v31 offset:49152
    ds_read_b64_tr_b16 v[48:49], v32 offset:14336
    ds_read_b64_tr_b16 v[50:51], v32 offset:14848
    ds_read_b64_tr_b16 v[52:53], v33 offset:14336
    ds_read_b64_tr_b16 v[54:55], v33 offset:14848
    v_mfma_f32_32x32x16_bf16 v[80:95], v[60:63], v[212:215], v[80:95]
    s_waitcnt lgkmcnt(5)
    v_mfma_f32_16x16x32_bf16 v[20:23], v[16:19], v[40:43], v[20:23]
    v_mfma_f32_16x16x32_bf16 v[24:27], v[16:19], v[44:47], v[24:27]
    v_mfma_f32_32x32x16_bf16 v[64:79], v[40:43], v[216:219], v[64:79]
    s_barrier
    v_add_u32 v28, 57344, v28
    v_add_u32 v29, 57344, v29
    v_add_u32 v30, 57344, v30
    v_add_u32 v31, 57344, v31
    ds_read_b128 v[224:227], v28 offset:16384
    ds_read_b64_tr_b16 v[56:57], v32 offset:32768
    ds_read_b64_tr_b16 v[58:59], v32 offset:33280
    ds_read_b64_tr_b16 v[60:61], v33 offset:32768
    ds_read_b64_tr_b16 v[62:63], v33 offset:33280
    v_mfma_f32_32x32x16_bf16 v[80:95], v[44:47], v[216:219], v[80:95]
    buffer_load_dwordx4 v[8:11], v36, s[32:35], s80 offen offset:0 sc1
    s_waitcnt lgkmcnt(5)
    v_mfma_f32_16x16x32_bf16 v[20:23], v[16:19], v[48:51], v[20:23]
    v_mfma_f32_16x16x32_bf16 v[24:27], v[16:19], v[52:55], v[24:27]
    v_mfma_f32_32x32x16_bf16 v[64:79], v[48:51], v[220:223], v[64:79]
    ds_read_b128 v[228:231], v29 offset:16384
    ds_read_b64_tr_b16 v[40:41], v32 offset:34816
    ds_read_b64_tr_b16 v[42:43], v32 offset:35328
    ds_read_b64_tr_b16 v[44:45], v33 offset:34816
    ds_read_b64_tr_b16 v[46:47], v33 offset:35328
    v_mfma_f32_32x32x16_bf16 v[80:95], v[52:55], v[220:223], v[80:95]
    s_waitcnt lgkmcnt(5)
    v_mfma_f32_16x16x32_bf16 v[20:23], v[16:19], v[56:59], v[20:23]
    v_mfma_f32_16x16x32_bf16 v[24:27], v[16:19], v[60:63], v[24:27]
    v_mfma_f32_32x32x16_bf16 v[64:79], v[56:59], v[224:227], v[64:79]
    ds_read_b128 v[232:235], v30 offset:16384
    ds_read_b64_tr_b16 v[48:49], v32 offset:36864
    ds_read_b64_tr_b16 v[50:51], v32 offset:37376
    ds_read_b64_tr_b16 v[52:53], v33 offset:36864
    ds_read_b64_tr_b16 v[54:55], v33 offset:37376
    v_mfma_f32_32x32x16_bf16 v[80:95], v[60:63], v[224:227], v[80:95]
    s_waitcnt lgkmcnt(5)
    v_mfma_f32_16x16x32_bf16 v[20:23], v[16:19], v[40:43], v[20:23]
    v_mfma_f32_16x16x32_bf16 v[24:27], v[16:19], v[44:47], v[24:27]
    v_mfma_f32_32x32x16_bf16 v[64:79], v[40:43], v[228:231], v[64:79]
    ds_read_b128 v[236:239], v31 offset:16384
    ds_read_b64_tr_b16 v[56:57], v32 offset:38912
    ds_read_b64_tr_b16 v[58:59], v32 offset:39424
    ds_read_b64_tr_b16 v[60:61], v33 offset:38912
    ds_read_b64_tr_b16 v[62:63], v33 offset:39424
    v_mfma_f32_32x32x16_bf16 v[80:95], v[44:47], v[228:231], v[80:95]
    s_waitcnt lgkmcnt(5)
    v_mfma_f32_16x16x32_bf16 v[20:23], v[16:19], v[48:51], v[20:23]
    v_mfma_f32_16x16x32_bf16 v[24:27], v[16:19], v[52:55], v[24:27]
    v_mfma_f32_32x32x16_bf16 v[64:79], v[48:51], v[232:235], v[64:79]
    s_barrier
    ds_read_b128 v[240:243], v28 offset:40960
    ds_read_b64_tr_b16 v[40:41], v32 offset:57344
    ds_read_b64_tr_b16 v[42:43], v32 offset:57856
    ds_read_b64_tr_b16 v[44:45], v33 offset:57344
    ds_read_b64_tr_b16 v[46:47], v33 offset:57856
    v_mfma_f32_32x32x16_bf16 v[80:95], v[52:55], v[232:235], v[80:95]
    s_waitcnt lgkmcnt(5)
    v_mfma_f32_16x16x32_bf16 v[20:23], v[16:19], v[56:59], v[20:23]
    v_mfma_f32_16x16x32_bf16 v[24:27], v[16:19], v[60:63], v[24:27]
    v_mfma_f32_32x32x16_bf16 v[64:79], v[56:59], v[236:239], v[64:79]
    ds_read_b128 v[244:247], v29 offset:40960
    ds_read_b64_tr_b16 v[48:49], v32 offset:59392
    ds_read_b64_tr_b16 v[50:51], v32 offset:59904
    ds_read_b64_tr_b16 v[52:53], v33 offset:59392
    ds_read_b64_tr_b16 v[54:55], v33 offset:59904
    v_mfma_f32_32x32x16_bf16 v[80:95], v[60:63], v[236:239], v[80:95]
    s_waitcnt lgkmcnt(5)
    v_mfma_f32_16x16x32_bf16 v[20:23], v[16:19], v[40:43], v[20:23]
    v_mfma_f32_16x16x32_bf16 v[24:27], v[16:19], v[44:47], v[24:27]
    v_mfma_f32_32x32x16_bf16 v[64:79], v[40:43], v[240:243], v[64:79]
    ds_read_b128 v[248:251], v30 offset:40960
    ds_read_b64_tr_b16 v[56:57], v32 offset:61440
    ds_read_b64_tr_b16 v[58:59], v32 offset:61952
L_chain3:
    s_cbranch_execz L_pad3_1
    ds_read_b64_tr_b16 v[60:61], v33 offset:61440
    ds_read_b64_tr_b16 v[62:63], v33 offset:61952
    v_mfma_f32_32x32x16_bf16 v[80:95], v[44:47], v[240:243], v[80:95]
    s_waitcnt lgkmcnt(5)
    v_mfma_f32_16x16x32_bf16 v[20:23], v[16:19], v[48:51], v[20:23]
    v_mfma_f32_16x16x32_bf16 v[24:27], v[16:19], v[52:55], v[24:27]
    v_mfma_f32_32x32x16_bf16 v[64:79], v[48:51], v[244:247], v[64:79]
    ds_read_b128 v[252:255], v31 offset:40960
    ds_read_b64_tr_b16 v[40:41], v32 offset:63488
    ds_read_b64_tr_b16 v[42:43], v32 offset:64000
    ds_read_b64_tr_b16 v[44:45], v33 offset:63488
    ds_read_b64_tr_b16 v[46:47], v33 offset:64000
    v_mfma_f32_32x32x16_bf16 v[80:95], v[52:55], v[244:247], v[80:95]
    s_waitcnt lgkmcnt(5)
    v_mfma_f32_16x16x32_bf16 v[20:23], v[16:19], v[56:59], v[20:23]
    v_mfma_f32_16x16x32_bf16 v[24:27], v[16:19], v[60:63], v[24:27]
    v_mfma_f32_32x32x16_bf16 v[64:79], v[56:59], v[248:251], v[64:79]
    v_mfma_f32_32x32x16_bf16 v[80:95], v[60:63], v[248:251], v[80:95]
    s_waitcnt lgkmcnt(0)
    s_waitcnt vmcnt(0)
    v_cmp_ne_u32 vcc, s42, v10
    v_cmp_ne_u32 s[46:47], s42, v10
    s_nop 0
    s_or_b64 vcc, vcc, s[46:47]
    s_cbranch_scc1 L_st_18
L_sto_19:
    v_mfma_f32_16x16x32_bf16 v[20:23], v[16:19], v[40:43], v[20:23]
    v_mfma_f32_16x16x32_bf16 v[24:27], v[16:19], v[44:47], v[24:27]
    v_mfma_f32_32x32x16_bf16 v[64:79], v[40:43], v[252:255], v[64:79]
    v_cvt_pk_bf16_f32 v56, -v9, -v9
    v_mov_b32 v57, v56
    v_mov_b32 v58, 0
    v_mov_b32 v59, 0
    v_mov_b32 v50, 0
    v_mfma_f32_32x32x16_bf16 v[80:95], v[44:47], v[252:255], v[80:95]
    v_mov_b32 v51, 0
    v_mov_b32 v54, 0
    v_mov_b32 v55, 0
    v_mul_f32 v12, 0x3ea52b5c, v8
    v_and_b32 v2, 0xffff0000, v20
    v_sub_f32 v3, v20, v2
    v_and_b32 v4, 0xffff0000, v3
    v_sub_f32 v3, v3, v4
    v_cvt_pk_bf16_f32 v48, v2, v4
    v_cvt_pk_bf16_f32 v49, v3, 0
    v_and_b32 v2, 0xffff0000, v24
    v_sub_f32 v3, v24, v2
    v_and_b32 v4, 0xffff0000, v3
    v_sub_f32 v3, v3, v4
    v_cvt_pk_bf16_f32 v52, v2, v4
    v_cvt_pk_bf16_f32 v53, v3, 0
    v_mfma_f32_32x32x16_bf16 v[64:79], v[48:51], v[56:59], v[64:79]
    s_nop 0
    v_mfma_f32_32x32x16_bf16 v[80:95], v[52:55], v[56:59], v[80:95]
    s_nop 9
    v_pk_mul_f32 v[64:65], v[64:65], v[12:13] op_sel:[0,0] op_sel_hi:[1,0]
    v_pk_mul_f32 v[66:67], v[66:67], v[12:13] op_sel:[0,0] op_sel_hi:[1,0]
    v_pk_mul_f32 v[68:69], v[68:69], v[12:13] op_sel:[0,0] op_sel_hi:[1,0]
    v_pk_mul_f32 v[70:71], v[70:71], v[12:13] op_sel:[0,0] op_sel_hi:[1,0]
    v_pk_mul_f32 v[72:73], v[72:73], v[12:13] op_sel:[0,0] op_sel_hi:[1,0]
    v_pk_mul_f32 v[74:75], v[74:75], v[12:13] op_sel:[0,0] op_sel_hi:[1,0]
    v_pk_mul_f32 v[76:77], v[76:77], v[12:13] op_sel:[0,0] op_sel_hi:[1,0]
    v_pk_mul_f32 v[78:79], v[78:79], v[12:13] op_sel:[0,0] op_sel_hi:[1,0]
    v_cvt_pk_bf16_f32 v64, v64, v65
    v_cvt_pk_bf16_f32 v65, v66, v67
    v_cvt_pk_bf16_f32 v66, v68, v69
    v_cvt_pk_bf16_f32 v67, v70, v71
    v_cvt_pk_bf16_f32 v68, v72, v73
    v_cvt_pk_bf16_f32 v69, v74, v75
    v_cvt_pk_bf16_f32 v70, v76, v77
    v_cvt_pk_bf16_f32 v71, v78, v79
    v_permlane32_swap_b32 v64, v66
    v_permlane32_swap_b32 v65, v67
    v_permlane32_swap_b32 v68, v70
    v_permlane32_swap_b32 v69, v71
    buffer_store_dwordx4 v[64:67], v34, s[32:35], s78 offen offset:0 sc1
    buffer_store_dwordx4 v[68:71], v34, s[32:35], s78 offen offset:2048 sc1
    v_pk_mul_f32 v[80:81], v[80:81], v[12:13] op_sel:[0,0] op_sel_hi:[1,0]
    v_pk_mul_f32 v[82:83], v[82:83], v[12:13] op_sel:[0,0] op_sel_hi:[1,0]
    v_pk_mul_f32 v[84:85], v[84:85], v[12:13] op_sel:[0,0] op_sel_hi:[1,0]
    v_pk_mul_f32 v[86:87], v[86:87], v[12:13] op_sel:[0,0] op_sel_hi:[1,0]
    v_pk_mul_f32 v[88:89], v[88:89], v[12:13] op_sel:[0,0] op_sel_hi:[1,0]
    v_pk_mul_f32 v[90:91], v[90:91], v[12:13] op_sel:[0,0] op_sel_hi:[1,0]
    v_pk_mul_f32 v[92:93], v[92:93], v[12:13] op_sel:[0,0] op_sel_hi:[1,0]
    v_pk_mul_f32 v[94:95], v[94:95], v[12:13] op_sel:[0,0] op_sel_hi:[1,0]
    v_cvt_pk_bf16_f32 v80, v80, v81
    v_cvt_pk_bf16_f32 v81, v82, v83
    v_cvt_pk_bf16_f32 v82, v84, v85
    v_cvt_pk_bf16_f32 v83, v86, v87
    v_cvt_pk_bf16_f32 v84, v88, v89
    v_cvt_pk_bf16_f32 v85, v90, v91
    v_cvt_pk_bf16_f32 v86, v92, v93
    v_cvt_pk_bf16_f32 v87, v94, v95
    v_permlane32_swap_b32 v80, v82
    v_permlane32_swap_b32 v81, v83
    v_permlane32_swap_b32 v84, v86
    v_permlane32_swap_b32 v85, v87
    buffer_store_dwordx4 v[80:83], v34, s[32:35], s84 offen offset:0 sc1
    buffer_store_dwordx4 v[84:87], v34, s[32:35], s84 offen offset:2048 sc1
    s_barrier
    v_subrev_u32 v32, 57344, v32
    v_subrev_u32 v33, 57344, v33
    ds_read_b64_tr_b16 v[48:49], v32 offset:0
    ds_read_b64_tr_b16 v[50:51], v32 offset:512
    ds_read_b64_tr_b16 v[52:53], v33 offset:0
    ds_read_b64_tr_b16 v[54:55], v33 offset:512
    ds_read_b64_tr_b16 v[56:57], v32 offset:2048
    ds_read_b64_tr_b16 v[58:59], v32 offset:2560
    ds_read_b64_tr_b16 v[60:61], v33 offset:2048
    ds_read_b64_tr_b16 v[62:63], v33 offset:2560
    s_waitcnt lgkmcnt(4)
    v_mfma_f32_32x32x16_bf16 v[64:79], v[48:51], v[96:99], 0
    ds_read_b64_tr_b16 v[40:41], v32 offset:4096
    ds_read_b64_tr_b16 v[42:43], v32 offset:4608
    ds_read_b64_tr_b16 v[44:45], v33 offset:4096
    ds_read_b64_tr_b16 v[46:47], v33 offset:4608
    v_mfma_f32_32x32x16_bf16 v[80:95], v[52:55], v[96:99], 0
    s_waitcnt lgkmcnt(4)
    v_mfma_f32_32x32x16_bf16 v[64:79], v[56:59], v[100:103], v[64:79]
    ds_read_b64_tr_b16 v[48:49], v32 offset:6144
    ds_read_b64_tr_b16 v[50:51], v32 offset:6656
    ds_read_b64_tr_b16 v[52:53], v33 offset:6144
    ds_read_b64_tr_b16 v[54:55], v33 offset:6656
    v_mfma_f32_32x32x16_bf16 v[80:95], v[60:63], v[100:103], v[80:95]
    s_waitcnt lgkmcnt(4)
    v_mfma_f32_32x32x16_bf16 v[64:79], v[40:43], v[104:107], v[64:79]
    ds_read_b64_tr_b16 v[56:57], v32 offset:8192
    ds_read_b64_tr_b16 v[58:59], v32 offset:8704
    ds_read_b64_tr_b16 v[60:61], v33 offset:8192
    ds_read_b64_tr_b16 v[62:63], v33 offset:8704
    v_mfma_f32_32x32x16_bf16 v[80:95], v[44:47], v[104:107], v[80:95]
    s_waitcnt lgkmcnt(4)
    v_mfma_f32_32x32x16_bf16 v[64:79], v[48:51], v[108:111], v[64:79]
    ds_read_b64_tr_b16 v[40:41], v32 offset:10240
    ds_read_b64_tr_b16 v[42:43], v32 offset:10752
    ds_read_b64_tr_b16 v[44:45], v33 offset:10240
    ds_read_b64_tr_b16 v[46:47], v33 offset:10752
    v_mfma_f32_32x32x16_bf16 v[80:95], v[52:55], v[108:111], v[80:95]
    s_waitcnt lgkmcnt(4)
    v_mfma_f32_32x32x16_bf16 v[64:79], v[56:59], v[112:115], v[64:79]
    ds_read_b64_tr_b16 v[48:49], v32 offset:12288
    ds_read_b64_tr_b16 v[50:51], v32 offset:12800
    ds_read_b64_tr_b16 v[52:53], v33 offset:12288
    ds_read_b64_tr_b16 v[54:55], v33 offset:12800
    v_mfma_f32_32x32x16_bf16 v[80:95], v[60:63], v[112:115], v[80:95]
    s_waitcnt lgkmcnt(4)
    v_mfma_f32_32x32x16_bf16 v[64:79], v[40:43], v[116:119], v[64:79]
    ds_read_b64_tr_b16 v[56:57], v32 offset:14336
    ds_read_b64_tr_b16 v[58:59], v32 offset:14848
    ds_read_b64_tr_b16 v[60:61], v33 offset:14336
    ds_read_b64_tr_b16 v[62:63], v33 offset:14848
    v_mfma_f32_32x32x16_bf16 v[80:95], v[44:47], v[116:119], v[80:95]
    s_waitcnt lgkmcnt(4)
    v_mfma_f32_32x32x16_bf16 v[64:79], v[48:51], v[120:123], v[64:79]
    ds_read_b64_tr_b16 v[40:41], v32 offset:16384
    ds_read_b64_tr_b16 v[42:43], v32 offset:16896
    ds_read_b64_tr_b16 v[44:45], v33 offset:16384
    ds_read_b64_tr_b16 v[46:47], v33 offset:16896
    v_mfma_f32_32x32x16_bf16 v[80:95], v[52:55], v[120:123], v[80:95]
    s_waitcnt lgkmcnt(4)
    v_mfma_f32_32x32x16_bf16 v[64:79], v[56:59], v[124:127], v[64:79]
    ds_read_b64_tr_b16 v[48:49], v32 offset:18432
    ds_read_b64_tr_b16 v[50:51], v32 offset:18944
    ds_read_b64_tr_b16 v[52:53], v33 offset:18432
    ds_read_b64_tr_b16 v[54:55], v33 offset:18944
    v_mfma_f32_32x32x16_bf16 v[80:95], v[60:63], v[124:127], v[80:95]
    s_waitcnt lgkmcnt(4)
    v_mfma_f32_32x32x16_bf16 v[64:79], v[40:43], v[128:131], v[64:79]
    ds_read_b64_tr_b16 v[56:57], v32 offset:20480
    ds_read_b64_tr_b16 v[58:59], v32 offset:20992
    ds_read_b64_tr_b16 v[60:61], v33 offset:20480
    ds_read_b64_tr_b16 v[62:63], v33 offset:20992
    v_mfma_f32_32x32x16_bf16 v[80:95], v[44:47], v[128:131], v[80:95]
    s_waitcnt lgkmcnt(4)
    v_mfma_f32_32x32x16_bf16 v[64:79], v[48:51], v[132:135], v[64:79]
    ds_read_b64_tr_b16 v[40:41], v32 offset:22528
    ds_read_b64_tr_b16 v[42:43], v32 offset:23040
    ds_read_b64_tr_b16 v[44:45], v33 offset:22528
    ds_read_b64_tr_b16 v[46:47], v33 offset:23040
    v_mfma_f32_32x32x16_bf16 v[80:95], v[52:55], v[132:135], v[80:95]
    s_lshr_b32 s66, s41, 3
    s_lshl_b32 s52, s40, 2
    s_add_u32 s52, s52, s66
    s_mov_b32 s43, s52
    s_and_b32 s51, s41, 7
    s_waitcnt lgkmcnt(4)
    v_mfma_f32_32x32x16_bf16 v[64:79], v[56:59], v[136:139], v[64:79]
    s_barrier
    ds_read_b64_tr_b16 v[48:49], v32 offset:24576
    ds_read_b64_tr_b16 v[50:51], v32 offset:25088
    ds_read_b64_tr_b16 v[52:53], v33 offset:24576
    ds_read_b64_tr_b16 v[54:55], v33 offset:25088
    v_mfma_f32_32x32x16_bf16 v[80:95], v[60:63], v[136:139], v[80:95]
    s_mov_b32 s45, s51
    s_and_b32 s48, s43, 1
    s_lshr_b32 s66, s43, 1
    s_mul_i32 s66, s66, 5
    s_lshl_b32 s67, s48, 1
    s_waitcnt lgkmcnt(4)
    v_mfma_f32_32x32x16_bf16 v[64:79], v[40:43], v[140:143], v[64:79]
    ds_read_b64_tr_b16 v[56:57], v32 offset:26624
    ds_read_b64_tr_b16 v[58:59], v32 offset:27136
    ds_read_b64_tr_b16 v[60:61], v33 offset:26624
    ds_read_b64_tr_b16 v[62:63], v33 offset:27136
    v_mfma_f32_32x32x16_bf16 v[80:95], v[44:47], v[140:143], v[80:95]
    s_add_u32 s49, s66, s67
    s_lshl_b32 s50, s45, 2
    s_add_u32 s50, s50, s3
    s_and_b32 s5, s41, 15
    s_add_u32 s6, s3, s51
    s_waitcnt lgkmcnt(4)
    v_mfma_f32_32x32x16_bf16 v[64:79], v[48:51], v[144:147], v[64:79]
    ds_read_b64_tr_b16 v[40:41], v32 offset:28672
    ds_read_b64_tr_b16 v[42:43], v32 offset:29184
    ds_read_b64_tr_b16 v[44:45], v33 offset:28672
    ds_read_b64_tr_b16 v[46:47], v33 offset:29184
    v_mfma_f32_32x32x16_bf16 v[80:95], v[52:55], v[144:147], v[80:95]
    s_waitcnt vmcnt(0)
    v_mov_b32 v2, s42
    buffer_store_dword v2, v35, s[32:35], s82 offen sc1
    s_and_b32 s6, s6, 3
    v_lshlrev_b32 v112, 4, v1
    v_and_b32 v98, 31, v1
    v_lshrrev_b32 v99, 5, v1
    v_lshlrev_b32 v98, 4, v98
    s_waitcnt lgkmcnt(4)
    v_mfma_f32_32x32x16_bf16 v[64:79], v[56:59], v[148:151], v[64:79]
    ds_read_b64_tr_b16 v[48:49], v32 offset:30720
    ds_read_b64_tr_b16 v[50:51], v32 offset:31232
    ds_read_b64_tr_b16 v[52:53], v33 offset:30720
    ds_read_b64_tr_b16 v[54:55], v33 offset:31232
    v_mfma_f32_32x32x16_bf16 v[80:95], v[60:63], v[148:151], v[80:95]
    v_add_u32 v100, s48, v99
    v_lshl_add_u32 v124, v100, 10, v98
    s_mul_i32 s66, s50, 80
    s_add_u32 s66, s66, s49
    s_lshl_b32 s66, s66, 10
    s_waitcnt lgkmcnt(4)
    v_mfma_f32_32x32x16_bf16 v[64:79], v[40:43], v[152:155], v[64:79]
    ds_read_b64_tr_b16 v[56:57], v32 offset:32768
    ds_read_b64_tr_b16 v[58:59], v32 offset:33280
    ds_read_b64_tr_b16 v[60:61], v33 offset:32768
    ds_read_b64_tr_b16 v[62:63], v33 offset:33280
    v_mfma_f32_32x32x16_bf16 v[80:95], v[44:47], v[152:155], v[80:95]
    s_add_u32 s88, s66, 8388608
    s_cmp_eq_u32 s48, 0
    s_cselect_b32 s67, 2048, 8
    s_add_u32 s89, s67, s88
    s_lshl_b32 s4, s43, 5
    s_waitcnt lgkmcnt(4)
    v_mfma_f32_32x32x16_bf16 v[64:79], v[48:51], v[156:159], v[64:79]
    ds_read_b64_tr_b16 v[40:41], v32 offset:34816
    ds_read_b64_tr_b16 v[42:43], v32 offset:35328
    ds_read_b64_tr_b16 v[44:45], v33 offset:34816
    ds_read_b64_tr_b16 v[46:47], v33 offset:35328
    v_mfma_f32_32x32x16_bf16 v[80:95], v[52:55], v[156:159], v[80:95]
    s_add_u32 s4, s4, s50
    s_lshl_b32 s4, s4, 7
    s_add_u32 s4, s4, 21364736
    v_add_u32 v120, 92160, v124
    s_cmp_eq_u32 s48, 0
    s_cselect_b32 s63, 2048, 8
    s_waitcnt lgkmcnt(4)
    v_mfma_f32_32x32x16_bf16 v[64:79], v[56:59], v[160:163], v[64:79]
    ds_read_b64_tr_b16 v[48:49], v32 offset:36864
    ds_read_b64_tr_b16 v[50:51], v32 offset:37376
    ds_read_b64_tr_b16 v[52:53], v33 offset:36864
    ds_read_b64_tr_b16 v[54:55], v33 offset:37376
    v_mfma_f32_32x32x16_bf16 v[80:95], v[60:63], v[160:163], v[80:95]
    v_add_u32 v127, s63, v98
    v_add_u32 v100, 6144, v98
    v_cmp_gt_u32 vcc, 32, v1
    s_nop 1
    v_cndmask_b32 v121, v100, v127, vcc
    v_add_u32 v121, 92160, v121
    s_waitcnt lgkmcnt(4)
    v_mfma_f32_32x32x16_bf16 v[64:79], v[40:43], v[164:167], v[64:79]
    ds_read_b64_tr_b16 v[56:57], v32 offset:38912
    ds_read_b64_tr_b16 v[58:59], v32 offset:39424
    ds_read_b64_tr_b16 v[60:61], v33 offset:38912
    ds_read_b64_tr_b16 v[62:63], v33 offset:39424
    v_mfma_f32_32x32x16_bf16 v[80:95], v[44:47], v[164:167], v[80:95]
    v_bfe_u32 v100, v1, 4, 1
    v_and_b32 v101, 3, v1
    v_lshl_add_u32 v100, v100, 2, v101
    v_lshrrev_b32 v101, 1, v100
    v_add_u32 v102, s48, v101
    s_waitcnt lgkmcnt(4)
    v_mfma_f32_32x32x16_bf16 v[64:79], v[48:51], v[168:171], v[64:79]
    ds_read_b64_tr_b16 v[40:41], v32 offset:40960
    ds_read_b64_tr_b16 v[42:43], v32 offset:41472
    ds_read_b64_tr_b16 v[44:45], v33 offset:40960
    ds_read_b64_tr_b16 v[46:47], v33 offset:41472
    v_mfma_f32_32x32x16_bf16 v[80:95], v[52:55], v[168:171], v[80:95]
    s_lshr_b32 s63, s63, 10
    v_mov_b32 v103, s63
    v_cmp_eq_u32 vcc, 2, v101
    s_nop 1
    v_cndmask_b32 v102, v102, v103, vcc
    v_and_b32 v104, 1, v100
    s_waitcnt lgkmcnt(4)
    v_mfma_f32_32x32x16_bf16 v[64:79], v[56:59], v[172:175], v[64:79]
    ds_read_b64_tr_b16 v[48:49], v32 offset:43008
    ds_read_b64_tr_b16 v[50:51], v32 offset:43520
    ds_read_b64_tr_b16 v[52:53], v33 offset:43008
    ds_read_b64_tr_b16 v[54:55], v33 offset:43520
    v_mfma_f32_32x32x16_bf16 v[80:95], v[60:63], v[172:175], v[80:95]
    v_xor_b32 v105, s48, v104
    v_cndmask_b32 v104, v104, v105, vcc
    v_cmp_le_u32 vcc, 5, v100
    s_nop 1
    v_cndmask_b32 v102, v102, 3, vcc
    v_cndmask_b32 v104, v104, 0, vcc
    s_waitcnt lgkmcnt(4)
    v_mfma_f32_32x32x16_bf16 v[64:79], v[40:43], v[176:179], v[64:79]
    ds_read_b64_tr_b16 v[56:57], v32 offset:45056
    ds_read_b64_tr_b16 v[58:59], v32 offset:45568
    ds_read_b64_tr_b16 v[60:61], v33 offset:45056
    ds_read_b64_tr_b16 v[62:63], v33 offset:45568
    v_mfma_f32_32x32x16_bf16 v[80:95], v[44:47], v[176:179], v[80:95]
    v_cmp_eq_u32 vcc, 5, v100
    s_nop 1
    v_cndmask_b32 v104, v104, 1, vcc
    v_bfe_u32 v105, v1, 2, 2
    v_lshl_add_u32 v105, v99, 2, v105
    v_lshlrev_b32 v106, 2, v102
    s_waitcnt lgkmcnt(4)
    v_mfma_f32_32x32x16_bf16 v[64:79], v[48:51], v[180:183], v[64:79]
    ds_read_b64_tr_b16 v[40:41], v32 offset:47104
    ds_read_b64_tr_b16 v[42:43], v32 offset:47616
    ds_read_b64_tr_b16 v[44:45], v33 offset:47104
    ds_read_b64_tr_b16 v[46:47], v33 offset:47616
    v_mfma_f32_32x32x16_bf16 v[80:95], v[52:55], v[180:183], v[80:95]
    v_xor_b32 v105, v105, v106
    v_lshlrev_b32 v105, 4, v105
    v_lshl_add_u32 v105, v102, 10, v105
    v_lshl_add_u32 v105, v104, 3, v105
    v_add_u32 v122, 95232, v105
    s_waitcnt lgkmcnt(4)
    v_mfma_f32_32x32x16_bf16 v[64:79], v[56:59], v[184:187], v[64:79]
    s_barrier
    ds_read_b64_tr_b16 v[48:49], v32 offset:49152
    ds_read_b64_tr_b16 v[50:51], v32 offset:49664
    ds_read_b64_tr_b16 v[52:53], v33 offset:49152
    ds_read_b64_tr_b16 v[54:55], v33 offset:49664
    v_mfma_f32_32x32x16_bf16 v[80:95], v[60:63], v[184:187], v[80:95]
    v_xor_b32 v123, 128, v122
    v_and_b32 v98, 15, v1
    v_mul_u32_u24 v98, 160, v98
    v_lshrrev_b32 v99, 4, v1
    v_lshl_add_u32 v98, v99, 3, v98
    s_waitcnt lgkmcnt(4)
    v_mfma_f32_32x32x16_bf16 v[64:79], v[40:43], v[188:191], v[64:79]
    ds_read_b64_tr_b16 v[56:57], v32 offset:51200
    ds_read_b64_tr_b16 v[58:59], v32 offset:51712
    ds_read_b64_tr_b16 v[60:61], v33 offset:51200
    ds_read_b64_tr_b16 v[62:63], v33 offset:51712
    v_mfma_f32_32x32x16_bf16 v[80:95], v[44:47], v[188:191], v[80:95]
    s_mul_i32 s66, s3, 2560
    s_add_u32 s66, s66, 81920
    v_add_u32 v110, s66, v98
    s_mul_i32 s66, s3, 3072
    s_add_u32 s66, s66, 122880
    s_waitcnt lgkmcnt(4)
    v_mfma_f32_32x32x16_bf16 v[64:79], v[48:51], v[192:195], v[64:79]
    ds_read_b64_tr_b16 v[40:41], v32 offset:53248
    ds_read_b64_tr_b16 v[42:43], v32 offset:53760
    ds_read_b64_tr_b16 v[44:45], v33 offset:53248
    ds_read_b64_tr_b16 v[46:47], v33 offset:53760
    v_mfma_f32_32x32x16_bf16 v[80:95], v[52:55], v[192:195], v[80:95]
    v_add_u32 v113, s66, v124
    v_add_u32 v114, s66, v127
    s_mul_i32 s66, s3, 20480
    v_add_u32 v115, s66, v112
    s_mul_i32 s66, s3, 5120
    s_waitcnt lgkmcnt(4)
    v_mfma_f32_32x32x16_bf16 v[64:79], v[56:59], v[196:199], v[64:79]
    ds_read_b64_tr_b16 v[48:49], v32 offset:55296
    ds_read_b64_tr_b16 v[50:51], v32 offset:55808
    ds_read_b64_tr_b16 v[52:53], v33 offset:55296
    ds_read_b64_tr_b16 v[54:55], v33 offset:55808
    v_mfma_f32_32x32x16_bf16 v[80:95], v[60:63], v[196:199], v[80:95]
    s_add_u32 s66, s66, 86016
    v_add_u32 v117, s66, v112
    s_mov_b32 s61, 0
    v_and_b32 v116, 31, v1
    v_lshl_add_u32 v116, v116, 3, s40
    s_waitcnt lgkmcnt(4)
    v_mfma_f32_32x32x16_bf16 v[64:79], v[40:43], v[200:203], v[64:79]
    v_add_u32 v32, 57344, v32
    v_add_u32 v33, 57344, v33
    ds_read_b64_tr_b16 v[56:57], v32 offset:0
    ds_read_b64_tr_b16 v[58:59], v32 offset:512
    ds_read_b64_tr_b16 v[60:61], v33 offset:0
    ds_read_b64_tr_b16 v[62:63], v33 offset:512
    v_mfma_f32_32x32x16_bf16 v[80:95], v[44:47], v[200:203], v[80:95]
    v_lshlrev_b32 v116, 7, v116
    v_add_u32 v116, 22020096, v116
    s_waitcnt lgkmcnt(4)
    v_mfma_f32_32x32x16_bf16 v[64:79], v[48:51], v[204:207], v[64:79]
    ds_read_b64_tr_b16 v[40:41], v32 offset:2048
    ds_read_b64_tr_b16 v[42:43], v32 offset:2560
    ds_read_b64_tr_b16 v[44:45], v33 offset:2048
    ds_read_b64_tr_b16 v[46:47], v33 offset:2560
    v_mfma_f32_32x32x16_bf16 v[80:95], v[52:55], v[204:207], v[80:95]
    s_waitcnt lgkmcnt(4)
    v_mfma_f32_32x32x16_bf16 v[64:79], v[56:59], v[208:211], v[64:79]
    ds_read_b64_tr_b16 v[48:49], v32 offset:4096
    ds_read_b64_tr_b16 v[50:51], v32 offset:4608
    ds_read_b64_tr_b16 v[52:53], v33 offset:4096
    ds_read_b64_tr_b16 v[54:55], v33 offset:4608
    v_mfma_f32_32x32x16_bf16 v[80:95], v[60:63], v[208:211], v[80:95]
    s_waitcnt lgkmcnt(4)
    v_mfma_f32_32x32x16_bf16 v[64:79], v[40:43], v[212:215], v[64:79]
    ds_read_b64_tr_b16 v[56:57], v32 offset:6144
    ds_read_b64_tr_b16 v[58:59], v32 offset:6656
    ds_read_b64_tr_b16 v[60:61], v33 offset:6144
    ds_read_b64_tr_b16 v[62:63], v33 offset:6656
    v_mfma_f32_32x32x16_bf16 v[80:95], v[44:47], v[212:215], v[80:95]
    s_waitcnt lgkmcnt(4)
    v_mfma_f32_32x32x16_bf16 v[64:79], v[48:51], v[216:219], v[64:79]
    ds_read_b64_tr_b16 v[40:41], v32 offset:8192
    ds_read_b64_tr_b16 v[42:43], v32 offset:8704
    ds_read_b64_tr_b16 v[44:45], v33 offset:8192
    ds_read_b64_tr_b16 v[46:47], v33 offset:8704
    v_mfma_f32_32x32x16_bf16 v[80:95], v[52:55], v[216:219], v[80:95]
    buffer_load_dwordx2 v[20:21], v37, s[32:35], s81 offen offset:0 sc1
    buffer_load_dwordx2 v[24:25], v37, s[32:35], s81 offen offset:256 sc1
    s_waitcnt lgkmcnt(4)
    v_mfma_f32_32x32x16_bf16 v[64:79], v[56:59], v[220:223], v[64:79]
    ds_read_b64_tr_b16 v[48:49], v32 offset:10240
    ds_read_b64_tr_b16 v[50:51], v32 offset:10752
    ds_read_b64_tr_b16 v[52:53], v33 offset:10240
    ds_read_b64_tr_b16 v[54:55], v33 offset:10752
    v_mfma_f32_32x32x16_bf16 v[80:95], v[60:63], v[220:223], v[80:95]
    s_waitcnt lgkmcnt(4)
    v_mfma_f32_32x32x16_bf16 v[64:79], v[40:43], v[224:227], v[64:79]
    ds_read_b64_tr_b16 v[56:57], v32 offset:12288
    ds_read_b64_tr_b16 v[58:59], v32 offset:12800
    ds_read_b64_tr_b16 v[60:61], v33 offset:12288
    ds_read_b64_tr_b16 v[62:63], v33 offset:12800
    v_mfma_f32_32x32x16_bf16 v[80:95], v[44:47], v[224:227], v[80:95]
    s_waitcnt lgkmcnt(4)
    v_mfma_f32_32x32x16_bf16 v[64:79], v[48:51], v[228:231], v[64:79]
    ds_read_b64_tr_b16 v[40:41], v32 offset:14336
    ds_read_b64_tr_b16 v[42:43], v32 offset:14848
    ds_read_b64_tr_b16 v[44:45], v33 offset:14336
    ds_read_b64_tr_b16 v[46:47], v33 offset:14848
    v_mfma_f32_32x32x16_bf16 v[80:95], v[52:55], v[228:231], v[80:95]
    s_waitcnt lgkmcnt(4)
    v_mfma_f32_32x32x16_bf16 v[64:79], v[56:59], v[232:235], v[64:79]
    ds_read_b64_tr_b16 v[48:49], v32 offset:16384
    ds_read_b64_tr_b16 v[50:51], v32 offset:16896
    ds_read_b64_tr_b16 v[52:53], v33 offset:16384
    ds_read_b64_tr_b16 v[54:55], v33 offset:16896
    v_mfma_f32_32x32x16_bf16 v[80:95], v[60:63], v[232:235], v[80:95]
    s_waitcnt lgkmcnt(4)
    v_mfma_f32_32x32x16_bf16 v[64:79], v[40:43], v[236:239], v[64:79]
    ds_read_b64_tr_b16 v[56:57], v32 offset:18432
    ds_read_b64_tr_b16 v[58:59], v32 offset:18944
    ds_read_b64_tr_b16 v[60:61], v33 offset:18432
    ds_read_b64_tr_b16 v[62:63], v33 offset:18944
    v_mfma_f32_32x32x16_bf16 v[80:95], v[44:47], v[236:239], v[80:95]
    s_waitcnt lgkmcnt(4)
    v_mfma_f32_32x32x16_bf16 v[64:79], v[48:51], v[240:243], v[64:79]
    ds_read_b64_tr_b16 v[40:41], v32 offset:20480
    ds_read_b64_tr_b16 v[42:43], v32 offset:20992
    ds_read_b64_tr_b16 v[44:45], v33 offset:20480
    ds_read_b64_tr_b16 v[46:47], v33 offset:20992
    v_mfma_f32_32x32x16_bf16 v[80:95], v[52:55], v[240:243], v[80:95]
    s_waitcnt lgkmcnt(4)
    v_mfma_f32_32x32x16_bf16 v[64:79], v[56:59], v[244:247], v[64:79]
    ds_read_b64_tr_b16 v[48:49], v32 offset:22528
    ds_read_b64_tr_b16 v[50:51], v32 offset:23040
    ds_read_b64_tr_b16 v[52:53], v33 offset:22528
    ds_read_b64_tr_b16 v[54:55], v33 offset:23040
    v_mfma_f32_32x32x16_bf16 v[80:95], v[60:63], v[244:247], v[80:95]
    s_waitcnt lgkmcnt(4)
    v_mfma_f32_32x32x16_bf16 v[64:79], v[40:43], v[248:251], v[64:79]
    v_mfma_f32_32x32x16_bf16 v[80:95], v[44:47], v[248:251], v[80:95]
    s_waitcnt lgkmcnt(0)
    s_waitcnt vmcnt(1)
    v_cmp_ne_u32 vcc, s42, v21
    s_waitcnt vmcnt(0)
    v_cmp_ne_u32 s[46:47], s42, v25
    s_nop 0
    s_or_b64 vcc, vcc, s[46:47]
    s_cbranch_scc1 L_st_20
L_sto_21:
    v_mfma_f32_32x32x16_bf16 v[64:79], v[48:51], v[252:255], v[64:79]
    v_mul_f32 v9, 0.5, v9
    v_cvt_pk_bf16_f32 v40, -v9, -v9
    v_mov_b32 v41, v40
    v_mov_b32 v42, 0
    v_mov_b32 v43, 0
    v_mov_b32 v58, 0
    v_mov_b32 v59, 0
    v_mov_b32 v62, 0
    v_mov_b32 v63, 0
    v_and_b32 v2, 0xffff0000, v20
    v_sub_f32 v3, v20, v2
    v_mfma_f32_32x32x16_bf16 v[80:95], v[52:55], v[252:255], v[80:95]
    v_and_b32 v4, 0xffff0000, v3
    v_sub_f32 v3, v3, v4
    v_cvt_pk_bf16_f32 v56, v2, v4
    v_cvt_pk_bf16_f32 v57, v3, 0
    v_and_b32 v2, 0xffff0000, v24
    v_sub_f32 v3, v24, v2
    v_and_b32 v4, 0xffff0000, v3
    v_sub_f32 v3, v3, v4
    v_cvt_pk_bf16_f32 v60, v2, v4
    v_cvt_pk_bf16_f32 v61, v3, 0
    v_mfma_f32_32x32x16_bf16 v[64:79], v[56:59], v[40:43], v[64:79]
    s_nop 0
    v_mfma_f32_32x32x16_bf16 v[80:95], v[60:63], v[40:43], v[80:95]
    s_nop 9
    v_pk_mul_f32 v[64:65], v[64:65], v[8:9] op_sel:[0,0] op_sel_hi:[1,0]
    v_pk_mul_f32 v[66:67], v[66:67], v[8:9] op_sel:[0,0] op_sel_hi:[1,0]
    v_pk_mul_f32 v[68:69], v[68:69], v[8:9] op_sel:[0,0] op_sel_hi:[1,0]
    v_pk_mul_f32 v[70:71], v[70:71], v[8:9] op_sel:[0,0] op_sel_hi:[1,0]
    v_pk_mul_f32 v[72:73], v[72:73], v[8:9] op_sel:[0,0] op_sel_hi:[1,0]
    v_pk_mul_f32 v[74:75], v[74:75], v[8:9] op_sel:[0,0] op_sel_hi:[1,0]
    v_pk_mul_f32 v[76:77], v[76:77], v[8:9] op_sel:[0,0] op_sel_hi:[1,0]
    v_pk_mul_f32 v[78:79], v[78:79], v[8:9] op_sel:[0,0] op_sel_hi:[1,0]
    v_cvt_pk_bf16_f32 v64, v64, v65
    v_cvt_pk_bf16_f32 v65, v66, v67
    v_cvt_pk_bf16_f32 v66, v68, v69
    v_cvt_pk_bf16_f32 v67, v70, v71
    v_cvt_pk_bf16_f32 v68, v72, v73
    v_cvt_pk_bf16_f32 v69, v74, v75
    v_cvt_pk_bf16_f32 v70, v76, v77
    v_cvt_pk_bf16_f32 v71, v78, v79
    v_permlane32_swap_b32 v64, v66
    v_permlane32_swap_b32 v65, v67
    v_permlane32_swap_b32 v68, v70
    v_permlane32_swap_b32 v69, v71
    buffer_store_dwordx4 v[64:67], v34, s[32:35], s79 offen offset:0 sc1
    buffer_store_dwordx4 v[68:71], v34, s[32:35], s79 offen offset:2048 sc1
    v_pk_mul_f32 v[80:81], v[80:81], v[8:9] op_sel:[0,0] op_sel_hi:[1,0]
    v_pk_mul_f32 v[82:83], v[82:83], v[8:9] op_sel:[0,0] op_sel_hi:[1,0]
    v_pk_mul_f32 v[84:85], v[84:85], v[8:9] op_sel:[0,0] op_sel_hi:[1,0]
    v_pk_mul_f32 v[86:87], v[86:87], v[8:9] op_sel:[0,0] op_sel_hi:[1,0]
    v_pk_mul_f32 v[88:89], v[88:89], v[8:9] op_sel:[0,0] op_sel_hi:[1,0]
    v_pk_mul_f32 v[90:91], v[90:91], v[8:9] op_sel:[0,0] op_sel_hi:[1,0]
    v_pk_mul_f32 v[92:93], v[92:93], v[8:9] op_sel:[0,0] op_sel_hi:[1,0]
    v_pk_mul_f32 v[94:95], v[94:95], v[8:9] op_sel:[0,0] op_sel_hi:[1,0]
    v_cvt_pk_bf16_f32 v80, v80, v81
    v_cvt_pk_bf16_f32 v81, v82, v83
    v_cvt_pk_bf16_f32 v82, v84, v85
    v_cvt_pk_bf16_f32 v83, v86, v87
    v_cvt_pk_bf16_f32 v84, v88, v89
    v_cvt_pk_bf16_f32 v85, v90, v91
    v_cvt_pk_bf16_f32 v86, v92, v93
    v_cvt_pk_bf16_f32 v87, v94, v95
    v_permlane32_swap_b32 v80, v82
    v_permlane32_swap_b32 v81, v83
    v_permlane32_swap_b32 v84, v86
    v_permlane32_swap_b32 v85, v87
    buffer_store_dwordx4 v[80:83], v34, s[32:35], s85 offen offset:0 sc1
    buffer_store_dwordx4 v[84:87], v34, s[32:35], s85 offen offset:2048 sc1
    s_branch L_c_p1_done
L_c_typew:
    v_and_b32 v2, 31, v1
    v_lshrrev_b32 v3, 5, v1
    v_bfe_u32 v4, v1, 1, 3
    v_xor_b32 v4, v4, v3
    v_lshlrev_b32 v4, 4, v4
    v_lshl_add_u32 v28, v2, 7, v4
    v_lshlrev_b32 v36, 4, v2
    v_lshl_add_u32 v34, v3, 10, v36
    v_lshlrev_b32 v35, 2, v2
    v_lshl_add_u32 v35, v3, 7, v35
    v_bfe_u32 v4, v1, 2, 2
    v_lshl_add_u32 v5, v3, 3, v4
    v_lshlrev_b32 v5, 7, v5
    v_lshrrev_b32 v4, 1, v4
    v_lshl_add_u32 v5, v4, 6, v5
    v_bfe_u32 v4, v1, 4, 1
    v_lshl_add_u32 v5, v4, 5, v5
    v_and_b32 v37, 3, v1
    v_lshl_add_u32 v32, v37, 3, v5
    v_and_b32 v37, 15, v1
    v_lshlrev_b32 v4, 2, v4
    v_cmp_eq_u32 vcc, v37, v4
    v_mov_b32 v37, 0x3f803f80
    s_nop 0
    v_cndmask_b32 v16, 0, v37, vcc
    v_cndmask_b32 v17, 0, v37, vcc
    v_cndmask_b32 v18, 0, v37, vcc
    v_cndmask_b32 v19, 0, v37, vcc
    s_lshr_b32 s75, s3, 1
    s_and_b32 s76, s3, 1
    s_lshl_b32 s66, s75, 13
    s_lshl_b32 s67, s76, 6
    v_xor_b32 v32, s67, v32
    v_add_u32 v32, s66, v32
    s_cmp_eq_u32 s75, 0
    s_cselect_b32 s74, s72, s73
    s_lshl_b32 s74, s74, 1
    s_add_u32 s74, s74, s76
    s_lshl_b32 s67, s70, 6
    s_add_u32 s67, s67, s74
    s_lshl_b32 s78, s67, 12
    s_add_u32 s84, s78, 512
    s_lshl_b32 s80, s70, 10
    s_add_u32 s80, s80, 22327296
    s_lshl_b32 s67, s74, 5
    s_add_u32 s67, s67, s70
    s_lshl_b32 s67, s67, 8
    s_add_u32 s82, s67, 20840448
    s_lshl_b32 s67, s71, 6
    s_add_u32 s67, s67, s74
    s_lshl_b32 s79, s67, 12
    s_add_u32 s85, s79, 512
    s_lshl_b32 s81, s71, 10
    s_add_u32 s81, s81, 22327296
L_pad3_1:
    s_cbranch_execz L_pad3_2
    s_lshl_b32 s67, s74, 5
    s_add_u32 s67, s67, s71
    s_lshl_b32 s67, s67, 8
    s_add_u32 s83, s67, 20840448
    v_lshrrev_b32 v37, 1, v36
    s_lshl_b32 s77, s74, 8
    s_add_u32 s77, s77, 22360064
    s_and_b32 s66, s70, 7
    s_cselect_b32 s77, 0x7f000000, s77
    v_xor_b32 v29, 32, v28
    v_xor_b32 v30, 64, v28
    v_xor_b32 v31, 96, v28
    v_xor_b32 v33, 64, v32
    s_setprio 1
    s_barrier
    ds_read_b64_tr_b16 v[96:97], v32 offset:8192
    ds_read_b64_tr_b16 v[98:99], v32 offset:8704
    ds_read_b128 v[40:43], v28 offset:0
    ds_read_b128 v[44:47], v28 offset:4096
    ds_read_b64_tr_b16 v[100:101], v32 offset:10240
    ds_read_b64_tr_b16 v[102:103], v32 offset:10752
    ds_read_b128 v[48:51], v29 offset:0
    ds_read_b128 v[52:55], v29 offset:4096
    s_waitcnt lgkmcnt(4)
    v_mfma_f32_16x16x32_bf16 v[20:23], v[16:19], v[96:99], 0
    v_mfma_f32_32x32x16_bf16 v[64:79], v[96:99], v[40:43], 0
    ds_read_b64_tr_b16 v[104:105], v32 offset:12288
    ds_read_b64_tr_b16 v[106:107], v32 offset:12800
    ds_read_b128 v[56:59], v30 offset:0
    ds_read_b128 v[60:63], v30 offset:4096
    v_mfma_f32_32x32x16_bf16 v[80:95], v[96:99], v[44:47], 0
    buffer_load_dwordx4 v[244:247], v6, s[8:11], 0 offen offset:0
    buffer_load_dwordx4 v[248:251], v6, s[8:11], 0 offen offset:512
    buffer_load_dwordx4 v[252:255], v7, s[8:11], 0 offen offset:1024
    v_mov_b32 v6, 0
    s_waitcnt lgkmcnt(4)
    v_mfma_f32_16x16x32_bf16 v[20:23], v[16:19], v[100:103], v[20:23]
    v_mfma_f32_32x32x16_bf16 v[64:79], v[100:103], v[48:51], v[64:79]
    ds_read_b64_tr_b16 v[108:109], v32 offset:14336
    ds_read_b64_tr_b16 v[110:111], v32 offset:14848
    ds_read_b128 v[40:43], v31 offset:0
    ds_read_b128 v[44:47], v31 offset:4096
    v_mfma_f32_32x32x16_bf16 v[80:95], v[100:103], v[52:55], v[80:95]
    s_waitcnt lgkmcnt(4)
    v_mfma_f32_16x16x32_bf16 v[20:23], v[16:19], v[104:107], v[20:23]
    v_mfma_f32_32x32x16_bf16 v[64:79], v[104:107], v[56:59], v[64:79]
    s_barrier
    ds_read_b64_tr_b16 v[112:113], v32 offset:32768
    ds_read_b64_tr_b16 v[114:115], v32 offset:33280
    ds_read_b128 v[48:51], v28 offset:24576
    ds_read_b128 v[52:55], v28 offset:28672
    v_mfma_f32_32x32x16_bf16 v[80:95], v[104:107], v[60:63], v[80:95]
    s_waitcnt lgkmcnt(4)
    v_mfma_f32_16x16x32_bf16 v[20:23], v[16:19], v[108:111], v[20:23]
    v_mfma_f32_32x32x16_bf16 v[64:79], v[108:111], v[40:43], v[64:79]
    ds_read_b64_tr_b16 v[116:117], v32 offset:34816
    ds_read_b64_tr_b16 v[118:119], v32 offset:35328
    ds_read_b128 v[56:59], v29 offset:24576
    ds_read_b128 v[60:63], v29 offset:28672
    v_mfma_f32_32x32x16_bf16 v[80:95], v[108:111], v[44:47], v[80:95]
    buffer_load_dword v7, v6, s[36:39], 0 offen sc1
    s_waitcnt lgkmcnt(4)
    v_mfma_f32_16x16x32_bf16 v[20:23], v[16:19], v[112:115], v[20:23]
    v_mfma_f32_32x32x16_bf16 v[64:79], v[112:115], v[48:51], v[64:79]
    ds_read_b64_tr_b16 v[120:121], v32 offset:36864
    ds_read_b64_tr_b16 v[122:123], v32 offset:37376
    ds_read_b128 v[40:43], v30 offset:24576
    ds_read_b128 v[44:47], v30 offset:28672
    v_mfma_f32_32x32x16_bf16 v[80:95], v[112:115], v[52:55], v[80:95]
    s_waitcnt lgkmcnt(4)
    v_mfma_f32_16x16x32_bf16 v[20:23], v[16:19], v[116:119], v[20:23]
    v_mfma_f32_32x32x16_bf16 v[64:79], v[116:119], v[56:59], v[64:79]
    ds_read_b64_tr_b16 v[124:125], v32 offset:38912
    ds_read_b64_tr_b16 v[126:127], v32 offset:39424
    ds_read_b128 v[48:51], v31 offset:24576
    ds_read_b128 v[52:55], v31 offset:28672
    v_mfma_f32_32x32x16_bf16 v[80:95], v[116:119], v[60:63], v[80:95]
    s_waitcnt lgkmcnt(4)
    v_mfma_f32_16x16x32_bf16 v[20:23], v[16:19], v[120:123], v[20:23]
    v_mfma_f32_32x32x16_bf16 v[64:79], v[120:123], v[40:43], v[64:79]
    s_barrier
    v_add_u32 v32, 57344, v32
    v_add_u32 v33, 57344, v33
    ds_read_b64_tr_b16 v[128:129], v32 offset:0
    ds_read_b64_tr_b16 v[130:131], v32 offset:512
    ds_read_b128 v[56:59], v28 offset:49152
    ds_read_b128 v[60:63], v28 offset:53248
    v_mfma_f32_32x32x16_bf16 v[80:95], v[120:123], v[44:47], v[80:95]
    s_waitcnt lgkmcnt(4)
    v_mfma_f32_16x16x32_bf16 v[20:23], v[16:19], v[124:127], v[20:23]
    v_mfma_f32_32x32x16_bf16 v[64:79], v[124:127], v[48:51], v[64:79]
    ds_read_b64_tr_b16 v[132:133], v32 offset:2048
    ds_read_b64_tr_b16 v[134:135], v32 offset:2560
    ds_read_b128 v[40:43], v29 offset:49152
    ds_read_b128 v[44:47], v29 offset:53248
    v_mfma_f32_32x32x16_bf16 v[80:95], v[124:127], v[52:55], v[80:95]
    s_waitcnt lgkmcnt(4)
    v_mfma_f32_16x16x32_bf16 v[20:23], v[16:19], v[128:131], v[20:23]
    v_mfma_f32_32x32x16_bf16 v[64:79], v[128:131], v[56:59], v[64:79]
    ds_read_b64_tr_b16 v[136:137], v32 offset:4096
    ds_read_b64_tr_b16 v[138:139], v32 offset:4608
    ds_read_b128 v[48:51], v30 offset:49152
    ds_read_b128 v[52:55], v30 offset:53248
    v_mfma_f32_32x32x16_bf16 v[80:95], v[128:131], v[60:63], v[80:95]
    s_waitcnt lgkmcnt(4)
    v_mfma_f32_16x16x32_bf16 v[20:23], v[16:19], v[132:135], v[20:23]
    v_mfma_f32_32x32x16_bf16 v[64:79], v[132:135], v[40:43], v[64:79]
    ds_read_b64_tr_b16 v[140:141], v32 offset:6144
    ds_read_b64_tr_b16 v[142:143], v32 offset:6656
    ds_read_b128 v[56:59], v31 offset:49152
    ds_read_b128 v[60:63], v31 offset:53248
    v_mfma_f32_32x32x16_bf16 v[80:95], v[132:135], v[44:47], v[80:95]
    s_waitcnt lgkmcnt(4)
    v_mfma_f32_16x16x32_bf16 v[20:23], v[16:19], v[136:139], v[20:23]
    v_mfma_f32_32x32x16_bf16 v[64:79], v[136:139], v[48:51], v[64:79]
    v_mov_b32 v4, 0x3f803f80
    s_waitcnt vmcnt(3)
    v_dot2_f32_bf16 v2, v244, v4, 0
    v_dot2_f32_bf16 v3, v244, v244, 0
    v_dot2_f32_bf16 v2, v245, v4, v2
    v_dot2_f32_bf16 v3, v245, v245, v3
    v_dot2_f32_bf16 v2, v246, v4, v2
    v_dot2_f32_bf16 v3, v246, v246, v3
    v_dot2_f32_bf16 v2, v247, v4, v2
    v_dot2_f32_bf16 v3, v247, v247, v3
    s_waitcnt vmcnt(2)
    v_dot2_f32_bf16 v2, v248, v4, v2
    v_dot2_f32_bf16 v3, v248, v248, v3
    v_dot2_f32_bf16 v2, v249, v4, v2
    v_dot2_f32_bf16 v3, v249, v249, v3
    v_dot2_f32_bf16 v2, v250, v4, v2
    v_dot2_f32_bf16 v3, v250, v250, v3
    v_dot2_f32_bf16 v2, v251, v4, v2
    v_dot2_f32_bf16 v3, v251, v251, v3
    s_waitcnt vmcnt(1)
    v_dot2_f32_bf16 v2, v252, v4, v2
    v_dot2_f32_bf16 v3, v252, v252, v3
    v_dot2_f32_bf16 v2, v253, v4, v2
    v_dot2_f32_bf16 v3, v253, v253, v3
    v_dot2_f32_bf16 v2, v254, v4, v2
    v_dot2_f32_bf16 v3, v254, v254, v3
    v_dot2_f32_bf16 v2, v255, v4, v2
    v_dot2_f32_bf16 v3, v255, v255, v3
    s_nop 1
    v_add_f32_dpp v2, v2, v2 row_ror:8 row_mask:0xf bank_mask:0xf
    v_add_f32_dpp v3, v3, v3 row_ror:8 row_mask:0xf bank_mask:0xf
    s_nop 0
    v_add_f32_dpp v2, v2, v2 row_ror:4 row_mask:0xf bank_mask:0xf
    v_add_f32_dpp v3, v3, v3 row_ror:4 row_mask:0xf bank_mask:0xf
    s_nop 0
    v_add_f32_dpp v2, v2, v2 row_ror:2 row_mask:0xf bank_mask:0xf
    v_add_f32_dpp v3, v3, v3 row_ror:2 row_mask:0xf bank_mask:0xf
    s_nop 0
    v_add_f32_dpp v2, v2, v2 row_ror:1 row_mask:0xf bank_mask:0xf
    v_add_f32_dpp v3, v3, v3 row_ror:1 row_mask:0xf bank_mask:0xf
    v_mov_b32 v4, v2
    v_mov_b32 v5, v3
    s_nop 0
    v_permlane16_swap_b32 v2, v4
    v_permlane16_swap_b32 v3, v5
    v_add_f32 v2, v2, v4
    v_add_f32 v3, v3, v5
    v_mul_f32 v9, 0x3acccccd, v2
    v_mul_f32 v4, 0x3acccccd, v3
    v_fma_f32 v4, -v9, v9, v4
    v_max_f32 v4, 0, v4
    v_cvt_pk_bf16_f32 v4, v4, v4
    v_and_b32 v4, 0xffff0000, v4
    v_add_f32 v4, 0x3727c5ac, v4
    v_cvt_pk_bf16_f32 v4, v4, v4
    v_and_b32 v4, 0xffff0000, v4
    v_sqrt_f32 v4, v4
    s_nop 0
    v_cvt_pk_bf16_f32 v4, v4, v4
    v_and_b32 v4, 0xffff0000, v4
    v_rcp_f32 v8, v4
    v_cvt_pk_bf16_f32 v9, v9, v9
    v_and_b32 v9, 0xffff0000, v9
    s_barrier
    ds_read_b64_tr_b16 v[144:145], v32 offset:24576
    ds_read_b64_tr_b16 v[146:147], v32 offset:25088
    v_add_u32 v28, 57344, v28
    v_add_u32 v29, 57344, v29
    v_add_u32 v30, 57344, v30
    v_add_u32 v31, 57344, v31
    ds_read_b128 v[40:43], v28 offset:16384
    ds_read_b128 v[44:47], v28 offset:20480
    v_mfma_f32_32x32x16_bf16 v[80:95], v[136:139], v[52:55], v[80:95]
    s_waitcnt lgkmcnt(4)
    v_mfma_f32_16x16x32_bf16 v[20:23], v[16:19], v[140:143], v[20:23]
    v_mfma_f32_32x32x16_bf16 v[64:79], v[140:143], v[56:59], v[64:79]
    ds_read_b64_tr_b16 v[148:149], v32 offset:26624
    ds_read_b64_tr_b16 v[150:151], v32 offset:27136
    ds_read_b128 v[48:51], v29 offset:16384
    ds_read_b128 v[52:55], v29 offset:20480
    v_mfma_f32_32x32x16_bf16 v[80:95], v[140:143], v[60:63], v[80:95]
    s_waitcnt vmcnt(0)
    v_readfirstlane_b32 s42, v7
    s_nop 0
    s_cmp_eq_u32 s42, 0
    s_cbranch_scc1 L_nz_22
L_nzb_23:
    s_mov_b32 s46, 22327296
    v_mov_b32 v10, s42
    v_mov_b32 v11, s42
    s_mov_b32 exec_lo, 1
    s_mov_b32 exec_hi, 1
    buffer_store_dwordx4 v[8:11], v12, s[32:35], s46 offen sc1
    s_mov_b64 exec, -1
    s_waitcnt lgkmcnt(4)
    v_mfma_f32_16x16x32_bf16 v[20:23], v[16:19], v[144:147], v[20:23]
    v_mfma_f32_32x32x16_bf16 v[64:79], v[144:147], v[40:43], v[64:79]
    ds_read_b64_tr_b16 v[152:153], v32 offset:28672
    ds_read_b64_tr_b16 v[154:155], v32 offset:29184
    ds_read_b128 v[56:59], v30 offset:16384
    ds_read_b128 v[60:63], v30 offset:20480
    v_mfma_f32_32x32x16_bf16 v[80:95], v[144:147], v[44:47], v[80:95]
    s_waitcnt lgkmcnt(4)
    v_mfma_f32_16x16x32_bf16 v[20:23], v[16:19], v[148:151], v[20:23]
    v_mfma_f32_32x32x16_bf16 v[64:79], v[148:151], v[48:51], v[64:79]
    ds_read_b64_tr_b16 v[156:157], v32 offset:30720
    ds_read_b64_tr_b16 v[158:159], v32 offset:31232
    ds_read_b128 v[40:43], v31 offset:16384
    ds_read_b128 v[44:47], v31 offset:20480
    v_mfma_f32_32x32x16_bf16 v[80:95], v[148:151], v[52:55], v[80:95]
    s_waitcnt lgkmcnt(4)
    v_mfma_f32_16x16x32_bf16 v[20:23], v[16:19], v[152:155], v[20:23]
    v_mfma_f32_32x32x16_bf16 v[64:79], v[152:155], v[56:59], v[64:79]
    s_barrier
    ds_read_b64_tr_b16 v[160:161], v32 offset:49152
    ds_read_b64_tr_b16 v[162:163], v32 offset:49664
    ds_read_b128 v[48:51], v28 offset:40960
    ds_read_b128 v[52:55], v28 offset:45056
    v_mfma_f32_32x32x16_bf16 v[80:95], v[152:155], v[60:63], v[80:95]
    s_waitcnt lgkmcnt(4)
    v_mfma_f32_16x16x32_bf16 v[20:23], v[16:19], v[156:159], v[20:23]
    v_mfma_f32_32x32x16_bf16 v[64:79], v[156:159], v[40:43], v[64:79]
    ds_read_b64_tr_b16 v[164:165], v32 offset:51200
    ds_read_b64_tr_b16 v[166:167], v32 offset:51712
    ds_read_b128 v[56:59], v29 offset:40960
    ds_read_b128 v[60:63], v29 offset:45056
    v_mfma_f32_32x32x16_bf16 v[80:95], v[156:159], v[44:47], v[80:95]
    s_waitcnt lgkmcnt(4)
    v_mfma_f32_16x16x32_bf16 v[20:23], v[16:19], v[160:163], v[20:23]
    v_mfma_f32_32x32x16_bf16 v[64:79], v[160:163], v[48:51], v[64:79]
    ds_read_b64_tr_b16 v[168:169], v32 offset:53248
    ds_read_b64_tr_b16 v[170:171], v32 offset:53760
    ds_read_b128 v[40:43], v30 offset:40960
    ds_read_b128 v[44:47], v30 offset:45056
    v_mfma_f32_32x32x16_bf16 v[80:95], v[160:163], v[52:55], v[80:95]
    s_waitcnt lgkmcnt(4)
    v_mfma_f32_16x16x32_bf16 v[20:23], v[16:19], v[164:167], v[20:23]
    v_mfma_f32_32x32x16_bf16 v[64:79], v[164:167], v[56:59], v[64:79]
    ds_read_b64_tr_b16 v[172:173], v32 offset:55296
    ds_read_b64_tr_b16 v[174:175], v32 offset:55808
    ds_read_b128 v[48:51], v31 offset:40960
    ds_read_b128 v[52:55], v31 offset:45056
    v_mfma_f32_32x32x16_bf16 v[80:95], v[164:167], v[60:63], v[80:95]
    s_waitcnt lgkmcnt(4)
    v_mfma_f32_16x16x32_bf16 v[20:23], v[16:19], v[168:171], v[20:23]
    v_mfma_f32_32x32x16_bf16 v[64:79], v[168:171], v[40:43], v[64:79]
    s_barrier
    v_subrev_u32 v32, 57344, v32
    v_subrev_u32 v33, 57344, v33
    ds_read_b64_tr_b16 v[176:177], v32 offset:8192
    ds_read_b64_tr_b16 v[178:179], v32 offset:8704
    v_subrev_u32 v28, 57344, v28
    v_subrev_u32 v29, 57344, v29
    v_subrev_u32 v30, 57344, v30
    v_subrev_u32 v31, 57344, v31
    ds_read_b128 v[56:59], v28 offset:0
    ds_read_b128 v[60:63], v28 offset:4096
    v_mfma_f32_32x32x16_bf16 v[80:95], v[168:171], v[44:47], v[80:95]
    s_waitcnt lgkmcnt(4)
    v_mfma_f32_16x16x32_bf16 v[20:23], v[16:19], v[172:175], v[20:23]
    v_mfma_f32_32x32x16_bf16 v[64:79], v[172:175], v[48:51], v[64:79]
    ds_read_b64_tr_b16 v[180:181], v32 offset:10240
    ds_read_b64_tr_b16 v[182:183], v32 offset:10752
    ds_read_b128 v[40:43], v29 offset:0
    ds_read_b128 v[44:47], v29 offset:4096
    v_mfma_f32_32x32x16_bf16 v[80:95], v[172:175], v[52:55], v[80:95]
    s_waitcnt lgkmcnt(4)
    v_mfma_f32_16x16x32_bf16 v[20:23], v[16:19], v[176:179], v[20:23]
    v_mfma_f32_32x32x16_bf16 v[64:79], v[176:179], v[56:59], v[64:79]
    ds_read_b64_tr_b16 v[184:185], v32 offset:12288
    ds_read_b64_tr_b16 v[186:187], v32 offset:12800
    ds_read_b128 v[48:51], v30 offset:0
    ds_read_b128 v[52:55], v30 offset:4096
    v_mfma_f32_32x32x16_bf16 v[80:95], v[176:179], v[60:63], v[80:95]
    s_waitcnt lgkmcnt(4)
    v_mfma_f32_16x16x32_bf16 v[20:23], v[16:19], v[180:183], v[20:23]
    v_mfma_f32_32x32x16_bf16 v[64:79], v[180:183], v[40:43], v[64:79]
    ds_read_b64_tr_b16 v[188:189], v32 offset:14336
    ds_read_b64_tr_b16 v[190:191], v32 offset:14848
    ds_read_b128 v[56:59], v31 offset:0
    ds_read_b128 v[60:63], v31 offset:4096
    v_mfma_f32_32x32x16_bf16 v[80:95], v[180:183], v[44:47], v[80:95]
    s_waitcnt lgkmcnt(4)
    v_mfma_f32_16x16x32_bf16 v[20:23], v[16:19], v[184:187], v[20:23]
    v_mfma_f32_32x32x16_bf16 v[64:79], v[184:187], v[48:51], v[64:79]
    s_barrier
    ds_read_b64_tr_b16 v[192:193], v32 offset:32768
    ds_read_b64_tr_b16 v[194:195], v32 offset:33280
    ds_read_b128 v[40:43], v28 offset:24576
    ds_read_b128 v[44:47], v28 offset:28672
    v_mfma_f32_32x32x16_bf16 v[80:95], v[184:187], v[52:55], v[80:95]
    s_waitcnt lgkmcnt(4)
    v_mfma_f32_16x16x32_bf16 v[20:23], v[16:19], v[188:191], v[20:23]
    v_mfma_f32_32x32x16_bf16 v[64:79], v[188:191], v[56:59], v[64:79]
    ds_read_b64_tr_b16 v[196:197], v32 offset:34816
    ds_read_b64_tr_b16 v[198:199], v32 offset:35328
    ds_read_b128 v[48:51], v29 offset:24576
    ds_read_b128 v[52:55], v29 offset:28672
    v_mfma_f32_32x32x16_bf16 v[80:95], v[188:191], v[60:63], v[80:95]
    s_waitcnt lgkmcnt(4)
    v_mfma_f32_16x16x32_bf16 v[20:23], v[16:19], v[192:195], v[20:23]
    v_mfma_f32_32x32x16_bf16 v[64:79], v[192:195], v[40:43], v[64:79]
    ds_read_b64_tr_b16 v[200:201], v32 offset:36864
    ds_read_b64_tr_b16 v[202:203], v32 offset:37376
    ds_read_b128 v[56:59], v30 offset:24576
    ds_read_b128 v[60:63], v30 offset:28672
    v_mfma_f32_32x32x16_bf16 v[80:95], v[192:195], v[44:47], v[80:95]
    s_waitcnt lgkmcnt(4)
    v_mfma_f32_16x16x32_bf16 v[20:23], v[16:19], v[196:199], v[20:23]
    v_mfma_f32_32x32x16_bf16 v[64:79], v[196:199], v[48:51], v[64:79]
    ds_read_b64_tr_b16 v[204:205], v32 offset:38912
    ds_read_b64_tr_b16 v[206:207], v32 offset:39424
    ds_read_b128 v[40:43], v31 offset:24576
    ds_read_b128 v[44:47], v31 offset:28672
    v_mfma_f32_32x32x16_bf16 v[80:95], v[196:199], v[52:55], v[80:95]
    s_waitcnt lgkmcnt(4)
    v_mfma_f32_16x16x32_bf16 v[20:23], v[16:19], v[200:203], v[20:23]
    v_mfma_f32_32x32x16_bf16 v[64:79], v[200:203], v[56:59], v[64:79]
    s_barrier
    v_add_u32 v32, 57344, v32
    v_add_u32 v33, 57344, v33
    ds_read_b64_tr_b16 v[208:209], v32 offset:0
    ds_read_b64_tr_b16 v[210:211], v32 offset:512
    ds_read_b128 v[48:51], v28 offset:49152
    ds_read_b128 v[52:55], v28 offset:53248
    v_mfma_f32_32x32x16_bf16 v[80:95], v[200:203], v[60:63], v[80:95]
    s_waitcnt lgkmcnt(4)
    v_mfma_f32_16x16x32_bf16 v[20:23], v[16:19], v[204:207], v[20:23]
    v_mfma_f32_32x32x16_bf16 v[64:79], v[204:207], v[40:43], v[64:79]
    ds_read_b64_tr_b16 v[212:213], v32 offset:2048
    ds_read_b64_tr_b16 v[214:215], v32 offset:2560
    ds_read_b128 v[56:59], v29 offset:49152
    ds_read_b128 v[60:63], v29 offset:53248
    v_mfma_f32_32x32x16_bf16 v[80:95], v[204:207], v[44:47], v[80:95]
    s_waitcnt lgkmcnt(4)
    v_mfma_f32_16x16x32_bf16 v[20:23], v[16:19], v[208:211], v[20:23]
    v_mfma_f32_32x32x16_bf16 v[64:79], v[208:211], v[48:51], v[64:79]
    ds_read_b64_tr_b16 v[216:217], v32 offset:4096
    ds_read_b64_tr_b16 v[218:219], v32 offset:4608
    ds_read_b128 v[40:43], v30 offset:49152
    ds_read_b128 v[44:47], v30 offset:53248
    v_mfma_f32_32x32x16_bf16 v[80:95], v[208:211], v[52:55], v[80:95]
    s_waitcnt lgkmcnt(4)
    v_mfma_f32_16x16x32_bf16 v[20:23], v[16:19], v[212:215], v[20:23]
    v_mfma_f32_32x32x16_bf16 v[64:79], v[212:215], v[56:59], v[64:79]
    ds_read_b64_tr_b16 v[220:221], v32 offset:6144
    ds_read_b64_tr_b16 v[222:223], v32 offset:6656
    ds_read_b128 v[48:51], v31 offset:49152
    ds_read_b128 v[52:55], v31 offset:53248
    v_mfma_f32_32x32x16_bf16 v[80:95], v[212:215], v[60:63], v[80:95]
    s_waitcnt lgkmcnt(4)
    v_mfma_f32_16x16x32_bf16 v[20:23], v[16:19], v[216:219], v[20:23]
    v_mfma_f32_32x32x16_bf16 v[64:79], v[216:219], v[40:43], v[64:79]
    s_barrier
    ds_read_b64_tr_b16 v[224:225], v32 offset:24576
    ds_read_b64_tr_b16 v[226:227], v32 offset:25088
    v_add_u32 v28, 57344, v28
    v_add_u32 v29, 57344, v29
    v_add_u32 v30, 57344, v30
    v_add_u32 v31, 57344, v31
    ds_read_b128 v[56:59], v28 offset:16384
    ds_read_b128 v[60:63], v28 offset:20480
    v_mfma_f32_32x32x16_bf16 v[80:95], v[216:219], v[44:47], v[80:95]
    buffer_load_dwordx4 v[8:11], v36, s[32:35], s80 offen offset:0 sc1
    buffer_load_dwordx4 v[12:15], v36, s[32:35], s80 offen offset:512 sc1
    s_waitcnt lgkmcnt(4)
    v_mfma_f32_16x16x32_bf16 v[20:23], v[16:19], v[220:223], v[20:23]
    v_mfma_f32_32x32x16_bf16 v[64:79], v[220:223], v[48:51], v[64:79]
    ds_read_b64_tr_b16 v[228:229], v32 offset:26624
    ds_read_b64_tr_b16 v[230:231], v32 offset:27136
    ds_read_b128 v[40:43], v29 offset:16384
    ds_read_b128 v[44:47], v29 offset:20480
    v_mfma_f32_32x32x16_bf16 v[80:95], v[220:223], v[52:55], v[80:95]
    s_waitcnt lgkmcnt(4)
    v_mfma_f32_16x16x32_bf16 v[20:23], v[16:19], v[224:227], v[20:23]
    v_mfma_f32_32x32x16_bf16 v[64:79], v[224:227], v[56:59], v[64:79]
    ds_read_b64_tr_b16 v[232:233], v32 offset:28672
    ds_read_b64_tr_b16 v[234:235], v32 offset:29184
    ds_read_b128 v[48:51], v30 offset:16384
    ds_read_b128 v[52:55], v30 offset:20480
    v_mfma_f32_32x32x16_bf16 v[80:95], v[224:227], v[60:63], v[80:95]
    s_waitcnt lgkmcnt(4)
    v_mfma_f32_16x16x32_bf16 v[20:23], v[16:19], v[228:231], v[20:23]
    v_mfma_f32_32x32x16_bf16 v[64:79], v[228:231], v[40:43], v[64:79]
    ds_read_b64_tr_b16 v[236:237], v32 offset:30720
    ds_read_b64_tr_b16 v[238:239], v32 offset:31232
    ds_read_b128 v[56:59], v31 offset:16384
    ds_read_b128 v[60:63], v31 offset:20480
    v_mfma_f32_32x32x16_bf16 v[80:95], v[228:231], v[44:47], v[80:95]
    s_waitcnt lgkmcnt(4)
    v_mfma_f32_16x16x32_bf16 v[20:23], v[16:19], v[232:235], v[20:23]
    v_mfma_f32_32x32x16_bf16 v[64:79], v[232:235], v[48:51], v[64:79]
    s_barrier
    ds_read_b64_tr_b16 v[240:241], v32 offset:49152
    ds_read_b64_tr_b16 v[242:243], v32 offset:49664
    ds_read_b128 v[40:43], v28 offset:40960
    ds_read_b128 v[44:47], v28 offset:45056
    v_mfma_f32_32x32x16_bf16 v[80:95], v[232:235], v[52:55], v[80:95]
    s_waitcnt lgkmcnt(4)
    v_mfma_f32_16x16x32_bf16 v[20:23], v[16:19], v[236:239], v[20:23]
    v_mfma_f32_32x32x16_bf16 v[64:79], v[236:239], v[56:59], v[64:79]
    ds_read_b64_tr_b16 v[244:245], v32 offset:51200
    ds_read_b64_tr_b16 v[246:247], v32 offset:51712
    ds_read_b128 v[48:51], v29 offset:40960
    ds_read_b128 v[52:55], v29 offset:45056
    v_mfma_f32_32x32x16_bf16 v[80:95], v[236:239], v[60:63], v[80:95]
    s_waitcnt lgkmcnt(4)
    v_mfma_f32_16x16x32_bf16 v[20:23], v[16:19], v[240:243], v[20:23]
    v_mfma_f32_32x32x16_bf16 v[64:79], v[240:243], v[40:43], v[64:79]
    ds_read_b64_tr_b16 v[248:249], v32 offset:53248
    ds_read_b64_tr_b16 v[250:251], v32 offset:53760
    ds_read_b128 v[56:59], v30 offset:40960
    ds_read_b128 v[60:63], v30 offset:45056
    v_mfma_f32_32x32x16_bf16 v[80:95], v[240:243], v[44:47], v[80:95]
    s_waitcnt lgkmcnt(4)
    v_mfma_f32_16x16x32_bf16 v[20:23], v[16:19], v[244:247], v[20:23]
    v_mfma_f32_32x32x16_bf16 v[64:79], v[244:247], v[48:51], v[64:79]
    ds_read_b64_tr_b16 v[252:253], v32 offset:55296
    ds_read_b64_tr_b16 v[254:255], v32 offset:55808
    ds_read_b128 v[40:43], v31 offset:40960
    ds_read_b128 v[44:47], v31 offset:45056
    v_mfma_f32_32x32x16_bf16 v[80:95], v[244:247], v[52:55], v[80:95]
    s_waitcnt lgkmcnt(4)
    v_mfma_f32_16x16x32_bf16 v[20:23], v[16:19], v[248:251], v[20:23]
    v_mfma_f32_32x32x16_bf16 v[64:79], v[248:251], v[56:59], v[64:79]
    v_mfma_f32_32x32x16_bf16 v[80:95], v[248:251], v[60:63], v[80:95]
    s_waitcnt lgkmcnt(0)
    s_waitcnt vmcnt(1)
    v_cmp_ne_u32 vcc, s42, v10
    s_waitcnt vmcnt(0)
    v_cmp_ne_u32 s[46:47], s42, v14
    s_nop 0
    s_or_b64 vcc, vcc, s[46:47]
    s_cbranch_scc1 L_st_24
L_sto_25:
    v_mfma_f32_16x16x32_bf16 v[20:23], v[16:19], v[252:255], v[20:23]
    v_mfma_f32_32x32x16_bf16 v[64:79], v[252:255], v[40:43], v[64:79]
    v_cvt_pk_bf16_f32 v56, -v9, -v9
    v_mov_b32 v57, v56
    v_mov_b32 v58, 0
    v_mov_b32 v59, 0
    v_cvt_pk_bf16_f32 v60, -v13, -v13
    v_mov_b32 v61, v60
    v_mfma_f32_32x32x16_bf16 v[80:95], v[252:255], v[44:47], v[80:95]
    v_mov_b32 v62, 0
    v_mov_b32 v63, 0
    v_mov_b32 v50, 0
    v_mov_b32 v51, 0
    v_and_b32 v2, 0xffff0000, v20
    v_sub_f32 v3, v20, v2
    v_and_b32 v4, 0xffff0000, v3
    v_sub_f32 v3, v3, v4
    v_cvt_pk_bf16_f32 v48, v2, v4
    v_cvt_pk_bf16_f32 v49, v3, 0
    s_nop 1
    v_mfma_f32_32x32x16_bf16 v[64:79], v[48:51], v[56:59], v[64:79]
    v_mfma_f32_32x32x16_bf16 v[80:95], v[48:51], v[60:63], v[80:95]
    s_nop 10
    v_pk_mul_f32 v[64:65], v[64:65], v[8:9] op_sel:[0,0] op_sel_hi:[1,0]
    v_pk_mul_f32 v[66:67], v[66:67], v[8:9] op_sel:[0,0] op_sel_hi:[1,0]
    v_pk_mul_f32 v[68:69], v[68:69], v[8:9] op_sel:[0,0] op_sel_hi:[1,0]
    v_pk_mul_f32 v[70:71], v[70:71], v[8:9] op_sel:[0,0] op_sel_hi:[1,0]
    v_pk_mul_f32 v[72:73], v[72:73], v[8:9] op_sel:[0,0] op_sel_hi:[1,0]
    v_pk_mul_f32 v[74:75], v[74:75], v[8:9] op_sel:[0,0] op_sel_hi:[1,0]
    v_pk_mul_f32 v[76:77], v[76:77], v[8:9] op_sel:[0,0] op_sel_hi:[1,0]
    v_pk_mul_f32 v[78:79], v[78:79], v[8:9] op_sel:[0,0] op_sel_hi:[1,0]
    v_cvt_pk_bf16_f32 v64, v64, v65
    v_cvt_pk_bf16_f32 v65, v66, v67
    v_cvt_pk_bf16_f32 v66, v68, v69
    v_cvt_pk_bf16_f32 v67, v70, v71
    v_cvt_pk_bf16_f32 v68, v72, v73
    v_cvt_pk_bf16_f32 v69, v74, v75
    v_cvt_pk_bf16_f32 v70, v76, v77
    v_cvt_pk_bf16_f32 v71, v78, v79
    v_permlane32_swap_b32 v64, v66
    v_permlane32_swap_b32 v65, v67
    v_permlane32_swap_b32 v68, v70
    v_permlane32_swap_b32 v69, v71
    buffer_store_dwordx4 v[64:67], v34, s[32:35], s78 offen offset:0 sc1
    buffer_store_dwordx4 v[68:71], v34, s[32:35], s78 offen offset:2048 sc1
    v_pk_mul_f32 v[80:81], v[80:81], v[12:13] op_sel:[0,0] op_sel_hi:[1,0]
    v_pk_mul_f32 v[82:83], v[82:83], v[12:13] op_sel:[0,0] op_sel_hi:[1,0]
    v_pk_mul_f32 v[84:85], v[84:85], v[12:13] op_sel:[0,0] op_sel_hi:[1,0]
    v_pk_mul_f32 v[86:87], v[86:87], v[12:13] op_sel:[0,0] op_sel_hi:[1,0]
    v_pk_mul_f32 v[88:89], v[88:89], v[12:13] op_sel:[0,0] op_sel_hi:[1,0]
    v_pk_mul_f32 v[90:91], v[90:91], v[12:13] op_sel:[0,0] op_sel_hi:[1,0]
    v_pk_mul_f32 v[92:93], v[92:93], v[12:13] op_sel:[0,0] op_sel_hi:[1,0]
    v_pk_mul_f32 v[94:95], v[94:95], v[12:13] op_sel:[0,0] op_sel_hi:[1,0]
    v_cvt_pk_bf16_f32 v80, v80, v81
    v_cvt_pk_bf16_f32 v81, v82, v83
    v_cvt_pk_bf16_f32 v82, v84, v85
    v_cvt_pk_bf16_f32 v83, v86, v87
    v_cvt_pk_bf16_f32 v84, v88, v89
    v_cvt_pk_bf16_f32 v85, v90, v91
    v_cvt_pk_bf16_f32 v86, v92, v93
    v_cvt_pk_bf16_f32 v87, v94, v95
    v_permlane32_swap_b32 v80, v82
    v_permlane32_swap_b32 v81, v83
    v_permlane32_swap_b32 v84, v86
    v_permlane32_swap_b32 v85, v87
    buffer_store_dwordx4 v[80:83], v34, s[32:35], s84 offen offset:0 sc1
    buffer_store_dwordx4 v[84:87], v34, s[32:35], s84 offen offset:2048 sc1
    v_mov_b32 v21, s42
    s_mov_b32 exec_hi, 0
    buffer_store_dwordx2 v[20:21], v37, s[32:35], s77 offen sc1
    s_mov_b32 exec_hi, -1
    s_barrier
    v_subrev_u32 v28, 57344, v28
    v_subrev_u32 v29, 57344, v29
    v_subrev_u32 v30, 57344, v30
    v_subrev_u32 v31, 57344, v31
    ds_read_b128 v[48:51], v28 offset:0
    ds_read_b128 v[52:55], v28 offset:4096
    ds_read_b128 v[56:59], v29 offset:0
    ds_read_b128 v[60:63], v29 offset:4096
    s_waitcnt lgkmcnt(2)
    v_mfma_f32_32x32x16_bf16 v[64:79], v[96:99], v[48:51], 0
    ds_read_b128 v[40:43], v30 offset:0
    ds_read_b128 v[44:47], v30 offset:4096
    v_mfma_f32_32x32x16_bf16 v[80:95], v[96:99], v[52:55], 0
    s_waitcnt lgkmcnt(2)
    v_mfma_f32_32x32x16_bf16 v[64:79], v[100:103], v[56:59], v[64:79]
    ds_read_b128 v[48:51], v31 offset:0
    ds_read_b128 v[52:55], v31 offset:4096
    v_mfma_f32_32x32x16_bf16 v[80:95], v[100:103], v[60:63], v[80:95]
    s_waitcnt lgkmcnt(2)
    v_mfma_f32_32x32x16_bf16 v[64:79], v[104:107], v[40:43], v[64:79]
    ds_read_b128 v[56:59], v28 offset:8192
    ds_read_b128 v[60:63], v28 offset:12288
    v_mfma_f32_32x32x16_bf16 v[80:95], v[104:107], v[44:47], v[80:95]
    s_waitcnt lgkmcnt(2)
    v_mfma_f32_32x32x16_bf16 v[64:79], v[108:111], v[48:51], v[64:79]
    ds_read_b128 v[40:43], v29 offset:8192
    ds_read_b128 v[44:47], v29 offset:12288
    v_mfma_f32_32x32x16_bf16 v[80:95], v[108:111], v[52:55], v[80:95]
    s_waitcnt lgkmcnt(2)
    v_mfma_f32_32x32x16_bf16 v[64:79], v[112:115], v[56:59], v[64:79]
    ds_read_b128 v[48:51], v30 offset:8192
    ds_read_b128 v[52:55], v30 offset:12288
    v_mfma_f32_32x32x16_bf16 v[80:95], v[112:115], v[60:63], v[80:95]
    s_waitcnt lgkmcnt(2)
    v_mfma_f32_32x32x16_bf16 v[64:79], v[116:119], v[40:43], v[64:79]
    ds_read_b128 v[56:59], v31 offset:8192
    ds_read_b128 v[60:63], v31 offset:12288
    v_mfma_f32_32x32x16_bf16 v[80:95], v[116:119], v[44:47], v[80:95]
    s_waitcnt lgkmcnt(2)
    v_mfma_f32_32x32x16_bf16 v[64:79], v[120:123], v[48:51], v[64:79]
    ds_read_b128 v[40:43], v28 offset:16384
    ds_read_b128 v[44:47], v28 offset:20480
    v_mfma_f32_32x32x16_bf16 v[80:95], v[120:123], v[52:55], v[80:95]
    s_waitcnt lgkmcnt(2)
    v_mfma_f32_32x32x16_bf16 v[64:79], v[124:127], v[56:59], v[64:79]
    ds_read_b128 v[48:51], v29 offset:16384
    ds_read_b128 v[52:55], v29 offset:20480
    v_mfma_f32_32x32x16_bf16 v[80:95], v[124:127], v[60:63], v[80:95]
    s_waitcnt lgkmcnt(2)
    v_mfma_f32_32x32x16_bf16 v[64:79], v[128:131], v[40:43], v[64:79]
    ds_read_b128 v[56:59], v30 offset:16384
    ds_read_b128 v[60:63], v30 offset:20480
    v_mfma_f32_32x32x16_bf16 v[80:95], v[128:131], v[44:47], v[80:95]
    s_waitcnt lgkmcnt(2)
    v_mfma_f32_32x32x16_bf16 v[64:79], v[132:135], v[48:51], v[64:79]
    ds_read_b128 v[40:43], v31 offset:16384
L_pad3_2:
    s_cbranch_execz L_chain3_ret
    ds_read_b128 v[44:47], v31 offset:20480
    v_mfma_f32_32x32x16_bf16 v[80:95], v[132:135], v[52:55], v[80:95]
    s_lshr_b32 s66, s41, 3
    s_lshl_b32 s52, s40, 2
    s_add_u32 s52, s52, s66
    s_mov_b32 s43, s52
    s_and_b32 s51, s41, 7
    s_waitcnt lgkmcnt(2)
    v_mfma_f32_32x32x16_bf16 v[64:79], v[136:139], v[56:59], v[64:79]
    s_barrier
    ds_read_b128 v[48:51], v28 offset:24576
    ds_read_b128 v[52:55], v28 offset:28672
    v_mfma_f32_32x32x16_bf16 v[80:95], v[136:139], v[60:63], v[80:95]
    s_mov_b32 s45, s51
    s_and_b32 s48, s43, 1
    s_lshr_b32 s66, s43, 1
    s_mul_i32 s66, s66, 5
    s_lshl_b32 s67, s48, 1
    s_waitcnt lgkmcnt(2)
    v_mfma_f32_32x32x16_bf16 v[64:79], v[140:143], v[40:43], v[64:79]
    ds_read_b128 v[56:59], v29 offset:24576
    ds_read_b128 v[60:63], v29 offset:28672
    v_mfma_f32_32x32x16_bf16 v[80:95], v[140:143], v[44:47], v[80:95]
    s_add_u32 s49, s66, s67
    s_lshl_b32 s50, s45, 2
    s_add_u32 s50, s50, s3
    s_and_b32 s5, s41, 15
    s_add_u32 s6, s3, s51
    s_waitcnt lgkmcnt(2)
    v_mfma_f32_32x32x16_bf16 v[64:79], v[144:147], v[48:51], v[64:79]
    ds_read_b128 v[40:43], v30 offset:24576
    ds_read_b128 v[44:47], v30 offset:28672
    v_mfma_f32_32x32x16_bf16 v[80:95], v[144:147], v[52:55], v[80:95]
    s_waitcnt vmcnt(0)
    v_mov_b32 v2, s42
    buffer_store_dword v2, v35, s[32:35], s82 offen sc1
    s_and_b32 s6, s6, 3
    v_lshlrev_b32 v112, 4, v1
    v_and_b32 v98, 31, v1
    v_lshrrev_b32 v99, 5, v1
    v_lshlrev_b32 v98, 4, v98
    s_waitcnt lgkmcnt(2)
    v_mfma_f32_32x32x16_bf16 v[64:79], v[148:151], v[56:59], v[64:79]
    ds_read_b128 v[48:51], v31 offset:24576
    ds_read_b128 v[52:55], v31 offset:28672
    v_mfma_f32_32x32x16_bf16 v[80:95], v[148:151], v[60:63], v[80:95]
    v_add_u32 v100, s48, v99
    v_lshl_add_u32 v124, v100, 10, v98
    s_mul_i32 s66, s50, 80
    s_add_u32 s66, s66, s49
    s_lshl_b32 s66, s66, 10
    s_waitcnt lgkmcnt(2)
    v_mfma_f32_32x32x16_bf16 v[64:79], v[152:155], v[40:43], v[64:79]
    ds_read_b128 v[56:59], v28 offset:32768
    ds_read_b128 v[60:63], v28 offset:36864
    v_mfma_f32_32x32x16_bf16 v[80:95], v[152:155], v[44:47], v[80:95]
    s_add_u32 s88, s66, 8388608
    s_cmp_eq_u32 s48, 0
    s_cselect_b32 s67, 2048, 8
    s_add_u32 s89, s67, s88
    s_lshl_b32 s4, s43, 5
    s_waitcnt lgkmcnt(2)
    v_mfma_f32_32x32x16_bf16 v[64:79], v[156:159], v[48:51], v[64:79]
    ds_read_b128 v[40:43], v29 offset:32768
    ds_read_b128 v[44:47], v29 offset:36864
    v_mfma_f32_32x32x16_bf16 v[80:95], v[156:159], v[52:55], v[80:95]
    s_add_u32 s4, s4, s50
    s_lshl_b32 s4, s4, 7
    s_add_u32 s4, s4, 21364736
    v_add_u32 v120, 92160, v124
    s_cmp_eq_u32 s48, 0
    s_cselect_b32 s63, 2048, 8
    s_waitcnt lgkmcnt(2)
    v_mfma_f32_32x32x16_bf16 v[64:79], v[160:163], v[56:59], v[64:79]
    ds_read_b128 v[48:51], v30 offset:32768
    ds_read_b128 v[52:55], v30 offset:36864
    v_mfma_f32_32x32x16_bf16 v[80:95], v[160:163], v[60:63], v[80:95]
    v_add_u32 v127, s63, v98
    v_add_u32 v100, 6144, v98
    v_cmp_gt_u32 vcc, 32, v1
    s_nop 1
    v_cndmask_b32 v121, v100, v127, vcc
    v_add_u32 v121, 92160, v121
    s_waitcnt lgkmcnt(2)
    v_mfma_f32_32x32x16_bf16 v[64:79], v[164:167], v[40:43], v[64:79]
    ds_read_b128 v[56:59], v31 offset:32768
    ds_read_b128 v[60:63], v31 offset:36864
    v_mfma_f32_32x32x16_bf16 v[80:95], v[164:167], v[44:47], v[80:95]
    v_bfe_u32 v100, v1, 4, 1
    v_and_b32 v101, 3, v1
    v_lshl_add_u32 v100, v100, 2, v101
    v_lshrrev_b32 v101, 1, v100
    v_add_u32 v102, s48, v101
    s_waitcnt lgkmcnt(2)
    v_mfma_f32_32x32x16_bf16 v[64:79], v[168:171], v[48:51], v[64:79]
    ds_read_b128 v[40:43], v28 offset:40960
    ds_read_b128 v[44:47], v28 offset:45056
    v_mfma_f32_32x32x16_bf16 v[80:95], v[168:171], v[52:55], v[80:95]
    s_lshr_b32 s63, s63, 10
    v_mov_b32 v103, s63
    v_cmp_eq_u32 vcc, 2, v101
    s_nop 1
    v_cndmask_b32 v102, v102, v103, vcc
    v_and_b32 v104, 1, v100
    s_waitcnt lgkmcnt(2)
    v_mfma_f32_32x32x16_bf16 v[64:79], v[172:175], v[56:59], v[64:79]
    ds_read_b128 v[48:51], v29 offset:40960
    ds_read_b128 v[52:55], v29 offset:45056
    v_mfma_f32_32x32x16_bf16 v[80:95], v[172:175], v[60:63], v[80:95]
    v_xor_b32 v105, s48, v104
    v_cndmask_b32 v104, v104, v105, vcc
    v_cmp_le_u32 vcc, 5, v100
    s_nop 1
    v_cndmask_b32 v102, v102, 3, vcc
    v_cndmask_b32 v104, v104, 0, vcc
    s_waitcnt lgkmcnt(2)
    v_mfma_f32_32x32x16_bf16 v[64:79], v[176:179], v[40:43], v[64:79]
    ds_read_b128 v[56:59], v30 offset:40960
    ds_read_b128 v[60:63], v30 offset:45056
    v_mfma_f32_32x32x16_bf16 v[80:95], v[176:179], v[44:47], v[80:95]
    v_cmp_eq_u32 vcc, 5, v100
    s_nop 1
    v_cndmask_b32 v104, v104, 1, vcc
    v_bfe_u32 v105, v1, 2, 2
    v_lshl_add_u32 v105, v99, 2, v105
    v_lshlrev_b32 v106, 2, v102
    s_waitcnt lgkmcnt(2)
    v_mfma_f32_32x32x16_bf16 v[64:79], v[180:183], v[48:51], v[64:79]
    ds_read_b128 v[40:43], v31 offset:40960
    ds_read_b128 v[44:47], v31 offset:45056
    v_mfma_f32_32x32x16_bf16 v[80:95], v[180:183], v[52:55], v[80:95]
    v_xor_b32 v105, v105, v106
    v_lshlrev_b32 v105, 4, v105
    v_lshl_add_u32 v105, v102, 10, v105
    v_lshl_add_u32 v105, v104, 3, v105
    v_add_u32 v122, 95232, v105
    s_waitcnt lgkmcnt(2)
    v_mfma_f32_32x32x16_bf16 v[64:79], v[184:187], v[56:59], v[64:79]
    s_barrier
    ds_read_b128 v[48:51], v28 offset:49152
    ds_read_b128 v[52:55], v28 offset:53248
    v_mfma_f32_32x32x16_bf16 v[80:95], v[184:187], v[60:63], v[80:95]
    v_xor_b32 v123, 128, v122
    v_and_b32 v98, 15, v1
    v_mul_u32_u24 v98, 160, v98
    v_lshrrev_b32 v99, 4, v1
    v_lshl_add_u32 v98, v99, 3, v98
    s_waitcnt lgkmcnt(2)
    v_mfma_f32_32x32x16_bf16 v[64:79], v[188:191], v[40:43], v[64:79]
    ds_read_b128 v[56:59], v29 offset:49152
    ds_read_b128 v[60:63], v29 offset:53248
    v_mfma_f32_32x32x16_bf16 v[80:95], v[188:191], v[44:47], v[80:95]
    s_mul_i32 s66, s3, 2560
    s_add_u32 s66, s66, 81920
    v_add_u32 v110, s66, v98
    s_mul_i32 s66, s3, 3072
    s_add_u32 s66, s66, 122880
    s_waitcnt lgkmcnt(2)
    v_mfma_f32_32x32x16_bf16 v[64:79], v[192:195], v[48:51], v[64:79]
    ds_read_b128 v[40:43], v30 offset:49152
    ds_read_b128 v[44:47], v30 offset:53248
    v_mfma_f32_32x32x16_bf16 v[80:95], v[192:195], v[52:55], v[80:95]
    v_add_u32 v113, s66, v124
    v_add_u32 v114, s66, v127
    s_mul_i32 s66, s3, 20480
    v_add_u32 v115, s66, v112
    s_mul_i32 s66, s3, 5120
    s_waitcnt lgkmcnt(2)
    v_mfma_f32_32x32x16_bf16 v[64:79], v[196:199], v[56:59], v[64:79]
    ds_read_b128 v[48:51], v31 offset:49152
    ds_read_b128 v[52:55], v31 offset:53248
    v_mfma_f32_32x32x16_bf16 v[80:95], v[196:199], v[60:63], v[80:95]
    s_add_u32 s66, s66, 86016
    v_add_u32 v117, s66, v112
    s_mov_b32 s61, 0
    v_and_b32 v116, 31, v1
    v_lshl_add_u32 v116, v116, 3, s40
    s_waitcnt lgkmcnt(2)
    v_mfma_f32_32x32x16_bf16 v[64:79], v[200:203], v[40:43], v[64:79]
    v_add_u32 v28, 57344, v28
    v_add_u32 v29, 57344, v29
    v_add_u32 v30, 57344, v30
    v_add_u32 v31, 57344, v31
    ds_read_b128 v[56:59], v28 offset:0
    ds_read_b128 v[60:63], v28 offset:4096
    v_mfma_f32_32x32x16_bf16 v[80:95], v[200:203], v[44:47], v[80:95]
    v_lshlrev_b32 v116, 7, v116
    v_add_u32 v116, 22020096, v116
    s_waitcnt lgkmcnt(2)
    v_mfma_f32_32x32x16_bf16 v[64:79], v[204:207], v[48:51], v[64:79]
    ds_read_b128 v[40:43], v29 offset:0
    ds_read_b128 v[44:47], v29 offset:4096
    v_mfma_f32_32x32x16_bf16 v[80:95], v[204:207], v[52:55], v[80:95]
    s_waitcnt lgkmcnt(2)
    v_mfma_f32_32x32x16_bf16 v[64:79], v[208:211], v[56:59], v[64:79]
    ds_read_b128 v[48:51], v30 offset:0
    ds_read_b128 v[52:55], v30 offset:4096
    v_mfma_f32_32x32x16_bf16 v[80:95], v[208:211], v[60:63], v[80:95]
    s_waitcnt lgkmcnt(2)
    v_mfma_f32_32x32x16_bf16 v[64:79], v[212:215], v[40:43], v[64:79]
    ds_read_b128 v[56:59], v31 offset:0
    ds_read_b128 v[60:63], v31 offset:4096
    v_mfma_f32_32x32x16_bf16 v[80:95], v[212:215], v[44:47], v[80:95]
    s_waitcnt lgkmcnt(2)
    v_mfma_f32_32x32x16_bf16 v[64:79], v[216:219], v[48:51], v[64:79]
    ds_read_b128 v[40:43], v28 offset:8192
    ds_read_b128 v[44:47], v28 offset:12288
    v_mfma_f32_32x32x16_bf16 v[80:95], v[216:219], v[52:55], v[80:95]
    buffer_load_dwordx4 v[8:11], v36, s[32:35], s81 offen offset:0 sc1
    buffer_load_dwordx4 v[12:15], v36, s[32:35], s81 offen offset:512 sc1
    s_waitcnt lgkmcnt(2)
    v_mfma_f32_32x32x16_bf16 v[64:79], v[220:223], v[56:59], v[64:79]
    ds_read_b128 v[48:51], v29 offset:8192
    ds_read_b128 v[52:55], v29 offset:12288
    v_mfma_f32_32x32x16_bf16 v[80:95], v[220:223], v[60:63], v[80:95]
    s_waitcnt lgkmcnt(2)
    v_mfma_f32_32x32x16_bf16 v[64:79], v[224:227], v[40:43], v[64:79]
    ds_read_b128 v[56:59], v30 offset:8192
    ds_read_b128 v[60:63], v30 offset:12288
    v_mfma_f32_32x32x16_bf16 v[80:95], v[224:227], v[44:47], v[80:95]
    s_waitcnt lgkmcnt(2)
    v_mfma_f32_32x32x16_bf16 v[64:79], v[228:231], v[48:51], v[64:79]
    ds_read_b128 v[40:43], v31 offset:8192
    ds_read_b128 v[44:47], v31 offset:12288
    v_mfma_f32_32x32x16_bf16 v[80:95], v[228:231], v[52:55], v[80:95]
    s_waitcnt lgkmcnt(2)
    v_mfma_f32_32x32x16_bf16 v[64:79], v[232:235], v[56:59], v[64:79]
    ds_read_b128 v[48:51], v28 offset:16384
    ds_read_b128 v[52:55], v28 offset:20480
    v_mfma_f32_32x32x16_bf16 v[80:95], v[232:235], v[60:63], v[80:95]
    s_waitcnt lgkmcnt(2)
    v_mfma_f32_32x32x16_bf16 v[64:79], v[236:239], v[40:43], v[64:79]
    ds_read_b128 v[56:59], v29 offset:16384
    ds_read_b128 v[60:63], v29 offset:20480
    v_mfma_f32_32x32x16_bf16 v[80:95], v[236:239], v[44:47], v[80:95]
    s_waitcnt lgkmcnt(2)
    v_mfma_f32_32x32x16_bf16 v[64:79], v[240:243], v[48:51], v[64:79]
    ds_read_b128 v[40:43], v30 offset:16384
    ds_read_b128 v[44:47], v30 offset:20480
    v_mfma_f32_32x32x16_bf16 v[80:95], v[240:243], v[52:55], v[80:95]
    s_waitcnt lgkmcnt(2)
    v_mfma_f32_32x32x16_bf16 v[64:79], v[244:247], v[56:59], v[64:79]
    ds_read_b128 v[48:51], v31 offset:16384
    ds_read_b128 v[52:55], v31 offset:20480
    v_mfma_f32_32x32x16_bf16 v[80:95], v[244:247], v[60:63], v[80:95]
    s_waitcnt lgkmcnt(2)
    v_mfma_f32_32x32x16_bf16 v[64:79], v[248:251], v[40:43], v[64:79]
    v_mfma_f32_32x32x16_bf16 v[80:95], v[248:251], v[44:47], v[80:95]
    s_waitcnt lgkmcnt(0)
    s_waitcnt vmcnt(1)
    v_cmp_ne_u32 vcc, s42, v10
    s_waitcnt vmcnt(0)
    v_cmp_ne_u32 s[46:47], s42, v14
    s_nop 0
    s_or_b64 vcc, vcc, s[46:47]
    s_cbranch_scc1 L_st_26
L_sto_27:
    v_mfma_f32_32x32x16_bf16 v[64:79], v[252:255], v[48:51], v[64:79]
    v_cvt_pk_bf16_f32 v40, -v9, -v9
    v_mov_b32 v41, v40
    v_mov_b32 v42, 0
    v_mov_b32 v43, 0
    v_cvt_pk_bf16_f32 v44, -v13, -v13
    v_mov_b32 v45, v44
    v_mov_b32 v46, 0
    v_mov_b32 v47, 0
    v_mov_b32 v58, 0
    v_mfma_f32_32x32x16_bf16 v[80:95], v[252:255], v[52:55], v[80:95]
    v_mov_b32 v59, 0
    v_and_b32 v2, 0xffff0000, v20
    v_sub_f32 v3, v20, v2
    v_and_b32 v4, 0xffff0000, v3
    v_sub_f32 v3, v3, v4
    v_cvt_pk_bf16_f32 v56, v2, v4
    v_cvt_pk_bf16_f32 v57, v3, 0
    s_nop 1
    v_mfma_f32_32x32x16_bf16 v[64:79], v[56:59], v[40:43], v[64:79]
    v_mfma_f32_32x32x16_bf16 v[80:95], v[56:59], v[44:47], v[80:95]
    s_nop 10
    v_pk_mul_f32 v[64:65], v[64:65], v[8:9] op_sel:[0,0] op_sel_hi:[1,0]
    v_pk_mul_f32 v[66:67], v[66:67], v[8:9] op_sel:[0,0] op_sel_hi:[1,0]
    v_pk_mul_f32 v[68:69], v[68:69], v[8:9] op_sel:[0,0] op_sel_hi:[1,0]
    v_pk_mul_f32 v[70:71], v[70:71], v[8:9] op_sel:[0,0] op_sel_hi:[1,0]
    v_pk_mul_f32 v[72:73], v[72:73], v[8:9] op_sel:[0,0] op_sel_hi:[1,0]
    v_pk_mul_f32 v[74:75], v[74:75], v[8:9] op_sel:[0,0] op_sel_hi:[1,0]
    v_pk_mul_f32 v[76:77], v[76:77], v[8:9] op_sel:[0,0] op_sel_hi:[1,0]
    v_pk_mul_f32 v[78:79], v[78:79], v[8:9] op_sel:[0,0] op_sel_hi:[1,0]
    v_cvt_pk_bf16_f32 v64, v64, v65
    v_cvt_pk_bf16_f32 v65, v66, v67
    v_cvt_pk_bf16_f32 v66, v68, v69
    v_cvt_pk_bf16_f32 v67, v70, v71
    v_cvt_pk_bf16_f32 v68, v72, v73
    v_cvt_pk_bf16_f32 v69, v74, v75
    v_cvt_pk_bf16_f32 v70, v76, v77
    v_cvt_pk_bf16_f32 v71, v78, v79
    v_permlane32_swap_b32 v64, v66
    v_permlane32_swap_b32 v65, v67
    v_permlane32_swap_b32 v68, v70
    v_permlane32_swap_b32 v69, v71
    buffer_store_dwordx4 v[64:67], v34, s[32:35], s79 offen offset:0 sc1
    buffer_store_dwordx4 v[68:71], v34, s[32:35], s79 offen offset:2048 sc1
    v_pk_mul_f32 v[80:81], v[80:81], v[12:13] op_sel:[0,0] op_sel_hi:[1,0]
    v_pk_mul_f32 v[82:83], v[82:83], v[12:13] op_sel:[0,0] op_sel_hi:[1,0]
    v_pk_mul_f32 v[84:85], v[84:85], v[12:13] op_sel:[0,0] op_sel_hi:[1,0]
    v_pk_mul_f32 v[86:87], v[86:87], v[12:13] op_sel:[0,0] op_sel_hi:[1,0]
    v_pk_mul_f32 v[88:89], v[88:89], v[12:13] op_sel:[0,0] op_sel_hi:[1,0]
    v_pk_mul_f32 v[90:91], v[90:91], v[12:13] op_sel:[0,0] op_sel_hi:[1,0]
    v_pk_mul_f32 v[92:93], v[92:93], v[12:13] op_sel:[0,0] op_sel_hi:[1,0]
    v_pk_mul_f32 v[94:95], v[94:95], v[12:13] op_sel:[0,0] op_sel_hi:[1,0]
    v_cvt_pk_bf16_f32 v80, v80, v81
    v_cvt_pk_bf16_f32 v81, v82, v83
    v_cvt_pk_bf16_f32 v82, v84, v85
    v_cvt_pk_bf16_f32 v83, v86, v87
    v_cvt_pk_bf16_f32 v84, v88, v89
    v_cvt_pk_bf16_f32 v85, v90, v91
    v_cvt_pk_bf16_f32 v86, v92, v93
    v_cvt_pk_bf16_f32 v87, v94, v95
    v_permlane32_swap_b32 v80, v82
    v_permlane32_swap_b32 v81, v83
    v_permlane32_swap_b32 v84, v86
    v_permlane32_swap_b32 v85, v87
    buffer_store_dwordx4 v[80:83], v34, s[32:35], s85 offen offset:0 sc1
    buffer_store_dwordx4 v[84:87], v34, s[32:35], s85 offen offset:2048 sc1
    s_branch L_c_p1_done
L_c_idle:
    buffer_load_dwordx4 v[244:247], v6, s[8:11], 0 offen offset:0
    buffer_load_dwordx4 v[248:251], v6, s[8:11], 0 offen offset:512
    buffer_load_dwordx4 v[252:255], v7, s[8:11], 0 offen offset:1024
    v_mov_b32 v6, 0
    v_mov_b32 v4, 0x3f803f80
    s_waitcnt vmcnt(2)
    v_dot2_f32_bf16 v2, v244, v4, 0
    v_dot2_f32_bf16 v3, v244, v244, 0
    v_dot2_f32_bf16 v2, v245, v4, v2
    v_dot2_f32_bf16 v3, v245, v245, v3
    v_dot2_f32_bf16 v2, v246, v4, v2
    v_dot2_f32_bf16 v3, v246, v246, v3
    v_dot2_f32_bf16 v2, v247, v4, v2
    v_dot2_f32_bf16 v3, v247, v247, v3
    s_waitcnt vmcnt(1)
    v_dot2_f32_bf16 v2, v248, v4, v2
    v_dot2_f32_bf16 v3, v248, v248, v3
    v_dot2_f32_bf16 v2, v249, v4, v2
    v_dot2_f32_bf16 v3, v249, v249, v3
    v_dot2_f32_bf16 v2, v250, v4, v2
    v_dot2_f32_bf16 v3, v250, v250, v3
    v_dot2_f32_bf16 v2, v251, v4, v2
    v_dot2_f32_bf16 v3, v251, v251, v3
    s_waitcnt vmcnt(0)
    v_dot2_f32_bf16 v2, v252, v4, v2
    v_dot2_f32_bf16 v3, v252, v252, v3
    v_dot2_f32_bf16 v2, v253, v4, v2
    v_dot2_f32_bf16 v3, v253, v253, v3
    v_dot2_f32_bf16 v2, v254, v4, v2
    v_dot2_f32_bf16 v3, v254, v254, v3
    v_dot2_f32_bf16 v2, v255, v4, v2
    v_dot2_f32_bf16 v3, v255, v255, v3
    s_nop 1
    v_add_f32_dpp v2, v2, v2 row_ror:8 row_mask:0xf bank_mask:0xf
    v_add_f32_dpp v3, v3, v3 row_ror:8 row_mask:0xf bank_mask:0xf
    s_nop 0
    v_add_f32_dpp v2, v2, v2 row_ror:4 row_mask:0xf bank_mask:0xf
    v_add_f32_dpp v3, v3, v3 row_ror:4 row_mask:0xf bank_mask:0xf
    s_nop 0
    v_add_f32_dpp v2, v2, v2 row_ror:2 row_mask:0xf bank_mask:0xf
    v_add_f32_dpp v3, v3, v3 row_ror:2 row_mask:0xf bank_mask:0xf
    s_nop 0
    v_add_f32_dpp v2, v2, v2 row_ror:1 row_mask:0xf bank_mask:0xf
    v_add_f32_dpp v3, v3, v3 row_ror:1 row_mask:0xf bank_mask:0xf
    v_mov_b32 v4, v2
    v_mov_b32 v5, v3
    s_nop 0
    v_permlane16_swap_b32 v2, v4
    v_permlane16_swap_b32 v3, v5
    v_add_f32 v2, v2, v4
    v_add_f32 v3, v3, v5
    v_mul_f32 v9, 0x3acccccd, v2
    v_mul_f32 v4, 0x3acccccd, v3
    v_fma_f32 v4, -v9, v9, v4
    v_max_f32 v4, 0, v4
    v_cvt_pk_bf16_f32 v4, v4, v4
    v_and_b32 v4, 0xffff0000, v4
    v_add_f32 v4, 0x3727c5ac, v4
    v_cvt_pk_bf16_f32 v4, v4, v4
    v_and_b32 v4, 0xffff0000, v4
    v_sqrt_f32 v4, v4
    s_nop 0
    v_cvt_pk_bf16_f32 v4, v4, v4
    v_and_b32 v4, 0xffff0000, v4
    v_rcp_f32 v8, v4
    v_cvt_pk_bf16_f32 v9, v9, v9
    v_and_b32 v9, 0xffff0000, v9
    buffer_load_dword v7, v6, s[36:39], 0 offen sc1
    s_waitcnt vmcnt(0)
    v_readfirstlane_b32 s42, v7
    s_nop 0
    s_cmp_eq_u32 s42, 0
    s_cbranch_scc1 L_nz_28
L_nzb_29:
    s_mov_b32 s46, 22327296
    v_mov_b32 v10, s42
    v_mov_b32 v11, s42
    s_mov_b32 exec_lo, 1
    s_mov_b32 exec_hi, 1
    buffer_store_dwordx4 v[8:11], v12, s[32:35], s46 offen sc1
    s_mov_b64 exec, -1
    s_mov_b32 s83, 0x7f000000
    v_mov_b32 v35, 0
    s_lshr_b32 s66, s41, 3
    s_lshl_b32 s52, s40, 2
    s_add_u32 s52, s52, s66
    s_mov_b32 s43, s52
    s_and_b32 s51, s41, 7
    s_mov_b32 s45, s51
    s_and_b32 s48, s43, 1
    s_lshr_b32 s66, s43, 1
    s_mul_i32 s66, s66, 5
    s_lshl_b32 s67, s48, 1
    s_add_u32 s49, s66, s67
    s_lshl_b32 s50, s45, 2
    s_add_u32 s50, s50, s3
    s_and_b32 s5, s41, 15
    s_add_u32 s6, s3, s51
    s_and_b32 s6, s6, 3
    v_lshlrev_b32 v112, 4, v1
    v_and_b32 v98, 31, v1
    v_lshrrev_b32 v99, 5, v1
    v_lshlrev_b32 v98, 4, v98
    v_add_u32 v100, s48, v99
    v_lshl_add_u32 v124, v100, 10, v98
    s_mul_i32 s66, s50, 80
    s_add_u32 s66, s66, s49
    s_lshl_b32 s66, s66, 10
    s_add_u32 s88, s66, 8388608
    s_cmp_eq_u32 s48, 0
    s_cselect_b32 s67, 2048, 8
    s_add_u32 s89, s67, s88
    s_lshl_b32 s4, s43, 5
    s_add_u32 s4, s4, s50
    s_lshl_b32 s4, s4, 7
    s_add_u32 s4, s4, 21364736
    v_add_u32 v120, 92160, v124
    s_cmp_eq_u32 s48, 0
    s_cselect_b32 s63, 2048, 8
    v_add_u32 v127, s63, v98
    v_add_u32 v100, 6144, v98
    v_cmp_gt_u32 vcc, 32, v1
    s_nop 1
    v_cndmask_b32 v121, v100, v127, vcc
    v_add_u32 v121, 92160, v121
    v_bfe_u32 v100, v1, 4, 1
    v_and_b32 v101, 3, v1
    v_lshl_add_u32 v100, v100, 2, v101
    v_lshrrev_b32 v101, 1, v100
    v_add_u32 v102, s48, v101
    s_lshr_b32 s63, s63, 10
    v_mov_b32 v103, s63
    v_cmp_eq_u32 vcc, 2, v101
    s_nop 1
    v_cndmask_b32 v102, v102, v103, vcc
    v_and_b32 v104, 1, v100
    v_xor_b32 v105, s48, v104
    v_cndmask_b32 v104, v104, v105, vcc
    v_cmp_le_u32 vcc, 5, v100
    s_nop 1
    v_cndmask_b32 v102, v102, 3, vcc
    v_cndmask_b32 v104, v104, 0, vcc
    v_cmp_eq_u32 vcc, 5, v100
    s_nop 1
    v_cndmask_b32 v104, v104, 1, vcc
    v_bfe_u32 v105, v1, 2, 2
    v_lshl_add_u32 v105, v99, 2, v105
    v_lshlrev_b32 v106, 2, v102
    v_xor_b32 v105, v105, v106
    v_lshlrev_b32 v105, 4, v105
    v_lshl_add_u32 v105, v102, 10, v105
    v_lshl_add_u32 v105, v104, 3, v105
    v_add_u32 v122, 95232, v105
    v_xor_b32 v123, 128, v122
    v_and_b32 v98, 15, v1
    v_mul_u32_u24 v98, 160, v98
    v_lshrrev_b32 v99, 4, v1
    v_lshl_add_u32 v98, v99, 3, v98
    s_mul_i32 s66, s3, 2560
    s_add_u32 s66, s66, 81920
    v_add_u32 v110, s66, v98
    s_mul_i32 s66, s3, 3072
    s_add_u32 s66, s66, 122880
    v_add_u32 v113, s66, v124
    v_add_u32 v114, s66, v127
    s_mul_i32 s66, s3, 20480
    v_add_u32 v115, s66, v112
    s_mul_i32 s66, s3, 5120
    s_add_u32 s66, s66, 86016
    v_add_u32 v117, s66, v112
    s_mov_b32 s61, 0
    v_and_b32 v116, 31, v1
    v_lshl_add_u32 v116, v116, 3, s40
    v_lshlrev_b32 v116, 7, v116
    v_add_u32 v116, 22020096, v116
    s_setprio 1
    s_nop 3
L_c_p1_done:
    v_mov_b32 v170, v35
    v_mov_b32 v14, v110
    v_mov_b32 v16, v112
    v_mov_b32 v17, v113
    v_mov_b32 v18, v114
    v_mov_b32 v19, v115
    v_mov_b32 v20, v116
    v_mov_b32 v21, v117
    v_mov_b32 v24, v120
    v_mov_b32 v25, v121
    v_mov_b32 v26, v122
    v_mov_b32 v27, v123
    v_mov_b32 v28, v124
    v_mov_b32 v31, v127
    s_mov_b32 s62, 0
    s_mov_b32 s63, -1
    s_barrier
    ds_read_b64 v[36:37], v18 offset:0
    ds_read_b64 v[44:45], v18 offset:512
    ds_read_b128 v[32:35], v17 offset:0
    ds_read_b128 v[40:43], v17 offset:512
    ds_read_b128 v[48:51], v24 offset:43008
    ds_read_b64 v[52:53], v25 offset:43008
    ds_read_b128 v[56:59], v24 offset:43520
    ds_read_b64 v[60:61], v25 offset:43520
    ds_read_b64_tr_b16 v[64:65], v26 offset:43008
    ds_read_b64_tr_b16 v[66:67], v27 offset:43008
    ds_read_b64_tr_b16 v[68:69], v26 offset:43264
    ds_read_b64_tr_b16 v[70:71], v27 offset:43264
    s_waitcnt lgkmcnt(11)
    v_cndmask_b32 v36, v36, 0, s[62:63]
    v_cndmask_b32 v37, v37, 0, s[62:63]
    s_waitcnt lgkmcnt(10)
    v_cndmask_b32 v44, v44, 0, s[62:63]
    v_cndmask_b32 v45, v45, 0, s[62:63]
    s_waitcnt lgkmcnt(7)
    v_mfma_f32_32x32x16_bf16 v[96:111], v[48:51], v[32:35], 0
    v_mfma_f32_32x32x16_bf16 v[112:127], v[48:51], v[40:43], 0
    s_waitcnt lgkmcnt(6)
    s_nop 7
    v_mfma_f32_32x32x8bf16_1k v[96:111], v[52:53], v[36:37], v[96:111]
    v_mfma_f32_32x32x8bf16_1k v[112:127], v[52:53], v[44:45], v[112:127]
    s_nop 10
    v_max3_f32 v2, v96, v97, v98
    v_max3_f32 v2, v2, v99, v100
    v_max3_f32 v2, v2, v101, v102
    v_max3_f32 v2, v2, v103, v104
    v_max3_f32 v2, v2, v105, v106
    v_max3_f32 v2, v2, v107, v108
    v_max3_f32 v2, v2, v109, v110
    v_max_f32 v2, v2, v111
    v_mov_b32 v4, v2
    s_nop 1
    v_permlane32_swap_b32 v2, v4
    v_max_f32 v2, v2, v4
    v_cvt_pk_bf16_f32 v2, -v2, 0
    v_cndmask_b32 v36, v36, v2, s[62:63]
    v_mfma_f32_32x32x16_bf16 v[96:111], v[48:51], v[32:35], 0
    v_max3_f32 v3, v112, v113, v114
    v_max3_f32 v3, v3, v115, v116
    v_max3_f32 v3, v3, v117, v118
    v_max3_f32 v3, v3, v119, v120
    v_max3_f32 v3, v3, v121, v122
    v_max3_f32 v3, v3, v123, v124
    v_max3_f32 v3, v3, v125, v126
    v_max_f32 v3, v3, v127
    v_mov_b32 v5, v3
    s_nop 1
    v_permlane32_swap_b32 v3, v5
    v_max_f32 v3, v3, v5
    v_cvt_pk_bf16_f32 v3, -v3, 0
    v_cndmask_b32 v44, v44, v3, s[62:63]
    v_mfma_f32_32x32x8bf16_1k v[96:111], v[52:53], v[36:37], v[96:111]
    v_mfma_f32_32x32x16_bf16 v[112:127], v[48:51], v[40:43], 0
    s_nop 10
    v_exp_f32 v96, v96
    v_exp_f32 v97, v97
    v_exp_f32 v98, v98
    v_exp_f32 v99, v99
    v_exp_f32 v100, v100
    v_exp_f32 v101, v101
    v_exp_f32 v102, v102
    v_exp_f32 v103, v103
    v_cvt_pk_bf16_f32 v80, v96, v97
    v_cvt_pk_bf16_f32 v81, v98, v99
    v_mfma_f32_32x32x8bf16_1k v[112:127], v[52:53], v[44:45], v[112:127]
    v_exp_f32 v104, v104
    v_exp_f32 v105, v105
    v_exp_f32 v106, v106
    v_exp_f32 v107, v107
    v_cvt_pk_bf16_f32 v82, v100, v101
    v_cvt_pk_bf16_f32 v83, v102, v103
    v_exp_f32 v108, v108
    v_exp_f32 v109, v109
    v_exp_f32 v110, v110
    v_exp_f32 v111, v111
    v_cvt_pk_bf16_f32 v84, v104, v105
    v_cvt_pk_bf16_f32 v85, v106, v107
    v_cvt_pk_bf16_f32 v86, v108, v109
    v_cvt_pk_bf16_f32 v87, v110, v111
    s_waitcnt lgkmcnt(5)
    v_mfma_f32_32x32x16_bf16 v[96:111], v[56:59], v[32:35], 0
    ds_read_b128 v[48:51], v24 offset:50176
    v_exp_f32 v112, v112
    v_exp_f32 v113, v113
    v_exp_f32 v114, v114
    v_exp_f32 v115, v115
    s_waitcnt lgkmcnt(3)
    v_mfma_f32_32x32x16_bf16 v[128:143], v[64:67], v[80:83], 0
    ds_read_b64 v[52:53], v25 offset:50176
    v_exp_f32 v116, v116
    v_exp_f32 v117, v117
    v_exp_f32 v118, v118
    v_exp_f32 v119, v119
    v_cvt_pk_bf16_f32 v88, v112, v113
    v_cvt_pk_bf16_f32 v89, v114, v115
    v_mfma_f32_32x32x8bf16_1k v[96:111], v[60:61], v[36:37], v[96:111]
    ds_read_b64_tr_b16 v[72:73], v26 offset:43520
    v_exp_f32 v120, v120
    v_exp_f32 v121, v121
    v_exp_f32 v122, v122
    v_exp_f32 v123, v123
    v_cvt_pk_bf16_f32 v90, v116, v117
    v_cvt_pk_bf16_f32 v91, v118, v119
    s_waitcnt lgkmcnt(3)
    v_mfma_f32_32x32x16_bf16 v[128:143], v[68:71], v[84:87], v[128:143]
    ds_read_b64_tr_b16 v[74:75], v27 offset:43520
    v_exp_f32 v124, v124
    v_exp_f32 v125, v125
    v_exp_f32 v126, v126
    v_exp_f32 v127, v127
    v_cvt_pk_bf16_f32 v92, v120, v121
    v_cvt_pk_bf16_f32 v93, v122, v123
    v_cvt_pk_bf16_f32 v94, v124, v125
    v_cvt_pk_bf16_f32 v95, v126, v127
    v_mfma_f32_32x32x16_bf16 v[112:127], v[56:59], v[40:43], 0
    ds_read_b64_tr_b16 v[76:77], v26 offset:43776
    v_exp_f32 v96, v96
    v_exp_f32 v97, v97
    v_exp_f32 v98, v98
    v_exp_f32 v99, v99
    v_mfma_f32_32x32x16_bf16 v[144:159], v[64:67], v[88:91], 0
    ds_read_b64_tr_b16 v[78:79], v27 offset:43776
    v_exp_f32 v100, v100
    v_exp_f32 v101, v101
    v_exp_f32 v102, v102
    v_exp_f32 v103, v103
    v_cvt_pk_bf16_f32 v80, v96, v97
    v_cvt_pk_bf16_f32 v81, v98, v99
    v_mfma_f32_32x32x8bf16_1k v[112:127], v[60:61], v[44:45], v[112:127]
    v_exp_f32 v104, v104
    v_exp_f32 v105, v105
    v_exp_f32 v106, v106
    v_exp_f32 v107, v107
    v_cvt_pk_bf16_f32 v82, v100, v101
    v_cvt_pk_bf16_f32 v83, v102, v103
    v_mfma_f32_32x32x16_bf16 v[144:159], v[68:71], v[92:95], v[144:159]
    v_exp_f32 v108, v108
    v_exp_f32 v109, v109
    v_exp_f32 v110, v110
    v_exp_f32 v111, v111
    v_cvt_pk_bf16_f32 v84, v104, v105
L_pad0_1:
    s_cbranch_execz L_pad0_2
    v_cvt_pk_bf16_f32 v85, v106, v107
    v_cvt_pk_bf16_f32 v86, v108, v109
    v_cvt_pk_bf16_f32 v87, v110, v111
    s_waitcnt lgkmcnt(0)
    s_waitcnt vmcnt(0)
    v_mov_b32 v2, s42
    buffer_store_dword v2, v170, s[32:35], s83 offen sc1
    buffer_load_dword v15, v20, s[32:35], 0 offen sc1
    v_mfma_f32_32x32x16_bf16 v[96:111], v[48:51], v[32:35], 0
    ds_read_b128 v[56:59], v24 offset:50688
    v_exp_f32 v112, v112
    v_exp_f32 v113, v113
    v_exp_f32 v114, v114
    v_exp_f32 v115, v115
    v_mfma_f32_32x32x16_bf16 v[128:143], v[72:75], v[80:83], v[128:143]
    ds_read_b64 v[60:61], v25 offset:50688
    v_exp_f32 v116, v116
    v_exp_f32 v117, v117
    v_exp_f32 v118, v118
    v_exp_f32 v119, v119
    v_cvt_pk_bf16_f32 v88, v112, v113
    v_cvt_pk_bf16_f32 v89, v114, v115
    v_mfma_f32_32x32x8bf16_1k v[96:111], v[52:53], v[36:37], v[96:111]
    ds_read_b64_tr_b16 v[64:65], v26 offset:50176
    v_exp_f32 v120, v120
    v_exp_f32 v121, v121
    v_exp_f32 v122, v122
    v_exp_f32 v123, v123
    v_cvt_pk_bf16_f32 v90, v116, v117
    v_cvt_pk_bf16_f32 v91, v118, v119
    v_mfma_f32_32x32x16_bf16 v[128:143], v[76:79], v[84:87], v[128:143]
    ds_read_b64_tr_b16 v[66:67], v27 offset:50176
    v_exp_f32 v124, v124
    v_exp_f32 v125, v125
    v_exp_f32 v126, v126
    v_exp_f32 v127, v127
    v_cvt_pk_bf16_f32 v92, v120, v121
    v_cvt_pk_bf16_f32 v93, v122, v123
    v_cvt_pk_bf16_f32 v94, v124, v125
    v_cvt_pk_bf16_f32 v95, v126, v127
    v_mfma_f32_32x32x16_bf16 v[112:127], v[48:51], v[40:43], 0
    ds_read_b64_tr_b16 v[68:69], v26 offset:50432
    v_exp_f32 v96, v96
    v_exp_f32 v97, v97
    v_exp_f32 v98, v98
    v_exp_f32 v99, v99
    v_mfma_f32_32x32x16_bf16 v[144:159], v[72:75], v[88:91], v[144:159]
    ds_read_b64_tr_b16 v[70:71], v27 offset:50432
    v_exp_f32 v100, v100
    v_exp_f32 v101, v101
    v_exp_f32 v102, v102
    v_exp_f32 v103, v103
    v_cvt_pk_bf16_f32 v80, v96, v97
    v_cvt_pk_bf16_f32 v81, v98, v99
    v_mfma_f32_32x32x8bf16_1k v[112:127], v[52:53], v[44:45], v[112:127]
    v_exp_f32 v104, v104
    v_exp_f32 v105, v105
    v_exp_f32 v106, v106
    v_exp_f32 v107, v107
    v_cvt_pk_bf16_f32 v82, v100, v101
    v_cvt_pk_bf16_f32 v83, v102, v103
    v_mfma_f32_32x32x16_bf16 v[144:159], v[76:79], v[92:95], v[144:159]
    v_exp_f32 v108, v108
    v_exp_f32 v109, v109
    v_exp_f32 v110, v110
    v_exp_f32 v111, v111
    v_cvt_pk_bf16_f32 v84, v104, v105
    v_cvt_pk_bf16_f32 v85, v106, v107
    v_cvt_pk_bf16_f32 v86, v108, v109
    v_cvt_pk_bf16_f32 v87, v110, v111
    s_waitcnt lgkmcnt(0)
    s_barrier
    v_mfma_f32_32x32x16_bf16 v[96:111], v[56:59], v[32:35], 0
    ds_read_b128 v[48:51], v24 offset:57344
    v_exp_f32 v112, v112
    v_exp_f32 v113, v113
    v_exp_f32 v114, v114
    v_exp_f32 v115, v115
    v_mfma_f32_32x32x16_bf16 v[128:143], v[64:67], v[80:83], v[128:143]
    ds_read_b64 v[52:53], v25 offset:57344
    v_exp_f32 v116, v116
    v_exp_f32 v117, v117
    v_exp_f32 v118, v118
    v_exp_f32 v119, v119
    v_cvt_pk_bf16_f32 v88, v112, v113
    v_cvt_pk_bf16_f32 v89, v114, v115
    v_mfma_f32_32x32x8bf16_1k v[96:111], v[60:61], v[36:37], v[96:111]
    ds_read_b64_tr_b16 v[72:73], v26 offset:50688
    v_exp_f32 v120, v120
    v_exp_f32 v121, v121
    v_exp_f32 v122, v122
    v_exp_f32 v123, v123
    v_cvt_pk_bf16_f32 v90, v116, v117
    v_cvt_pk_bf16_f32 v91, v118, v119
    v_mfma_f32_32x32x16_bf16 v[128:143], v[68:71], v[84:87], v[128:143]
    ds_read_b64_tr_b16 v[74:75], v27 offset:50688
    v_exp_f32 v124, v124
    v_exp_f32 v125, v125
    v_exp_f32 v126, v126
    v_exp_f32 v127, v127
    v_cvt_pk_bf16_f32 v92, v120, v121
    v_cvt_pk_bf16_f32 v93, v122, v123
    v_cvt_pk_bf16_f32 v94, v124, v125
    v_cvt_pk_bf16_f32 v95, v126, v127
    v_mfma_f32_32x32x16_bf16 v[112:127], v[56:59], v[40:43], 0
    ds_read_b64_tr_b16 v[76:77], v26 offset:50944
    v_exp_f32 v96, v96
    v_exp_f32 v97, v97
    v_exp_f32 v98, v98
    v_exp_f32 v99, v99
    v_mfma_f32_32x32x16_bf16 v[144:159], v[64:67], v[88:91], v[144:159]
    ds_read_b64_tr_b16 v[78:79], v27 offset:50944
    v_exp_f32 v100, v100
    v_exp_f32 v101, v101
    v_exp_f32 v102, v102
    v_exp_f32 v103, v103
    v_cvt_pk_bf16_f32 v80, v96, v97
    v_cvt_pk_bf16_f32 v81, v98, v99
    v_mfma_f32_32x32x8bf16_1k v[112:127], v[60:61], v[44:45], v[112:127]
    v_exp_f32 v104, v104
    v_exp_f32 v105, v105
    v_exp_f32 v106, v106
    v_exp_f32 v107, v107
    v_cvt_pk_bf16_f32 v82, v100, v101
    v_cvt_pk_bf16_f32 v83, v102, v103
    v_mfma_f32_32x32x16_bf16 v[144:159], v[68:71], v[92:95], v[144:159]
    v_exp_f32 v108, v108
    v_exp_f32 v109, v109
    v_exp_f32 v110, v110
    v_exp_f32 v111, v111
    v_cvt_pk_bf16_f32 v84, v104, v105
    v_cvt_pk_bf16_f32 v85, v106, v107
    v_cvt_pk_bf16_f32 v86, v108, v109
    v_cvt_pk_bf16_f32 v87, v110, v111
    s_waitcnt lgkmcnt(0)
    v_mfma_f32_32x32x16_bf16 v[96:111], v[48:51], v[32:35], 0
    ds_read_b128 v[56:59], v24 offset:57856
    v_exp_f32 v112, v112
    v_exp_f32 v113, v113
    v_exp_f32 v114, v114
    v_exp_f32 v115, v115
    v_mfma_f32_32x32x16_bf16 v[128:143], v[72:75], v[80:83], v[128:143]
    ds_read_b64 v[60:61], v25 offset:57856
    v_exp_f32 v116, v116
    v_exp_f32 v117, v117
    v_exp_f32 v118, v118
    v_exp_f32 v119, v119
    v_cvt_pk_bf16_f32 v88, v112, v113
    v_cvt_pk_bf16_f32 v89, v114, v115
    v_mfma_f32_32x32x8bf16_1k v[96:111], v[52:53], v[36:37], v[96:111]
    ds_read_b64_tr_b16 v[64:65], v26 offset:57344
    v_exp_f32 v120, v120
    v_exp_f32 v121, v121
    v_exp_f32 v122, v122
    v_exp_f32 v123, v123
    v_cvt_pk_bf16_f32 v90, v116, v117
    v_cvt_pk_bf16_f32 v91, v118, v119
    v_mfma_f32_32x32x16_bf16 v[128:143], v[76:79], v[84:87], v[128:143]
    ds_read_b64_tr_b16 v[66:67], v27 offset:57344
    v_exp_f32 v124, v124
    v_exp_f32 v125, v125
    v_exp_f32 v126, v126
    v_exp_f32 v127, v127
    v_cvt_pk_bf16_f32 v92, v120, v121
    v_cvt_pk_bf16_f32 v93, v122, v123
    v_cvt_pk_bf16_f32 v94, v124, v125
    v_cvt_pk_bf16_f32 v95, v126, v127
    v_mfma_f32_32x32x16_bf16 v[112:127], v[48:51], v[40:43], 0
    ds_read_b64_tr_b16 v[68:69], v26 offset:57600
    v_exp_f32 v96, v96
    v_exp_f32 v97, v97
    v_exp_f32 v98, v98
    v_exp_f32 v99, v99
    v_mfma_f32_32x32x16_bf16 v[144:159], v[72:75], v[88:91], v[144:159]
    ds_read_b64_tr_b16 v[70:71], v27 offset:57600
    v_exp_f32 v100, v100
    v_exp_f32 v101, v101
    v_exp_f32 v102, v102
    v_exp_f32 v103, v103
    v_cvt_pk_bf16_f32 v80, v96, v97
    v_cvt_pk_bf16_f32 v81, v98, v99
    v_mfma_f32_32x32x8bf16_1k v[112:127], v[52:53], v[44:45], v[112:127]
    v_exp_f32 v104, v104
    v_exp_f32 v105, v105
    v_exp_f32 v106, v106
    v_exp_f32 v107, v107
    v_cvt_pk_bf16_f32 v82, v100, v101
    v_cvt_pk_bf16_f32 v83, v102, v103
    v_mfma_f32_32x32x16_bf16 v[144:159], v[76:79], v[92:95], v[144:159]
    v_exp_f32 v108, v108
    v_exp_f32 v109, v109
    v_exp_f32 v110, v110
    v_exp_f32 v111, v111
    v_cvt_pk_bf16_f32 v84, v104, v105
    v_cvt_pk_bf16_f32 v85, v106, v107
    v_cvt_pk_bf16_f32 v86, v108, v109
    v_cvt_pk_bf16_f32 v87, v110, v111
    s_waitcnt lgkmcnt(0)
    v_mfma_f32_32x32x16_bf16 v[96:111], v[56:59], v[32:35], 0
    ds_read_b128 v[48:51], v24 offset:64512
    v_exp_f32 v112, v112
    v_exp_f32 v113, v113
    v_exp_f32 v114, v114
    v_exp_f32 v115, v115
    v_mfma_f32_32x32x16_bf16 v[128:143], v[64:67], v[80:83], v[128:143]
    ds_read_b64 v[52:53], v25 offset:64512
    v_exp_f32 v116, v116
    v_exp_f32 v117, v117
    v_exp_f32 v118, v118
    v_exp_f32 v119, v119
    v_cvt_pk_bf16_f32 v88, v112, v113
    v_cvt_pk_bf16_f32 v89, v114, v115
    v_mfma_f32_32x32x8bf16_1k v[96:111], v[60:61], v[36:37], v[96:111]
    ds_read_b64_tr_b16 v[72:73], v26 offset:57856
    v_exp_f32 v120, v120
    v_exp_f32 v121, v121
    v_exp_f32 v122, v122
    v_exp_f32 v123, v123
    v_cvt_pk_bf16_f32 v90, v116, v117
    v_cvt_pk_bf16_f32 v91, v118, v119
    v_mfma_f32_32x32x16_bf16 v[128:143], v[68:71], v[84:87], v[128:143]
    ds_read_b64_tr_b16 v[74:75], v27 offset:57856
    v_exp_f32 v124, v124
    v_exp_f32 v125, v125
    v_exp_f32 v126, v126
    v_exp_f32 v127, v127
    v_cvt_pk_bf16_f32 v92, v120, v121
    v_cvt_pk_bf16_f32 v93, v122, v123
    v_cvt_pk_bf16_f32 v94, v124, v125
    v_cvt_pk_bf16_f32 v95, v126, v127
    v_mfma_f32_32x32x16_bf16 v[112:127], v[56:59], v[40:43], 0
    ds_read_b64_tr_b16 v[76:77], v26 offset:58112
    v_exp_f32 v96, v96
    v_exp_f32 v97, v97
    v_exp_f32 v98, v98
    v_exp_f32 v99, v99
    v_mfma_f32_32x32x16_bf16 v[144:159], v[64:67], v[88:91], v[144:159]
    ds_read_b64_tr_b16 v[78:79], v27 offset:58112
    v_exp_f32 v100, v100
    v_exp_f32 v101, v101
    v_exp_f32 v102, v102
    v_exp_f32 v103, v103
    v_cvt_pk_bf16_f32 v80, v96, v97
    v_cvt_pk_bf16_f32 v81, v98, v99
    v_mfma_f32_32x32x8bf16_1k v[112:127], v[60:61], v[44:45], v[112:127]
    v_exp_f32 v104, v104
    v_exp_f32 v105, v105
    v_exp_f32 v106, v106
    v_exp_f32 v107, v107
    v_cvt_pk_bf16_f32 v82, v100, v101
    v_cvt_pk_bf16_f32 v83, v102, v103
    v_mfma_f32_32x32x16_bf16 v[144:159], v[68:71], v[92:95], v[144:159]
    v_exp_f32 v108, v108
    v_exp_f32 v109, v109
    v_exp_f32 v110, v110
    v_exp_f32 v111, v111
    v_cvt_pk_bf16_f32 v84, v104, v105
    v_cvt_pk_bf16_f32 v85, v106, v107
    v_cvt_pk_bf16_f32 v86, v108, v109
    v_cvt_pk_bf16_f32 v87, v110, v111
    s_waitcnt lgkmcnt(0)
    v_mfma_f32_32x32x16_bf16 v[96:111], v[48:51], v[32:35], 0
    ds_read_b128 v[56:59], v24 offset:65024
    v_exp_f32 v112, v112
    v_exp_f32 v113, v113
    v_exp_f32 v114, v114
    v_exp_f32 v115, v115
    v_mfma_f32_32x32x16_bf16 v[128:143], v[72:75], v[80:83], v[128:143]
    ds_read_b64 v[60:61], v25 offset:65024
    v_exp_f32 v116, v116
    v_exp_f32 v117, v117
    v_exp_f32 v118, v118
    v_exp_f32 v119, v119
    v_cvt_pk_bf16_f32 v88, v112, v113
    v_cvt_pk_bf16_f32 v89, v114, v115
    v_mfma_f32_32x32x8bf16_1k v[96:111], v[52:53], v[36:37], v[96:111]
    ds_read_b64_tr_b16 v[64:65], v26 offset:64512
    v_exp_f32 v120, v120
    v_exp_f32 v121, v121
    v_exp_f32 v122, v122
    v_exp_f32 v123, v123
    v_cvt_pk_bf16_f32 v90, v116, v117
    v_cvt_pk_bf16_f32 v91, v118, v119
    v_mfma_f32_32x32x16_bf16 v[128:143], v[76:79], v[84:87], v[128:143]
    ds_read_b64_tr_b16 v[66:67], v27 offset:64512
    v_exp_f32 v124, v124
    v_exp_f32 v125, v125
    v_exp_f32 v126, v126
    v_exp_f32 v127, v127
    v_cvt_pk_bf16_f32 v92, v120, v121
    v_cvt_pk_bf16_f32 v93, v122, v123
    v_cvt_pk_bf16_f32 v94, v124, v125
    v_cvt_pk_bf16_f32 v95, v126, v127
    v_mfma_f32_32x32x16_bf16 v[112:127], v[48:51], v[40:43], 0
    ds_read_b64_tr_b16 v[68:69], v26 offset:64768
    v_exp_f32 v96, v96
    v_exp_f32 v97, v97
    v_exp_f32 v98, v98
    v_exp_f32 v99, v99
    v_mfma_f32_32x32x16_bf16 v[144:159], v[72:75], v[88:91], v[144:159]
    ds_read_b64_tr_b16 v[70:71], v27 offset:64768
    v_exp_f32 v100, v100
    v_exp_f32 v101, v101
    v_exp_f32 v102, v102
    v_exp_f32 v103, v103
    v_cvt_pk_bf16_f32 v80, v96, v97
    v_cvt_pk_bf16_f32 v81, v98, v99
    v_mfma_f32_32x32x8bf16_1k v[112:127], v[52:53], v[44:45], v[112:127]
    v_exp_f32 v104, v104
    v_exp_f32 v105, v105
    v_exp_f32 v106, v106
    v_exp_f32 v107, v107
    v_cvt_pk_bf16_f32 v82, v100, v101
    v_cvt_pk_bf16_f32 v83, v102, v103
    v_mfma_f32_32x32x16_bf16 v[144:159], v[76:79], v[92:95], v[144:159]
    v_exp_f32 v108, v108
    v_exp_f32 v109, v109
    v_exp_f32 v110, v110
    v_exp_f32 v111, v111
    v_cvt_pk_bf16_f32 v84, v104, v105
    v_cvt_pk_bf16_f32 v85, v106, v107
    v_cvt_pk_bf16_f32 v86, v108, v109
    v_cvt_pk_bf16_f32 v87, v110, v111
    s_waitcnt lgkmcnt(0)
    s_barrier
    v_mfma_f32_32x32x16_bf16 v[96:111], v[56:59], v[32:35], 0
    ds_read_b128 v[48:51], v24 offset:0
    v_exp_f32 v112, v112
    v_exp_f32 v113, v113
    v_exp_f32 v114, v114
    v_exp_f32 v115, v115
    v_mfma_f32_32x32x16_bf16 v[128:143], v[64:67], v[80:83], v[128:143]
    ds_read_b64 v[52:53], v25 offset:0
    v_exp_f32 v116, v116
    v_exp_f32 v117, v117
    v_exp_f32 v118, v118
    v_exp_f32 v119, v119
    v_cvt_pk_bf16_f32 v88, v112, v113
    v_cvt_pk_bf16_f32 v89, v114, v115
    v_mfma_f32_32x32x8bf16_1k v[96:111], v[60:61], v[36:37], v[96:111]
    ds_read_b64_tr_b16 v[72:73], v26 offset:65024
    v_exp_f32 v120, v120
    v_exp_f32 v121, v121
    v_exp_f32 v122, v122
    v_exp_f32 v123, v123
    v_cvt_pk_bf16_f32 v90, v116, v117
    v_cvt_pk_bf16_f32 v91, v118, v119
    v_mfma_f32_32x32x16_bf16 v[128:143], v[68:71], v[84:87], v[128:143]
    ds_read_b64_tr_b16 v[74:75], v27 offset:65024
    v_exp_f32 v124, v124
    v_exp_f32 v125, v125
    v_exp_f32 v126, v126
    v_exp_f32 v127, v127
    v_cvt_pk_bf16_f32 v92, v120, v121
    v_cvt_pk_bf16_f32 v93, v122, v123
    v_cvt_pk_bf16_f32 v94, v124, v125
    v_cvt_pk_bf16_f32 v95, v126, v127
    v_mfma_f32_32x32x16_bf16 v[112:127], v[56:59], v[40:43], 0
    ds_read_b64_tr_b16 v[76:77], v26 offset:65280
    v_exp_f32 v96, v96
    v_exp_f32 v97, v97
    v_exp_f32 v98, v98
    v_exp_f32 v99, v99
    v_mfma_f32_32x32x16_bf16 v[144:159], v[64:67], v[88:91], v[144:159]
    ds_read_b64_tr_b16 v[78:79], v27 offset:65280
    v_exp_f32 v100, v100
    v_exp_f32 v101, v101
    v_exp_f32 v102, v102
    v_exp_f32 v103, v103
    v_cvt_pk_bf16_f32 v80, v96, v97
    v_cvt_pk_bf16_f32 v81, v98, v99
    v_mfma_f32_32x32x8bf16_1k v[112:127], v[60:61], v[44:45], v[112:127]
    v_exp_f32 v104, v104
    v_exp_f32 v105, v105
    v_exp_f32 v106, v106
    v_exp_f32 v107, v107
    v_cvt_pk_bf16_f32 v82, v100, v101
    v_cvt_pk_bf16_f32 v83, v102, v103
    v_mfma_f32_32x32x16_bf16 v[144:159], v[68:71], v[92:95], v[144:159]
    v_exp_f32 v108, v108
    v_exp_f32 v109, v109
    v_exp_f32 v110, v110
    v_exp_f32 v111, v111
    v_cvt_pk_bf16_f32 v84, v104, v105
    v_cvt_pk_bf16_f32 v85, v106, v107
    v_cvt_pk_bf16_f32 v86, v108, v109
    v_cvt_pk_bf16_f32 v87, v110, v111
    s_waitcnt lgkmcnt(0)
    v_mfma_f32_32x32x16_bf16 v[96:111], v[48:51], v[32:35], 0
    ds_read_b128 v[56:59], v24 offset:512
    v_exp_f32 v112, v112
    v_exp_f32 v113, v113
    v_exp_f32 v114, v114
    v_exp_f32 v115, v115
    v_mfma_f32_32x32x16_bf16 v[128:143], v[72:75], v[80:83], v[128:143]
    ds_read_b64 v[60:61], v25 offset:512
    v_exp_f32 v116, v116
    v_exp_f32 v117, v117
    v_exp_f32 v118, v118
    v_exp_f32 v119, v119
    v_cvt_pk_bf16_f32 v88, v112, v113
    v_cvt_pk_bf16_f32 v89, v114, v115
    v_mfma_f32_32x32x8bf16_1k v[96:111], v[52:53], v[36:37], v[96:111]
    ds_read_b64_tr_b16 v[64:65], v26 offset:0
    v_exp_f32 v120, v120
    v_exp_f32 v121, v121
    v_exp_f32 v122, v122
    v_exp_f32 v123, v123
    v_cvt_pk_bf16_f32 v90, v116, v117
    v_cvt_pk_bf16_f32 v91, v118, v119
    v_mfma_f32_32x32x16_bf16 v[128:143], v[76:79], v[84:87], v[128:143]
    ds_read_b64_tr_b16 v[66:67], v27 offset:0
    v_exp_f32 v124, v124
    v_exp_f32 v125, v125
    v_exp_f32 v126, v126
    v_exp_f32 v127, v127
    v_cvt_pk_bf16_f32 v92, v120, v121
    v_cvt_pk_bf16_f32 v93, v122, v123
    v_cvt_pk_bf16_f32 v94, v124, v125
    v_cvt_pk_bf16_f32 v95, v126, v127
    v_mfma_f32_32x32x16_bf16 v[112:127], v[48:51], v[40:43], 0
    ds_read_b64_tr_b16 v[68:69], v26 offset:256
    v_exp_f32 v96, v96
    v_exp_f32 v97, v97
    v_exp_f32 v98, v98
    v_exp_f32 v99, v99
    v_mfma_f32_32x32x16_bf16 v[144:159], v[72:75], v[88:91], v[144:159]
    ds_read_b64_tr_b16 v[70:71], v27 offset:256
    v_exp_f32 v100, v100
    v_exp_f32 v101, v101
    v_exp_f32 v102, v102
    v_exp_f32 v103, v103
    v_cvt_pk_bf16_f32 v80, v96, v97
    v_cvt_pk_bf16_f32 v81, v98, v99
    v_mfma_f32_32x32x8bf16_1k v[112:127], v[52:53], v[44:45], v[112:127]
    v_exp_f32 v104, v104
    v_exp_f32 v105, v105
    v_exp_f32 v106, v106
    v_exp_f32 v107, v107
    v_cvt_pk_bf16_f32 v82, v100, v101
    v_cvt_pk_bf16_f32 v83, v102, v103
    v_mfma_f32_32x32x16_bf16 v[144:159], v[76:79], v[92:95], v[144:159]
    v_exp_f32 v108, v108
    v_exp_f32 v109, v109
    v_exp_f32 v110, v110
    v_exp_f32 v111, v111
    v_cvt_pk_bf16_f32 v84, v104, v105
    v_cvt_pk_bf16_f32 v85, v106, v107
    v_cvt_pk_bf16_f32 v86, v108, v109
    v_cvt_pk_bf16_f32 v87, v110, v111
    s_waitcnt lgkmcnt(0)
    v_mfma_f32_32x32x16_bf16 v[96:111], v[56:59], v[32:35], 0
    ds_read_b128 v[48:51], v24 offset:7168
    v_exp_f32 v112, v112
    v_exp_f32 v113, v113
    v_exp_f32 v114, v114
    v_exp_f32 v115, v115
    v_mfma_f32_32x32x16_bf16 v[128:143], v[64:67], v[80:83], v[128:143]
    ds_read_b64 v[52:53], v25 offset:7168
    v_exp_f32 v116, v116
    v_exp_f32 v117, v117
    v_exp_f32 v118, v118
    v_exp_f32 v119, v119
    v_cvt_pk_bf16_f32 v88, v112, v113
    v_cvt_pk_bf16_f32 v89, v114, v115
    v_mfma_f32_32x32x8bf16_1k v[96:111], v[60:61], v[36:37], v[96:111]
    ds_read_b64_tr_b16 v[72:73], v26 offset:512
    v_exp_f32 v120, v120
    v_exp_f32 v121, v121
    v_exp_f32 v122, v122
    v_exp_f32 v123, v123
    v_cvt_pk_bf16_f32 v90, v116, v117
    v_cvt_pk_bf16_f32 v91, v118, v119
    v_mfma_f32_32x32x16_bf16 v[128:143], v[68:71], v[84:87], v[128:143]
    ds_read_b64_tr_b16 v[74:75], v27 offset:512
    v_exp_f32 v124, v124
    v_exp_f32 v125, v125
    v_exp_f32 v126, v126
    v_exp_f32 v127, v127
    v_cvt_pk_bf16_f32 v92, v120, v121
    v_cvt_pk_bf16_f32 v93, v122, v123
    v_cvt_pk_bf16_f32 v94, v124, v125
    v_cvt_pk_bf16_f32 v95, v126, v127
    v_mfma_f32_32x32x16_bf16 v[112:127], v[56:59], v[40:43], 0
    ds_read_b64_tr_b16 v[76:77], v26 offset:768
    v_exp_f32 v96, v96
    v_exp_f32 v97, v97
    v_exp_f32 v98, v98
    v_exp_f32 v99, v99
    v_mfma_f32_32x32x16_bf16 v[144:159], v[64:67], v[88:91], v[144:159]
    ds_read_b64_tr_b16 v[78:79], v27 offset:768
    v_exp_f32 v100, v100
    v_exp_f32 v101, v101
    v_exp_f32 v102, v102
    v_exp_f32 v103, v103
    v_cvt_pk_bf16_f32 v80, v96, v97
    v_cvt_pk_bf16_f32 v81, v98, v99
    v_mfma_f32_32x32x8bf16_1k v[112:127], v[60:61], v[44:45], v[112:127]
    v_exp_f32 v104, v104
    v_exp_f32 v105, v105
    v_exp_f32 v106, v106
    v_exp_f32 v107, v107
    v_cvt_pk_bf16_f32 v82, v100, v101
    v_cvt_pk_bf16_f32 v83, v102, v103
    v_mfma_f32_32x32x16_bf16 v[144:159], v[68:71], v[92:95], v[144:159]
    v_exp_f32 v108, v108
    v_exp_f32 v109, v109
    v_exp_f32 v110, v110
    v_exp_f32 v111, v111
    v_cvt_pk_bf16_f32 v84, v104, v105
    v_cvt_pk_bf16_f32 v85, v106, v107
    v_cvt_pk_bf16_f32 v86, v108, v109
    v_cvt_pk_bf16_f32 v87, v110, v111
    s_waitcnt lgkmcnt(0)
    v_mfma_f32_32x32x16_bf16 v[96:111], v[48:51], v[32:35], 0
    ds_read_b128 v[56:59], v24 offset:7680
    v_exp_f32 v112, v112
    v_exp_f32 v113, v113
    v_exp_f32 v114, v114
    v_exp_f32 v115, v115
    v_mfma_f32_32x32x16_bf16 v[128:143], v[72:75], v[80:83], v[128:143]
    ds_read_b64 v[60:61], v25 offset:7680
    v_exp_f32 v116, v116
    v_exp_f32 v117, v117
    v_exp_f32 v118, v118
    v_exp_f32 v119, v119
    v_cvt_pk_bf16_f32 v88, v112, v113
    v_cvt_pk_bf16_f32 v89, v114, v115
    v_mfma_f32_32x32x8bf16_1k v[96:111], v[52:53], v[36:37], v[96:111]
    ds_read_b64_tr_b16 v[64:65], v26 offset:7168
    v_exp_f32 v120, v120
    v_exp_f32 v121, v121
    v_exp_f32 v122, v122
    v_exp_f32 v123, v123
    v_cvt_pk_bf16_f32 v90, v116, v117
    v_cvt_pk_bf16_f32 v91, v118, v119
    v_mfma_f32_32x32x16_bf16 v[128:143], v[76:79], v[84:87], v[128:143]
    ds_read_b64_tr_b16 v[66:67], v27 offset:7168
    v_exp_f32 v124, v124
    v_exp_f32 v125, v125
    v_exp_f32 v126, v126
    v_exp_f32 v127, v127
    v_cvt_pk_bf16_f32 v92, v120, v121
    v_cvt_pk_bf16_f32 v93, v122, v123
    v_cvt_pk_bf16_f32 v94, v124, v125
    v_cvt_pk_bf16_f32 v95, v126, v127
    v_mfma_f32_32x32x16_bf16 v[112:127], v[48:51], v[40:43], 0
    ds_read_b64_tr_b16 v[68:69], v26 offset:7424
    v_exp_f32 v96, v96
    v_exp_f32 v97, v97
    v_exp_f32 v98, v98
    v_exp_f32 v99, v99
    v_mfma_f32_32x32x16_bf16 v[144:159], v[72:75], v[88:91], v[144:159]
    ds_read_b64_tr_b16 v[70:71], v27 offset:7424
    v_exp_f32 v100, v100
    v_exp_f32 v101, v101
    v_exp_f32 v102, v102
    v_exp_f32 v103, v103
    v_cvt_pk_bf16_f32 v80, v96, v97
    v_cvt_pk_bf16_f32 v81, v98, v99
    v_mfma_f32_32x32x8bf16_1k v[112:127], v[52:53], v[44:45], v[112:127]
    v_exp_f32 v104, v104
    v_exp_f32 v105, v105
    v_exp_f32 v106, v106
    v_exp_f32 v107, v107
    v_cvt_pk_bf16_f32 v82, v100, v101
    v_cvt_pk_bf16_f32 v83, v102, v103
    v_mfma_f32_32x32x16_bf16 v[144:159], v[76:79], v[92:95], v[144:159]
    v_exp_f32 v108, v108
    v_exp_f32 v109, v109
    v_exp_f32 v110, v110
    v_exp_f32 v111, v111
    v_cvt_pk_bf16_f32 v84, v104, v105
    v_cvt_pk_bf16_f32 v85, v106, v107
    v_cvt_pk_bf16_f32 v86, v108, v109
    v_cvt_pk_bf16_f32 v87, v110, v111
    s_waitcnt lgkmcnt(0)
    v_mfma_f32_32x32x16_bf16 v[96:111], v[56:59], v[32:35], 0
    ds_read_b128 v[48:51], v24 offset:14336
    v_exp_f32 v112, v112
    v_exp_f32 v113, v113
    v_exp_f32 v114, v114
    v_exp_f32 v115, v115
    v_mfma_f32_32x32x16_bf16 v[128:143], v[64:67], v[80:83], v[128:143]
    ds_read_b64 v[52:53], v25 offset:14336
    v_exp_f32 v116, v116
    v_exp_f32 v117, v117
    v_exp_f32 v118, v118
    v_exp_f32 v119, v119
    v_cvt_pk_bf16_f32 v88, v112, v113
    v_cvt_pk_bf16_f32 v89, v114, v115
    v_mfma_f32_32x32x8bf16_1k v[96:111], v[60:61], v[36:37], v[96:111]
    ds_read_b64_tr_b16 v[72:73], v26 offset:7680
    v_exp_f32 v120, v120
    v_exp_f32 v121, v121
    v_exp_f32 v122, v122
    v_exp_f32 v123, v123
    v_cvt_pk_bf16_f32 v90, v116, v117
    v_cvt_pk_bf16_f32 v91, v118, v119
    v_mfma_f32_32x32x16_bf16 v[128:143], v[68:71], v[84:87], v[128:143]
    ds_read_b64_tr_b16 v[74:75], v27 offset:7680
    v_exp_f32 v124, v124
    v_exp_f32 v125, v125
    v_exp_f32 v126, v126
    v_exp_f32 v127, v127
    v_cvt_pk_bf16_f32 v92, v120, v121
    v_cvt_pk_bf16_f32 v93, v122, v123
    v_cvt_pk_bf16_f32 v94, v124, v125
    v_cvt_pk_bf16_f32 v95, v126, v127
    v_mfma_f32_32x32x16_bf16 v[112:127], v[56:59], v[40:43], 0
    ds_read_b64_tr_b16 v[76:77], v26 offset:7936
    v_exp_f32 v96, v96
    v_exp_f32 v97, v97
    v_exp_f32 v98, v98
    v_exp_f32 v99, v99
    v_mfma_f32_32x32x16_bf16 v[144:159], v[64:67], v[88:91], v[144:159]
    ds_read_b64_tr_b16 v[78:79], v27 offset:7936
    v_exp_f32 v100, v100
    v_exp_f32 v101, v101
    v_exp_f32 v102, v102
    v_exp_f32 v103, v103
    v_cvt_pk_bf16_f32 v80, v96, v97
    v_cvt_pk_bf16_f32 v81, v98, v99
    v_mfma_f32_32x32x8bf16_1k v[112:127], v[60:61], v[44:45], v[112:127]
    v_exp_f32 v104, v104
    v_exp_f32 v105, v105
    v_exp_f32 v106, v106
    v_exp_f32 v107, v107
    v_cvt_pk_bf16_f32 v82, v100, v101
    v_cvt_pk_bf16_f32 v83, v102, v103
    v_mfma_f32_32x32x16_bf16 v[144:159], v[68:71], v[92:95], v[144:159]
    v_exp_f32 v108, v108
    v_exp_f32 v109, v109
    v_exp_f32 v110, v110
    v_exp_f32 v111, v111
    v_cvt_pk_bf16_f32 v84, v104, v105
    v_cvt_pk_bf16_f32 v85, v106, v107
    v_cvt_pk_bf16_f32 v86, v108, v109
    v_cvt_pk_bf16_f32 v87, v110, v111
    s_waitcnt lgkmcnt(0)
    v_mfma_f32_32x32x16_bf16 v[96:111], v[48:51], v[32:35], 0
    ds_read_b128 v[56:59], v24 offset:14848
    v_exp_f32 v112, v112
    v_exp_f32 v113, v113
    v_exp_f32 v114, v114
    v_exp_f32 v115, v115
    v_mfma_f32_32x32x16_bf16 v[128:143], v[72:75], v[80:83], v[128:143]
    ds_read_b64 v[60:61], v25 offset:14848
    v_exp_f32 v116, v116
    v_exp_f32 v117, v117
    v_exp_f32 v118, v118
    v_exp_f32 v119, v119
    v_cvt_pk_bf16_f32 v88, v112, v113
    v_cvt_pk_bf16_f32 v89, v114, v115
    v_mfma_f32_32x32x8bf16_1k v[96:111], v[52:53], v[36:37], v[96:111]
    ds_read_b64_tr_b16 v[64:65], v26 offset:14336
    v_exp_f32 v120, v120
    v_exp_f32 v121, v121
    v_exp_f32 v122, v122
    v_exp_f32 v123, v123
    v_cvt_pk_bf16_f32 v90, v116, v117
    v_cvt_pk_bf16_f32 v91, v118, v119
    v_mfma_f32_32x32x16_bf16 v[128:143], v[76:79], v[84:87], v[128:143]
    ds_read_b64_tr_b16 v[66:67], v27 offset:14336
    v_exp_f32 v124, v124
    v_exp_f32 v125, v125
    v_exp_f32 v126, v126
    v_exp_f32 v127, v127
    v_cvt_pk_bf16_f32 v92, v120, v121
    v_cvt_pk_bf16_f32 v93, v122, v123
    v_cvt_pk_bf16_f32 v94, v124, v125
    v_cvt_pk_bf16_f32 v95, v126, v127
    v_mfma_f32_32x32x16_bf16 v[112:127], v[48:51], v[40:43], 0
    ds_read_b64_tr_b16 v[68:69], v26 offset:14592
    v_exp_f32 v96, v96
    v_exp_f32 v97, v97
    v_exp_f32 v98, v98
    v_exp_f32 v99, v99
    v_mfma_f32_32x32x16_bf16 v[144:159], v[72:75], v[88:91], v[144:159]
    ds_read_b64_tr_b16 v[70:71], v27 offset:14592
    v_exp_f32 v100, v100
    v_exp_f32 v101, v101
    v_exp_f32 v102, v102
    v_exp_f32 v103, v103
    v_cvt_pk_bf16_f32 v80, v96, v97
    v_cvt_pk_bf16_f32 v81, v98, v99
    v_mfma_f32_32x32x8bf16_1k v[112:127], v[52:53], v[44:45], v[112:127]
    v_exp_f32 v104, v104
    v_exp_f32 v105, v105
    v_exp_f32 v106, v106
    v_exp_f32 v107, v107
    v_cvt_pk_bf16_f32 v82, v100, v101
    v_cvt_pk_bf16_f32 v83, v102, v103
L_pad0_2:
    s_cbranch_execz L_chain0_ret
    v_mfma_f32_32x32x16_bf16 v[144:159], v[76:79], v[92:95], v[144:159]
    v_exp_f32 v108, v108
    v_exp_f32 v109, v109
    v_exp_f32 v110, v110
    v_exp_f32 v111, v111
    v_cvt_pk_bf16_f32 v84, v104, v105
    v_cvt_pk_bf16_f32 v85, v106, v107
    v_cvt_pk_bf16_f32 v86, v108, v109
    v_cvt_pk_bf16_f32 v87, v110, v111
    s_waitcnt lgkmcnt(0)
    v_mfma_f32_32x32x16_bf16 v[96:111], v[56:59], v[32:35], 0
    ds_read_b128 v[48:51], v24 offset:21504
    v_exp_f32 v112, v112
    v_exp_f32 v113, v113
    v_exp_f32 v114, v114
    v_exp_f32 v115, v115
    v_mfma_f32_32x32x16_bf16 v[128:143], v[64:67], v[80:83], v[128:143]
    ds_read_b64 v[52:53], v25 offset:21504
    v_exp_f32 v116, v116
    v_exp_f32 v117, v117
    v_exp_f32 v118, v118
    v_exp_f32 v119, v119
    v_cvt_pk_bf16_f32 v88, v112, v113
    v_cvt_pk_bf16_f32 v89, v114, v115
    v_mfma_f32_32x32x8bf16_1k v[96:111], v[60:61], v[36:37], v[96:111]
    ds_read_b64_tr_b16 v[72:73], v26 offset:14848
    v_exp_f32 v120, v120
    v_exp_f32 v121, v121
    v_exp_f32 v122, v122
    v_exp_f32 v123, v123
    v_cvt_pk_bf16_f32 v90, v116, v117
    v_cvt_pk_bf16_f32 v91, v118, v119
    v_mfma_f32_32x32x16_bf16 v[128:143], v[68:71], v[84:87], v[128:143]
    ds_read_b64_tr_b16 v[74:75], v27 offset:14848
    v_exp_f32 v124, v124
    v_exp_f32 v125, v125
    v_exp_f32 v126, v126
    v_exp_f32 v127, v127
    v_cvt_pk_bf16_f32 v92, v120, v121
    v_cvt_pk_bf16_f32 v93, v122, v123
    v_cvt_pk_bf16_f32 v94, v124, v125
    v_cvt_pk_bf16_f32 v95, v126, v127
    v_mfma_f32_32x32x16_bf16 v[112:127], v[56:59], v[40:43], 0
    ds_read_b64_tr_b16 v[76:77], v26 offset:15104
    v_exp_f32 v96, v96
    v_exp_f32 v97, v97
    v_exp_f32 v98, v98
    v_exp_f32 v99, v99
    v_mfma_f32_32x32x16_bf16 v[144:159], v[64:67], v[88:91], v[144:159]
    ds_read_b64_tr_b16 v[78:79], v27 offset:15104
    v_exp_f32 v100, v100
    v_exp_f32 v101, v101
    v_exp_f32 v102, v102
    v_exp_f32 v103, v103
    v_cvt_pk_bf16_f32 v80, v96, v97
    v_cvt_pk_bf16_f32 v81, v98, v99
    v_mfma_f32_32x32x8bf16_1k v[112:127], v[60:61], v[44:45], v[112:127]
    v_exp_f32 v104, v104
    v_exp_f32 v105, v105
    v_exp_f32 v106, v106
    v_exp_f32 v107, v107
    v_cvt_pk_bf16_f32 v82, v100, v101
    v_cvt_pk_bf16_f32 v83, v102, v103
    v_mfma_f32_32x32x16_bf16 v[144:159], v[68:71], v[92:95], v[144:159]
    v_exp_f32 v108, v108
    v_exp_f32 v109, v109
    v_exp_f32 v110, v110
    v_exp_f32 v111, v111
    v_cvt_pk_bf16_f32 v84, v104, v105
    v_cvt_pk_bf16_f32 v85, v106, v107
    v_cvt_pk_bf16_f32 v86, v108, v109
    v_cvt_pk_bf16_f32 v87, v110, v111
    s_waitcnt lgkmcnt(0)
    v_mfma_f32_32x32x16_bf16 v[96:111], v[48:51], v[32:35], 0
    ds_read_b128 v[56:59], v24 offset:22016
    v_exp_f32 v112, v112
    v_exp_f32 v113, v113
    v_exp_f32 v114, v114
    v_exp_f32 v115, v115
    v_mfma_f32_32x32x16_bf16 v[128:143], v[72:75], v[80:83], v[128:143]
    ds_read_b64 v[60:61], v25 offset:22016
    v_exp_f32 v116, v116
    v_exp_f32 v117, v117
    v_exp_f32 v118, v118
    v_exp_f32 v119, v119
    v_cvt_pk_bf16_f32 v88, v112, v113
    v_cvt_pk_bf16_f32 v89, v114, v115
    v_mfma_f32_32x32x8bf16_1k v[96:111], v[52:53], v[36:37], v[96:111]
    ds_read_b64_tr_b16 v[64:65], v26 offset:21504
    v_exp_f32 v120, v120
    v_exp_f32 v121, v121
    v_exp_f32 v122, v122
    v_exp_f32 v123, v123
    v_cvt_pk_bf16_f32 v90, v116, v117
    v_cvt_pk_bf16_f32 v91, v118, v119
    v_mfma_f32_32x32x16_bf16 v[128:143], v[76:79], v[84:87], v[128:143]
    ds_read_b64_tr_b16 v[66:67], v27 offset:21504
    v_exp_f32 v124, v124
    v_exp_f32 v125, v125
    v_exp_f32 v126, v126
    v_exp_f32 v127, v127
    v_cvt_pk_bf16_f32 v92, v120, v121
    v_cvt_pk_bf16_f32 v93, v122, v123
    v_cvt_pk_bf16_f32 v94, v124, v125
    v_cvt_pk_bf16_f32 v95, v126, v127
    v_mfma_f32_32x32x16_bf16 v[112:127], v[48:51], v[40:43], 0
    ds_read_b64_tr_b16 v[68:69], v26 offset:21760
    v_exp_f32 v96, v96
    v_exp_f32 v97, v97
    v_exp_f32 v98, v98
    v_exp_f32 v99, v99
    v_mfma_f32_32x32x16_bf16 v[144:159], v[72:75], v[88:91], v[144:159]
    ds_read_b64_tr_b16 v[70:71], v27 offset:21760
    v_exp_f32 v100, v100
    v_exp_f32 v101, v101
    v_exp_f32 v102, v102
    v_exp_f32 v103, v103
    v_cvt_pk_bf16_f32 v80, v96, v97
    v_cvt_pk_bf16_f32 v81, v98, v99
    v_mfma_f32_32x32x8bf16_1k v[112:127], v[52:53], v[44:45], v[112:127]
    v_exp_f32 v104, v104
    v_exp_f32 v105, v105
    v_exp_f32 v106, v106
    v_exp_f32 v107, v107
    v_cvt_pk_bf16_f32 v82, v100, v101
    v_cvt_pk_bf16_f32 v83, v102, v103
    v_mfma_f32_32x32x16_bf16 v[144:159], v[76:79], v[92:95], v[144:159]
    v_exp_f32 v108, v108
    v_exp_f32 v109, v109
    v_exp_f32 v110, v110
    v_exp_f32 v111, v111
    v_cvt_pk_bf16_f32 v84, v104, v105
    v_cvt_pk_bf16_f32 v85, v106, v107
    v_cvt_pk_bf16_f32 v86, v108, v109
    v_cvt_pk_bf16_f32 v87, v110, v111
    s_waitcnt lgkmcnt(0)
    s_barrier
    v_mfma_f32_32x32x16_bf16 v[96:111], v[56:59], v[32:35], 0
    ds_read_b128 v[48:51], v24 offset:28672
    v_exp_f32 v112, v112
    v_exp_f32 v113, v113
    v_exp_f32 v114, v114
    v_exp_f32 v115, v115
    v_mfma_f32_32x32x16_bf16 v[128:143], v[64:67], v[80:83], v[128:143]
    ds_read_b64 v[52:53], v25 offset:28672
    v_exp_f32 v116, v116
    v_exp_f32 v117, v117
    v_exp_f32 v118, v118
    v_exp_f32 v119, v119
    v_cvt_pk_bf16_f32 v88, v112, v113
    v_cvt_pk_bf16_f32 v89, v114, v115
    v_mfma_f32_32x32x8bf16_1k v[96:111], v[60:61], v[36:37], v[96:111]
    ds_read_b64_tr_b16 v[72:73], v26 offset:22016
    v_exp_f32 v120, v120
    v_exp_f32 v121, v121
    v_exp_f32 v122, v122
    v_exp_f32 v123, v123
    v_cvt_pk_bf16_f32 v90, v116, v117
    v_cvt_pk_bf16_f32 v91, v118, v119
    v_mfma_f32_32x32x16_bf16 v[128:143], v[68:71], v[84:87], v[128:143]
    ds_read_b64_tr_b16 v[74:75], v27 offset:22016
    v_exp_f32 v124, v124
    v_exp_f32 v125, v125
    v_exp_f32 v126, v126
    v_exp_f32 v127, v127
    v_cvt_pk_bf16_f32 v92, v120, v121
    v_cvt_pk_bf16_f32 v93, v122, v123
    v_cvt_pk_bf16_f32 v94, v124, v125
    v_cvt_pk_bf16_f32 v95, v126, v127
    v_mfma_f32_32x32x16_bf16 v[112:127], v[56:59], v[40:43], 0
    ds_read_b64_tr_b16 v[76:77], v26 offset:22272
    v_exp_f32 v96, v96
    v_exp_f32 v97, v97
    v_exp_f32 v98, v98
    v_exp_f32 v99, v99
    v_mfma_f32_32x32x16_bf16 v[144:159], v[64:67], v[88:91], v[144:159]
    ds_read_b64_tr_b16 v[78:79], v27 offset:22272
    v_exp_f32 v100, v100
    v_exp_f32 v101, v101
    v_exp_f32 v102, v102
    v_exp_f32 v103, v103
    v_cvt_pk_bf16_f32 v80, v96, v97
    v_cvt_pk_bf16_f32 v81, v98, v99
    v_mfma_f32_32x32x8bf16_1k v[112:127], v[60:61], v[44:45], v[112:127]
    v_exp_f32 v104, v104
    v_exp_f32 v105, v105
    v_exp_f32 v106, v106
    v_exp_f32 v107, v107
    v_cvt_pk_bf16_f32 v82, v100, v101
    v_cvt_pk_bf16_f32 v83, v102, v103
    v_mfma_f32_32x32x16_bf16 v[144:159], v[68:71], v[92:95], v[144:159]
    v_exp_f32 v108, v108
    v_exp_f32 v109, v109
    v_exp_f32 v110, v110
    v_exp_f32 v111, v111
    v_cvt_pk_bf16_f32 v84, v104, v105
    v_cvt_pk_bf16_f32 v85, v106, v107
    v_cvt_pk_bf16_f32 v86, v108, v109
    v_cvt_pk_bf16_f32 v87, v110, v111
    s_waitcnt lgkmcnt(0)
    v_mfma_f32_32x32x16_bf16 v[96:111], v[48:51], v[32:35], 0
    ds_read_b128 v[56:59], v24 offset:29184
    v_exp_f32 v112, v112
    v_exp_f32 v113, v113
    v_exp_f32 v114, v114
    v_exp_f32 v115, v115
    v_mfma_f32_32x32x16_bf16 v[128:143], v[72:75], v[80:83], v[128:143]
    ds_read_b64 v[60:61], v25 offset:29184
    v_exp_f32 v116, v116
    v_exp_f32 v117, v117
    v_exp_f32 v118, v118
    v_exp_f32 v119, v119
    v_cvt_pk_bf16_f32 v88, v112, v113
    v_cvt_pk_bf16_f32 v89, v114, v115
    v_mfma_f32_32x32x8bf16_1k v[96:111], v[52:53], v[36:37], v[96:111]
    ds_read_b64_tr_b16 v[64:65], v26 offset:28672
    v_exp_f32 v120, v120
    v_exp_f32 v121, v121
    v_exp_f32 v122, v122
    v_exp_f32 v123, v123
    v_cvt_pk_bf16_f32 v90, v116, v117
    v_cvt_pk_bf16_f32 v91, v118, v119
    v_mfma_f32_32x32x16_bf16 v[128:143], v[76:79], v[84:87], v[128:143]
    ds_read_b64_tr_b16 v[66:67], v27 offset:28672
    v_exp_f32 v124, v124
    v_exp_f32 v125, v125
    v_exp_f32 v126, v126
    v_exp_f32 v127, v127
    v_cvt_pk_bf16_f32 v92, v120, v121
    v_cvt_pk_bf16_f32 v93, v122, v123
    v_cvt_pk_bf16_f32 v94, v124, v125
    v_cvt_pk_bf16_f32 v95, v126, v127
    v_mfma_f32_32x32x16_bf16 v[112:127], v[48:51], v[40:43], 0
    ds_read_b64_tr_b16 v[68:69], v26 offset:28928
    v_exp_f32 v96, v96
    v_exp_f32 v97, v97
    v_exp_f32 v98, v98
    v_exp_f32 v99, v99
    v_mfma_f32_32x32x16_bf16 v[144:159], v[72:75], v[88:91], v[144:159]
    ds_read_b64_tr_b16 v[70:71], v27 offset:28928
    v_exp_f32 v100, v100
    v_exp_f32 v101, v101
    v_exp_f32 v102, v102
    v_exp_f32 v103, v103
    v_cvt_pk_bf16_f32 v80, v96, v97
    v_cvt_pk_bf16_f32 v81, v98, v99
    v_mfma_f32_32x32x8bf16_1k v[112:127], v[52:53], v[44:45], v[112:127]
    v_exp_f32 v104, v104
    v_exp_f32 v105, v105
    v_exp_f32 v106, v106
    v_exp_f32 v107, v107
    v_cvt_pk_bf16_f32 v82, v100, v101
    v_cvt_pk_bf16_f32 v83, v102, v103
    v_mfma_f32_32x32x16_bf16 v[144:159], v[76:79], v[92:95], v[144:159]
    v_exp_f32 v108, v108
    v_exp_f32 v109, v109
    v_exp_f32 v110, v110
    v_exp_f32 v111, v111
    v_cvt_pk_bf16_f32 v84, v104, v105
    v_cvt_pk_bf16_f32 v85, v106, v107
    v_cvt_pk_bf16_f32 v86, v108, v109
    v_cvt_pk_bf16_f32 v87, v110, v111
    s_waitcnt lgkmcnt(0)
    v_mfma_f32_32x32x16_bf16 v[96:111], v[56:59], v[32:35], 0
    ds_read_b128 v[48:51], v24 offset:35840
    v_exp_f32 v112, v112
    v_exp_f32 v113, v113
    v_exp_f32 v114, v114
    v_exp_f32 v115, v115
    v_mfma_f32_32x32x16_bf16 v[128:143], v[64:67], v[80:83], v[128:143]
    ds_read_b64 v[52:53], v25 offset:35840
    v_exp_f32 v116, v116
    v_exp_f32 v117, v117
    v_exp_f32 v118, v118
    v_exp_f32 v119, v119
    v_cvt_pk_bf16_f32 v88, v112, v113
    v_cvt_pk_bf16_f32 v89, v114, v115
    v_mfma_f32_32x32x8bf16_1k v[96:111], v[60:61], v[36:37], v[96:111]
    ds_read_b64_tr_b16 v[72:73], v26 offset:29184
    v_exp_f32 v120, v120
    v_exp_f32 v121, v121
    v_exp_f32 v122, v122
    v_exp_f32 v123, v123
    v_cvt_pk_bf16_f32 v90, v116, v117
    v_cvt_pk_bf16_f32 v91, v118, v119
    v_mfma_f32_32x32x16_bf16 v[128:143], v[68:71], v[84:87], v[128:143]
    ds_read_b64_tr_b16 v[74:75], v27 offset:29184
    v_exp_f32 v124, v124
    v_exp_f32 v125, v125
    v_exp_f32 v126, v126
    v_exp_f32 v127, v127
    v_cvt_pk_bf16_f32 v92, v120, v121
    v_cvt_pk_bf16_f32 v93, v122, v123
    v_cvt_pk_bf16_f32 v94, v124, v125
    v_cvt_pk_bf16_f32 v95, v126, v127
    v_mfma_f32_32x32x16_bf16 v[112:127], v[56:59], v[40:43], 0
    ds_read_b64_tr_b16 v[76:77], v26 offset:29440
    v_exp_f32 v96, v96
    v_exp_f32 v97, v97
    v_exp_f32 v98, v98
    v_exp_f32 v99, v99
    v_mfma_f32_32x32x16_bf16 v[144:159], v[64:67], v[88:91], v[144:159]
    ds_read_b64_tr_b16 v[78:79], v27 offset:29440
    v_exp_f32 v100, v100
    v_exp_f32 v101, v101
    v_exp_f32 v102, v102
    v_exp_f32 v103, v103
    v_cvt_pk_bf16_f32 v80, v96, v97
    v_cvt_pk_bf16_f32 v81, v98, v99
    v_mfma_f32_32x32x8bf16_1k v[112:127], v[60:61], v[44:45], v[112:127]
    v_exp_f32 v104, v104
    v_exp_f32 v105, v105
    v_exp_f32 v106, v106
    v_exp_f32 v107, v107
    v_cvt_pk_bf16_f32 v82, v100, v101
    v_cvt_pk_bf16_f32 v83, v102, v103
    v_mfma_f32_32x32x16_bf16 v[144:159], v[68:71], v[92:95], v[144:159]
    v_exp_f32 v108, v108
    v_exp_f32 v109, v109
    v_exp_f32 v110, v110
    v_exp_f32 v111, v111
    v_cvt_pk_bf16_f32 v84, v104, v105
    v_cvt_pk_bf16_f32 v85, v106, v107
    v_cvt_pk_bf16_f32 v86, v108, v109
    v_cvt_pk_bf16_f32 v87, v110, v111
    s_waitcnt lgkmcnt(0)
    v_mfma_f32_32x32x16_bf16 v[96:111], v[48:51], v[32:35], 0
    ds_read_b128 v[56:59], v24 offset:36352
    v_exp_f32 v112, v112
    v_exp_f32 v113, v113
    v_exp_f32 v114, v114
    v_exp_f32 v115, v115
    v_mfma_f32_32x32x16_bf16 v[128:143], v[72:75], v[80:83], v[128:143]
    ds_read_b64 v[60:61], v25 offset:36352
    v_exp_f32 v116, v116
    v_exp_f32 v117, v117
    v_exp_f32 v118, v118
    v_exp_f32 v119, v119
    v_cvt_pk_bf16_f32 v88, v112, v113
    v_cvt_pk_bf16_f32 v89, v114, v115
    v_mfma_f32_32x32x8bf16_1k v[96:111], v[52:53], v[36:37], v[96:111]
    ds_read_b64_tr_b16 v[64:65], v26 offset:35840
    v_exp_f32 v120, v120
    v_exp_f32 v121, v121
    v_exp_f32 v122, v122
    v_exp_f32 v123, v123
    v_cvt_pk_bf16_f32 v90, v116, v117
    v_cvt_pk_bf16_f32 v91, v118, v119
    v_mfma_f32_32x32x16_bf16 v[128:143], v[76:79], v[84:87], v[128:143]
    ds_read_b64_tr_b16 v[66:67], v27 offset:35840
    v_exp_f32 v124, v124
    v_exp_f32 v125, v125
    v_exp_f32 v126, v126
    v_exp_f32 v127, v127
    v_cvt_pk_bf16_f32 v92, v120, v121
    v_cvt_pk_bf16_f32 v93, v122, v123
    v_cvt_pk_bf16_f32 v94, v124, v125
    v_cvt_pk_bf16_f32 v95, v126, v127
    v_mfma_f32_32x32x16_bf16 v[112:127], v[48:51], v[40:43], 0
    ds_read_b64_tr_b16 v[68:69], v26 offset:36096
    v_exp_f32 v96, v96
    v_exp_f32 v97, v97
    v_exp_f32 v98, v98
    v_exp_f32 v99, v99
    v_mfma_f32_32x32x16_bf16 v[144:159], v[72:75], v[88:91], v[144:159]
    ds_read_b64_tr_b16 v[70:71], v27 offset:36096
    v_exp_f32 v100, v100
    v_exp_f32 v101, v101
    v_exp_f32 v102, v102
    v_exp_f32 v103, v103
    v_cvt_pk_bf16_f32 v80, v96, v97
    v_cvt_pk_bf16_f32 v81, v98, v99
    v_mfma_f32_32x32x8bf16_1k v[112:127], v[52:53], v[44:45], v[112:127]
    v_exp_f32 v104, v104
    v_exp_f32 v105, v105
    v_exp_f32 v106, v106
    v_exp_f32 v107, v107
    v_cvt_pk_bf16_f32 v82, v100, v101
    v_cvt_pk_bf16_f32 v83, v102, v103
    v_mfma_f32_32x32x16_bf16 v[144:159], v[76:79], v[92:95], v[144:159]
    v_exp_f32 v108, v108
    v_exp_f32 v109, v109
    v_exp_f32 v110, v110
    v_exp_f32 v111, v111
    v_cvt_pk_bf16_f32 v84, v104, v105
    v_cvt_pk_bf16_f32 v85, v106, v107
    v_cvt_pk_bf16_f32 v86, v108, v109
    v_cvt_pk_bf16_f32 v87, v110, v111
    s_waitcnt lgkmcnt(0)
    v_mfma_f32_32x32x16_bf16 v[96:111], v[56:59], v[32:35], 0
    ds_read_b128 v[48:51], v24 offset:43008
    v_exp_f32 v112, v112
    v_exp_f32 v113, v113
    v_exp_f32 v114, v114
    v_exp_f32 v115, v115
    v_mfma_f32_32x32x16_bf16 v[128:143], v[64:67], v[80:83], v[128:143]
    ds_read_b64 v[52:53], v25 offset:43008
    v_exp_f32 v116, v116
    v_exp_f32 v117, v117
    v_exp_f32 v118, v118
    v_exp_f32 v119, v119
    v_cvt_pk_bf16_f32 v88, v112, v113
    v_cvt_pk_bf16_f32 v89, v114, v115
    v_mfma_f32_32x32x8bf16_1k v[96:111], v[60:61], v[36:37], v[96:111]
    ds_read_b64_tr_b16 v[72:73], v26 offset:36352
    v_exp_f32 v120, v120
    v_exp_f32 v121, v121
    v_exp_f32 v122, v122
    v_exp_f32 v123, v123
    v_cvt_pk_bf16_f32 v90, v116, v117
    v_cvt_pk_bf16_f32 v91, v118, v119
    v_mfma_f32_32x32x16_bf16 v[128:143], v[68:71], v[84:87], v[128:143]
    ds_read_b64_tr_b16 v[74:75], v27 offset:36352
    v_exp_f32 v124, v124
    v_exp_f32 v125, v125
    v_exp_f32 v126, v126
    v_exp_f32 v127, v127
    v_cvt_pk_bf16_f32 v92, v120, v121
    v_cvt_pk_bf16_f32 v93, v122, v123
    v_cvt_pk_bf16_f32 v94, v124, v125
    v_cvt_pk_bf16_f32 v95, v126, v127
    v_mfma_f32_32x32x16_bf16 v[112:127], v[56:59], v[40:43], 0
    ds_read_b64_tr_b16 v[76:77], v26 offset:36608
    v_exp_f32 v96, v96
    v_exp_f32 v97, v97
    v_exp_f32 v98, v98
    v_exp_f32 v99, v99
    v_mfma_f32_32x32x16_bf16 v[144:159], v[64:67], v[88:91], v[144:159]
    ds_read_b64_tr_b16 v[78:79], v27 offset:36608
    v_exp_f32 v100, v100
    v_exp_f32 v101, v101
    v_exp_f32 v102, v102
    v_exp_f32 v103, v103
    v_cvt_pk_bf16_f32 v80, v96, v97
    v_cvt_pk_bf16_f32 v81, v98, v99
    v_mfma_f32_32x32x8bf16_1k v[112:127], v[60:61], v[44:45], v[112:127]
    v_exp_f32 v104, v104
    v_exp_f32 v105, v105
    v_exp_f32 v106, v106
    v_exp_f32 v107, v107
    v_cvt_pk_bf16_f32 v82, v100, v101
    v_cvt_pk_bf16_f32 v83, v102, v103
    v_mfma_f32_32x32x16_bf16 v[144:159], v[68:71], v[92:95], v[144:159]
    v_exp_f32 v108, v108
    v_exp_f32 v109, v109
    v_exp_f32 v110, v110
    v_exp_f32 v111, v111
    v_cvt_pk_bf16_f32 v84, v104, v105
    v_cvt_pk_bf16_f32 v85, v106, v107
    v_cvt_pk_bf16_f32 v86, v108, v109
    v_cvt_pk_bf16_f32 v87, v110, v111
    s_waitcnt lgkmcnt(0)
    v_mfma_f32_32x32x16_bf16 v[96:111], v[48:51], v[32:35], 0
    ds_read_b128 v[56:59], v24 offset:43520
    v_exp_f32 v112, v112
    v_exp_f32 v113, v113
    v_exp_f32 v114, v114
    v_exp_f32 v115, v115
    v_mfma_f32_32x32x16_bf16 v[128:143], v[72:75], v[80:83], v[128:143]
    ds_read_b64 v[60:61], v25 offset:43520
    v_exp_f32 v116, v116
    v_exp_f32 v117, v117
    v_exp_f32 v118, v118
    v_exp_f32 v119, v119
    v_cvt_pk_bf16_f32 v88, v112, v113
    v_cvt_pk_bf16_f32 v89, v114, v115
    v_mfma_f32_32x32x8bf16_1k v[96:111], v[52:53], v[36:37], v[96:111]
    ds_read_b64_tr_b16 v[64:65], v26 offset:43008
    v_exp_f32 v120, v120
    v_exp_f32 v121, v121
    v_exp_f32 v122, v122
    v_exp_f32 v123, v123
    v_cvt_pk_bf16_f32 v90, v116, v117
    v_cvt_pk_bf16_f32 v91, v118, v119
    v_mfma_f32_32x32x16_bf16 v[128:143], v[76:79], v[84:87], v[128:143]
    ds_read_b64_tr_b16 v[66:67], v27 offset:43008
    v_exp_f32 v124, v124
    v_exp_f32 v125, v125
    v_exp_f32 v126, v126
    v_exp_f32 v127, v127
    v_cvt_pk_bf16_f32 v92, v120, v121
    v_cvt_pk_bf16_f32 v93, v122, v123
    v_cvt_pk_bf16_f32 v94, v124, v125
    v_cvt_pk_bf16_f32 v95, v126, v127
    v_mfma_f32_32x32x16_bf16 v[112:127], v[48:51], v[40:43], 0
    ds_read_b64_tr_b16 v[68:69], v26 offset:43264
    v_exp_f32 v96, v96
    v_exp_f32 v97, v97
    v_exp_f32 v98, v98
    v_exp_f32 v99, v99
    v_mfma_f32_32x32x16_bf16 v[144:159], v[72:75], v[88:91], v[144:159]
    ds_read_b64_tr_b16 v[70:71], v27 offset:43264
    v_exp_f32 v100, v100
    v_exp_f32 v101, v101
    v_exp_f32 v102, v102
    v_exp_f32 v103, v103
    v_cvt_pk_bf16_f32 v80, v96, v97
    v_cvt_pk_bf16_f32 v81, v98, v99
    v_mfma_f32_32x32x8bf16_1k v[112:127], v[52:53], v[44:45], v[112:127]
    v_exp_f32 v104, v104
    v_exp_f32 v105, v105
    v_exp_f32 v106, v106
    v_exp_f32 v107, v107
    v_cvt_pk_bf16_f32 v82, v100, v101
    v_cvt_pk_bf16_f32 v83, v102, v103
    v_mfma_f32_32x32x16_bf16 v[144:159], v[76:79], v[92:95], v[144:159]
    v_exp_f32 v108, v108
    v_exp_f32 v109, v109
    v_exp_f32 v110, v110
    v_exp_f32 v111, v111
    v_cvt_pk_bf16_f32 v84, v104, v105
    v_cvt_pk_bf16_f32 v85, v106, v107
    v_cvt_pk_bf16_f32 v86, v108, v109
    v_cvt_pk_bf16_f32 v87, v110, v111
    s_waitcnt lgkmcnt(0)
    v_mfma_f32_32x32x16_bf16 v[96:111], v[56:59], v[32:35], 0
    ds_read_b128 v[48:51], v24 offset:50176
    v_exp_f32 v112, v112
    v_exp_f32 v113, v113
    v_exp_f32 v114, v114
    v_exp_f32 v115, v115
    v_mfma_f32_32x32x16_bf16 v[128:143], v[64:67], v[80:83], v[128:143]
    ds_read_b64 v[52:53], v25 offset:50176
    v_exp_f32 v116, v116
    v_exp_f32 v117, v117
    v_exp_f32 v118, v118
    v_exp_f32 v119, v119
    v_cvt_pk_bf16_f32 v88, v112, v113
    v_cvt_pk_bf16_f32 v89, v114, v115
    v_mfma_f32_32x32x8bf16_1k v[96:111], v[60:61], v[36:37], v[96:111]
    ds_read_b64_tr_b16 v[72:73], v26 offset:43520
    v_exp_f32 v120, v120
    v_exp_f32 v121, v121
    v_exp_f32 v122, v122
    v_exp_f32 v123, v123
    v_cvt_pk_bf16_f32 v90, v116, v117
    v_cvt_pk_bf16_f32 v91, v118, v119
    v_mfma_f32_32x32x16_bf16 v[128:143], v[68:71], v[84:87], v[128:143]
    ds_read_b64_tr_b16 v[74:75], v27 offset:43520
    v_exp_f32 v124, v124
    v_exp_f32 v125, v125
    v_exp_f32 v126, v126
    v_exp_f32 v127, v127
    v_cvt_pk_bf16_f32 v92, v120, v121
    v_cvt_pk_bf16_f32 v93, v122, v123
    v_cvt_pk_bf16_f32 v94, v124, v125
    v_cvt_pk_bf16_f32 v95, v126, v127
    v_mfma_f32_32x32x16_bf16 v[112:127], v[56:59], v[40:43], 0
    ds_read_b64_tr_b16 v[76:77], v26 offset:43776
    v_exp_f32 v96, v96
    v_exp_f32 v97, v97
    v_exp_f32 v98, v98
    v_exp_f32 v99, v99
    v_mfma_f32_32x32x16_bf16 v[144:159], v[64:67], v[88:91], v[144:159]
    ds_read_b64_tr_b16 v[78:79], v27 offset:43776
    v_exp_f32 v100, v100
    v_exp_f32 v101, v101
    v_exp_f32 v102, v102
    v_exp_f32 v103, v103
    v_cvt_pk_bf16_f32 v80, v96, v97
    v_cvt_pk_bf16_f32 v81, v98, v99
    v_mfma_f32_32x32x8bf16_1k v[112:127], v[60:61], v[44:45], v[112:127]
    v_exp_f32 v104, v104
    v_exp_f32 v105, v105
    v_exp_f32 v106, v106
    v_exp_f32 v107, v107
    v_cvt_pk_bf16_f32 v82, v100, v101
    v_cvt_pk_bf16_f32 v83, v102, v103
    v_mfma_f32_32x32x16_bf16 v[144:159], v[68:71], v[92:95], v[144:159]
    v_exp_f32 v108, v108
    v_exp_f32 v109, v109
    v_exp_f32 v110, v110
    v_exp_f32 v111, v111
    v_cvt_pk_bf16_f32 v84, v104, v105
    v_cvt_pk_bf16_f32 v85, v106, v107
    v_cvt_pk_bf16_f32 v86, v108, v109
    v_cvt_pk_bf16_f32 v87, v110, v111
    s_waitcnt lgkmcnt(0)
    v_mfma_f32_32x32x16_bf16 v[96:111], v[48:51], v[32:35], 0
    ds_read_b128 v[56:59], v24 offset:50688
    v_exp_f32 v112, v112
    v_exp_f32 v113, v113
    v_exp_f32 v114, v114
    v_exp_f32 v115, v115
    v_mfma_f32_32x32x16_bf16 v[128:143], v[72:75], v[80:83], v[128:143]
    ds_read_b64 v[60:61], v25 offset:50688
    v_exp_f32 v116, v116
    v_exp_f32 v117, v117
    v_exp_f32 v118, v118
    v_exp_f32 v119, v119
    v_cvt_pk_bf16_f32 v88, v112, v113
    v_cvt_pk_bf16_f32 v89, v114, v115
    v_mfma_f32_32x32x8bf16_1k v[96:111], v[52:53], v[36:37], v[96:111]
    ds_read_b64_tr_b16 v[64:65], v26 offset:50176
    v_exp_f32 v120, v120
    v_exp_f32 v121, v121
    v_exp_f32 v122, v122
    v_exp_f32 v123, v123
    v_cvt_pk_bf16_f32 v90, v116, v117
    v_cvt_pk_bf16_f32 v91, v118, v119
    v_mfma_f32_32x32x16_bf16 v[128:143], v[76:79], v[84:87], v[128:143]
    ds_read_b64_tr_b16 v[66:67], v27 offset:50176
    v_exp_f32 v124, v124
    v_exp_f32 v125, v125
    v_exp_f32 v126, v126
    v_exp_f32 v127, v127
    v_cvt_pk_bf16_f32 v92, v120, v121
    v_cvt_pk_bf16_f32 v93, v122, v123
    v_cvt_pk_bf16_f32 v94, v124, v125
    v_cvt_pk_bf16_f32 v95, v126, v127
    v_mfma_f32_32x32x16_bf16 v[112:127], v[48:51], v[40:43], 0
    ds_read_b64_tr_b16 v[68:69], v26 offset:50432
    v_exp_f32 v96, v96
    v_exp_f32 v97, v97
    v_exp_f32 v98, v98
    v_exp_f32 v99, v99
    v_mfma_f32_32x32x16_bf16 v[144:159], v[72:75], v[88:91], v[144:159]
    ds_read_b64_tr_b16 v[70:71], v27 offset:50432
    v_exp_f32 v100, v100
    v_exp_f32 v101, v101
    v_exp_f32 v102, v102
    v_exp_f32 v103, v103
    v_cvt_pk_bf16_f32 v80, v96, v97
    v_cvt_pk_bf16_f32 v81, v98, v99
    v_mfma_f32_32x32x8bf16_1k v[112:127], v[52:53], v[44:45], v[112:127]
    v_exp_f32 v104, v104
    v_exp_f32 v105, v105
    v_exp_f32 v106, v106
    v_exp_f32 v107, v107
    v_cvt_pk_bf16_f32 v82, v100, v101
    v_cvt_pk_bf16_f32 v83, v102, v103
    v_mfma_f32_32x32x16_bf16 v[144:159], v[76:79], v[92:95], v[144:159]
    v_exp_f32 v108, v108
    v_exp_f32 v109, v109
    v_exp_f32 v110, v110
    v_exp_f32 v111, v111
    v_cvt_pk_bf16_f32 v84, v104, v105
    v_cvt_pk_bf16_f32 v85, v106, v107
    v_cvt_pk_bf16_f32 v86, v108, v109
    v_cvt_pk_bf16_f32 v87, v110, v111
    s_waitcnt lgkmcnt(0)
    s_barrier
    v_mfma_f32_32x32x16_bf16 v[96:111], v[56:59], v[32:35], 0
    ds_read_b128 v[48:51], v24 offset:57344
    v_exp_f32 v112, v112
    v_exp_f32 v113, v113
    v_exp_f32 v114, v114
    v_exp_f32 v115, v115
    v_mfma_f32_32x32x16_bf16 v[128:143], v[64:67], v[80:83], v[128:143]
    ds_read_b64 v[52:53], v25 offset:57344
    v_exp_f32 v116, v116
    v_exp_f32 v117, v117
    v_exp_f32 v118, v118
    v_exp_f32 v119, v119
    v_cvt_pk_bf16_f32 v88, v112, v113
    v_cvt_pk_bf16_f32 v89, v114, v115
    v_mfma_f32_32x32x8bf16_1k v[96:111], v[60:61], v[36:37], v[96:111]
    ds_read_b64_tr_b16 v[72:73], v26 offset:50688
    v_exp_f32 v120, v120
    v_exp_f32 v121, v121
    v_exp_f32 v122, v122
    v_exp_f32 v123, v123
    v_cvt_pk_bf16_f32 v90, v116, v117
    v_cvt_pk_bf16_f32 v91, v118, v119
    v_mfma_f32_32x32x16_bf16 v[128:143], v[68:71], v[84:87], v[128:143]
    ds_read_b64_tr_b16 v[74:75], v27 offset:50688
    v_exp_f32 v124, v124
    v_exp_f32 v125, v125
    v_exp_f32 v126, v126
    v_exp_f32 v127, v127
    v_cvt_pk_bf16_f32 v92, v120, v121
    v_cvt_pk_bf16_f32 v93, v122, v123
    v_cvt_pk_bf16_f32 v94, v124, v125
    v_cvt_pk_bf16_f32 v95, v126, v127
    v_mfma_f32_32x32x16_bf16 v[112:127], v[56:59], v[40:43], 0
    ds_read_b64_tr_b16 v[76:77], v26 offset:50944
    v_exp_f32 v96, v96
    v_exp_f32 v97, v97
    v_exp_f32 v98, v98
    v_exp_f32 v99, v99
    v_mfma_f32_32x32x16_bf16 v[144:159], v[64:67], v[88:91], v[144:159]
    ds_read_b64_tr_b16 v[78:79], v27 offset:50944
    v_exp_f32 v100, v100
    v_exp_f32 v101, v101
    v_exp_f32 v102, v102
    v_exp_f32 v103, v103
    v_cvt_pk_bf16_f32 v80, v96, v97
    v_cvt_pk_bf16_f32 v81, v98, v99
    v_mfma_f32_32x32x8bf16_1k v[112:127], v[60:61], v[44:45], v[112:127]
    v_exp_f32 v104, v104
    v_exp_f32 v105, v105
    v_exp_f32 v106, v106
    v_exp_f32 v107, v107
    v_cvt_pk_bf16_f32 v82, v100, v101
L_chain1:
    s_cbranch_execz L_pad1_1
    v_cvt_pk_bf16_f32 v83, v102, v103
    v_mfma_f32_32x32x16_bf16 v[144:159], v[68:71], v[92:95], v[144:159]
    v_exp_f32 v108, v108
    v_exp_f32 v109, v109
    v_exp_f32 v110, v110
    v_exp_f32 v111, v111
    v_cvt_pk_bf16_f32 v84, v104, v105
    v_cvt_pk_bf16_f32 v85, v106, v107
    v_cvt_pk_bf16_f32 v86, v108, v109
    v_cvt_pk_bf16_f32 v87, v110, v111
    s_waitcnt lgkmcnt(0)
    v_mfma_f32_32x32x16_bf16 v[96:111], v[48:51], v[32:35], 0
    ds_read_b128 v[56:59], v24 offset:57856
    v_exp_f32 v112, v112
    v_exp_f32 v113, v113
    v_exp_f32 v114, v114
    v_exp_f32 v115, v115
    v_mfma_f32_32x32x16_bf16 v[128:143], v[72:75], v[80:83], v[128:143]
    ds_read_b64 v[60:61], v25 offset:57856
    v_exp_f32 v116, v116
    v_exp_f32 v117, v117
    v_exp_f32 v118, v118
    v_exp_f32 v119, v119
    v_cvt_pk_bf16_f32 v88, v112, v113
    v_cvt_pk_bf16_f32 v89, v114, v115
    v_mfma_f32_32x32x8bf16_1k v[96:111], v[52:53], v[36:37], v[96:111]
    ds_read_b64_tr_b16 v[64:65], v26 offset:57344
    v_exp_f32 v120, v120
    v_exp_f32 v121, v121
    v_exp_f32 v122, v122
    v_exp_f32 v123, v123
    v_cvt_pk_bf16_f32 v90, v116, v117
    v_cvt_pk_bf16_f32 v91, v118, v119
    v_mfma_f32_32x32x16_bf16 v[128:143], v[76:79], v[84:87], v[128:143]
    ds_read_b64_tr_b16 v[66:67], v27 offset:57344
    v_exp_f32 v124, v124
    v_exp_f32 v125, v125
    v_exp_f32 v126, v126
    v_exp_f32 v127, v127
    v_cvt_pk_bf16_f32 v92, v120, v121
    v_cvt_pk_bf16_f32 v93, v122, v123
    v_cvt_pk_bf16_f32 v94, v124, v125
    v_cvt_pk_bf16_f32 v95, v126, v127
    v_mfma_f32_32x32x16_bf16 v[112:127], v[48:51], v[40:43], 0
    ds_read_b64_tr_b16 v[68:69], v26 offset:57600
    v_exp_f32 v96, v96
    v_exp_f32 v97, v97
    v_exp_f32 v98, v98
    v_exp_f32 v99, v99
    v_mfma_f32_32x32x16_bf16 v[144:159], v[72:75], v[88:91], v[144:159]
    ds_read_b64_tr_b16 v[70:71], v27 offset:57600
    v_exp_f32 v100, v100
    v_exp_f32 v101, v101
    v_exp_f32 v102, v102
    v_exp_f32 v103, v103
    v_cvt_pk_bf16_f32 v80, v96, v97
    v_cvt_pk_bf16_f32 v81, v98, v99
    v_mfma_f32_32x32x8bf16_1k v[112:127], v[52:53], v[44:45], v[112:127]
    v_exp_f32 v104, v104
    v_exp_f32 v105, v105
    v_exp_f32 v106, v106
    v_exp_f32 v107, v107
    v_cvt_pk_bf16_f32 v82, v100, v101
    v_cvt_pk_bf16_f32 v83, v102, v103
    v_mfma_f32_32x32x16_bf16 v[144:159], v[76:79], v[92:95], v[144:159]
    v_exp_f32 v108, v108
    v_exp_f32 v109, v109
    v_exp_f32 v110, v110
    v_exp_f32 v111, v111
    v_cvt_pk_bf16_f32 v84, v104, v105
    v_cvt_pk_bf16_f32 v85, v106, v107
    v_cvt_pk_bf16_f32 v86, v108, v109
    v_cvt_pk_bf16_f32 v87, v110, v111
    s_waitcnt lgkmcnt(0)
    v_mfma_f32_32x32x16_bf16 v[96:111], v[56:59], v[32:35], 0
    ds_read_b128 v[48:51], v24 offset:64512
    v_exp_f32 v112, v112
    v_exp_f32 v113, v113
    v_exp_f32 v114, v114
    v_exp_f32 v115, v115
    v_mfma_f32_32x32x16_bf16 v[128:143], v[64:67], v[80:83], v[128:143]
    ds_read_b64 v[52:53], v25 offset:64512
    v_exp_f32 v116, v116
    v_exp_f32 v117, v117
    v_exp_f32 v118, v118
    v_exp_f32 v119, v119
    v_cvt_pk_bf16_f32 v88, v112, v113
    v_cvt_pk_bf16_f32 v89, v114, v115
    v_mfma_f32_32x32x8bf16_1k v[96:111], v[60:61], v[36:37], v[96:111]
    ds_read_b64_tr_b16 v[72:73], v26 offset:57856
    v_exp_f32 v120, v120
    v_exp_f32 v121, v121
    v_exp_f32 v122, v122
    v_exp_f32 v123, v123
    v_cvt_pk_bf16_f32 v90, v116, v117
    v_cvt_pk_bf16_f32 v91, v118, v119
    v_mfma_f32_32x32x16_bf16 v[128:143], v[68:71], v[84:87], v[128:143]
    ds_read_b64_tr_b16 v[74:75], v27 offset:57856
    v_exp_f32 v124, v124
    v_exp_f32 v125, v125
    v_exp_f32 v126, v126
    v_exp_f32 v127, v127
    v_cvt_pk_bf16_f32 v92, v120, v121
    v_cvt_pk_bf16_f32 v93, v122, v123
    v_cvt_pk_bf16_f32 v94, v124, v125
    v_cvt_pk_bf16_f32 v95, v126, v127
    v_mfma_f32_32x32x16_bf16 v[112:127], v[56:59], v[40:43], 0
    ds_read_b64_tr_b16 v[76:77], v26 offset:58112
    v_exp_f32 v96, v96
    v_exp_f32 v97, v97
    v_exp_f32 v98, v98
    v_exp_f32 v99, v99
    v_mfma_f32_32x32x16_bf16 v[144:159], v[64:67], v[88:91], v[144:159]
    ds_read_b64_tr_b16 v[78:79], v27 offset:58112
    v_exp_f32 v100, v100
    v_exp_f32 v101, v101
    v_exp_f32 v102, v102
    v_exp_f32 v103, v103
    v_cvt_pk_bf16_f32 v80, v96, v97
    v_cvt_pk_bf16_f32 v81, v98, v99
    v_mfma_f32_32x32x8bf16_1k v[112:127], v[60:61], v[44:45], v[112:127]
    v_exp_f32 v104, v104
    v_exp_f32 v105, v105
    v_exp_f32 v106, v106
    v_exp_f32 v107, v107
    v_cvt_pk_bf16_f32 v82, v100, v101
    v_cvt_pk_bf16_f32 v83, v102, v103
    v_mfma_f32_32x32x16_bf16 v[144:159], v[68:71], v[92:95], v[144:159]
    v_exp_f32 v108, v108
    v_exp_f32 v109, v109
    v_exp_f32 v110, v110
    v_exp_f32 v111, v111
    v_cvt_pk_bf16_f32 v84, v104, v105
    v_cvt_pk_bf16_f32 v85, v106, v107
    v_cvt_pk_bf16_f32 v86, v108, v109
    v_cvt_pk_bf16_f32 v87, v110, v111
    s_waitcnt lgkmcnt(0)
    v_mfma_f32_32x32x16_bf16 v[96:111], v[48:51], v[32:35], 0
    ds_read_b128 v[56:59], v24 offset:65024
    v_exp_f32 v112, v112
    v_exp_f32 v113, v113
    v_exp_f32 v114, v114
    v_exp_f32 v115, v115
    v_mfma_f32_32x32x16_bf16 v[128:143], v[72:75], v[80:83], v[128:143]
    ds_read_b64 v[60:61], v25 offset:65024
    v_exp_f32 v116, v116
    v_exp_f32 v117, v117
    v_exp_f32 v118, v118
    v_exp_f32 v119, v119
    v_cvt_pk_bf16_f32 v88, v112, v113
    v_cvt_pk_bf16_f32 v89, v114, v115
    v_mfma_f32_32x32x8bf16_1k v[96:111], v[52:53], v[36:37], v[96:111]
    ds_read_b64_tr_b16 v[64:65], v26 offset:64512
    v_exp_f32 v120, v120
    v_exp_f32 v121, v121
    v_exp_f32 v122, v122
    v_exp_f32 v123, v123
    v_cvt_pk_bf16_f32 v90, v116, v117
    v_cvt_pk_bf16_f32 v91, v118, v119
    v_mfma_f32_32x32x16_bf16 v[128:143], v[76:79], v[84:87], v[128:143]
    ds_read_b64_tr_b16 v[66:67], v27 offset:64512
    v_exp_f32 v124, v124
    v_exp_f32 v125, v125
    v_exp_f32 v126, v126
    v_exp_f32 v127, v127
    v_cvt_pk_bf16_f32 v92, v120, v121
    v_cvt_pk_bf16_f32 v93, v122, v123
    v_cvt_pk_bf16_f32 v94, v124, v125
    v_cvt_pk_bf16_f32 v95, v126, v127
    v_mfma_f32_32x32x16_bf16 v[112:127], v[48:51], v[40:43], 0
    ds_read_b64_tr_b16 v[68:69], v26 offset:64768
    v_exp_f32 v96, v96
    v_exp_f32 v97, v97
    v_exp_f32 v98, v98
    v_exp_f32 v99, v99
    v_mfma_f32_32x32x16_bf16 v[144:159], v[72:75], v[88:91], v[144:159]
    ds_read_b64_tr_b16 v[70:71], v27 offset:64768
    v_exp_f32 v100, v100
    v_exp_f32 v101, v101
    v_exp_f32 v102, v102
    v_exp_f32 v103, v103
    v_cvt_pk_bf16_f32 v80, v96, v97
    v_cvt_pk_bf16_f32 v81, v98, v99
    v_mfma_f32_32x32x8bf16_1k v[112:127], v[52:53], v[44:45], v[112:127]
    v_exp_f32 v104, v104
    v_exp_f32 v105, v105
    v_exp_f32 v106, v106
    v_exp_f32 v107, v107
    v_cvt_pk_bf16_f32 v82, v100, v101
    v_cvt_pk_bf16_f32 v83, v102, v103
    v_mfma_f32_32x32x16_bf16 v[144:159], v[76:79], v[92:95], v[144:159]
    v_exp_f32 v108, v108
    v_exp_f32 v109, v109
    v_exp_f32 v110, v110
    v_exp_f32 v111, v111
    v_cvt_pk_bf16_f32 v84, v104, v105
    v_cvt_pk_bf16_f32 v85, v106, v107
    v_cvt_pk_bf16_f32 v86, v108, v109
    v_cvt_pk_bf16_f32 v87, v110, v111
    s_waitcnt lgkmcnt(0)
    v_mfma_f32_32x32x16_bf16 v[96:111], v[56:59], v[32:35], 0
    ds_read_b128 v[48:51], v24 offset:0
    v_exp_f32 v112, v112
    v_exp_f32 v113, v113
    v_exp_f32 v114, v114
    v_exp_f32 v115, v115
    v_mfma_f32_32x32x16_bf16 v[128:143], v[64:67], v[80:83], v[128:143]
    ds_read_b64 v[52:53], v25 offset:0
    v_exp_f32 v116, v116
    v_exp_f32 v117, v117
    v_exp_f32 v118, v118
    v_exp_f32 v119, v119
    v_cvt_pk_bf16_f32 v88, v112, v113
    v_cvt_pk_bf16_f32 v89, v114, v115
    v_mfma_f32_32x32x8bf16_1k v[96:111], v[60:61], v[36:37], v[96:111]
    ds_read_b64_tr_b16 v[72:73], v26 offset:65024
    v_exp_f32 v120, v120
    v_exp_f32 v121, v121
    v_exp_f32 v122, v122
    v_exp_f32 v123, v123
    v_cvt_pk_bf16_f32 v90, v116, v117
    v_cvt_pk_bf16_f32 v91, v118, v119
    v_mfma_f32_32x32x16_bf16 v[128:143], v[68:71], v[84:87], v[128:143]
    ds_read_b64_tr_b16 v[74:75], v27 offset:65024
    v_exp_f32 v124, v124
    v_exp_f32 v125, v125
    v_exp_f32 v126, v126
    v_exp_f32 v127, v127
    v_cvt_pk_bf16_f32 v92, v120, v121
    v_cvt_pk_bf16_f32 v93, v122, v123
    v_cvt_pk_bf16_f32 v94, v124, v125
    v_cvt_pk_bf16_f32 v95, v126, v127
    v_mfma_f32_32x32x16_bf16 v[112:127], v[56:59], v[40:43], 0
    ds_read_b64_tr_b16 v[76:77], v26 offset:65280
    v_exp_f32 v96, v96
    v_exp_f32 v97, v97
    v_exp_f32 v98, v98
    v_exp_f32 v99, v99
    v_mfma_f32_32x32x16_bf16 v[144:159], v[64:67], v[88:91], v[144:159]
    ds_read_b64_tr_b16 v[78:79], v27 offset:65280
    v_exp_f32 v100, v100
    v_exp_f32 v101, v101
    v_exp_f32 v102, v102
    v_exp_f32 v103, v103
    v_cvt_pk_bf16_f32 v80, v96, v97
    v_cvt_pk_bf16_f32 v81, v98, v99
    v_mfma_f32_32x32x8bf16_1k v[112:127], v[60:61], v[44:45], v[112:127]
    v_exp_f32 v104, v104
    v_exp_f32 v105, v105
    v_exp_f32 v106, v106
    v_exp_f32 v107, v107
    v_cvt_pk_bf16_f32 v82, v100, v101
    v_cvt_pk_bf16_f32 v83, v102, v103
    v_mfma_f32_32x32x16_bf16 v[144:159], v[68:71], v[92:95], v[144:159]
    v_exp_f32 v108, v108
    v_exp_f32 v109, v109
    v_exp_f32 v110, v110
    v_exp_f32 v111, v111
    v_cvt_pk_bf16_f32 v84, v104, v105
    v_cvt_pk_bf16_f32 v85, v106, v107
    v_cvt_pk_bf16_f32 v86, v108, v109
    v_cvt_pk_bf16_f32 v87, v110, v111
    s_waitcnt lgkmcnt(0)
    v_mfma_f32_32x32x16_bf16 v[96:111], v[48:51], v[32:35], 0
    ds_read_b128 v[56:59], v24 offset:512
    v_exp_f32 v112, v112
    v_exp_f32 v113, v113
    v_exp_f32 v114, v114
    v_exp_f32 v115, v115
    v_mfma_f32_32x32x16_bf16 v[128:143], v[72:75], v[80:83], v[128:143]
    ds_read_b64 v[60:61], v25 offset:512
    v_exp_f32 v116, v116
    v_exp_f32 v117, v117
    v_exp_f32 v118, v118
    v_exp_f32 v119, v119
    v_cvt_pk_bf16_f32 v88, v112, v113
    v_cvt_pk_bf16_f32 v89, v114, v115
    v_mfma_f32_32x32x8bf16_1k v[96:111], v[52:53], v[36:37], v[96:111]
    ds_read_b64_tr_b16 v[64:65], v26 offset:0
    v_exp_f32 v120, v120
    v_exp_f32 v121, v121
    v_exp_f32 v122, v122
    v_exp_f32 v123, v123
    v_cvt_pk_bf16_f32 v90, v116, v117
    v_cvt_pk_bf16_f32 v91, v118, v119
    v_mfma_f32_32x32x16_bf16 v[128:143], v[76:79], v[84:87], v[128:143]
    ds_read_b64_tr_b16 v[66:67], v27 offset:0
    v_exp_f32 v124, v124
    v_exp_f32 v125, v125
    v_exp_f32 v126, v126
    v_exp_f32 v127, v127
    v_cvt_pk_bf16_f32 v92, v120, v121
    v_cvt_pk_bf16_f32 v93, v122, v123
    v_cvt_pk_bf16_f32 v94, v124, v125
    v_cvt_pk_bf16_f32 v95, v126, v127
    v_mfma_f32_32x32x16_bf16 v[112:127], v[48:51], v[40:43], 0
    ds_read_b64_tr_b16 v[68:69], v26 offset:256
    v_exp_f32 v96, v96
    v_exp_f32 v97, v97
    v_exp_f32 v98, v98
    v_exp_f32 v99, v99
    v_mfma_f32_32x32x16_bf16 v[144:159], v[72:75], v[88:91], v[144:159]
    ds_read_b64_tr_b16 v[70:71], v27 offset:256
    v_exp_f32 v100, v100
    v_exp_f32 v101, v101
    v_exp_f32 v102, v102
    v_exp_f32 v103, v103
    v_cvt_pk_bf16_f32 v80, v96, v97
    v_cvt_pk_bf16_f32 v81, v98, v99
    v_mfma_f32_32x32x8bf16_1k v[112:127], v[52:53], v[44:45], v[112:127]
    v_exp_f32 v104, v104
    v_exp_f32 v105, v105
    v_exp_f32 v106, v106
    v_exp_f32 v107, v107
    v_cvt_pk_bf16_f32 v82, v100, v101
    v_cvt_pk_bf16_f32 v83, v102, v103
    v_mfma_f32_32x32x16_bf16 v[144:159], v[76:79], v[92:95], v[144:159]
    v_exp_f32 v108, v108
    v_exp_f32 v109, v109
    v_exp_f32 v110, v110
    v_exp_f32 v111, v111
    v_cvt_pk_bf16_f32 v84, v104, v105
    v_cvt_pk_bf16_f32 v85, v106, v107
    v_cvt_pk_bf16_f32 v86, v108, v109
    v_cvt_pk_bf16_f32 v87, v110, v111
    s_waitcnt lgkmcnt(0)
    v_mfma_f32_32x32x16_bf16 v[96:111], v[56:59], v[32:35], 0
    ds_read_b128 v[48:51], v24 offset:7168
    v_exp_f32 v112, v112
    v_exp_f32 v113, v113
    v_exp_f32 v114, v114
    v_exp_f32 v115, v115
    v_mfma_f32_32x32x16_bf16 v[128:143], v[64:67], v[80:83], v[128:143]
    ds_read_b64 v[52:53], v25 offset:7168
    v_exp_f32 v116, v116
    v_exp_f32 v117, v117
    v_exp_f32 v118, v118
    v_exp_f32 v119, v119
    v_cvt_pk_bf16_f32 v88, v112, v113
    v_cvt_pk_bf16_f32 v89, v114, v115
    v_mfma_f32_32x32x8bf16_1k v[96:111], v[60:61], v[36:37], v[96:111]
    ds_read_b64_tr_b16 v[72:73], v26 offset:512
    v_exp_f32 v120, v120
    v_exp_f32 v121, v121
    v_exp_f32 v122, v122
    v_exp_f32 v123, v123
    v_cvt_pk_bf16_f32 v90, v116, v117
    v_cvt_pk_bf16_f32 v91, v118, v119
    v_mfma_f32_32x32x16_bf16 v[128:143], v[68:71], v[84:87], v[128:143]
    ds_read_b64_tr_b16 v[74:75], v27 offset:512
    v_exp_f32 v124, v124
    v_exp_f32 v125, v125
    v_exp_f32 v126, v126
    v_exp_f32 v127, v127
    v_cvt_pk_bf16_f32 v92, v120, v121
    v_cvt_pk_bf16_f32 v93, v122, v123
    v_cvt_pk_bf16_f32 v94, v124, v125
    v_cvt_pk_bf16_f32 v95, v126, v127
    v_mfma_f32_32x32x16_bf16 v[112:127], v[56:59], v[40:43], 0
    ds_read_b64_tr_b16 v[76:77], v26 offset:768
    v_exp_f32 v96, v96
    v_exp_f32 v97, v97
    v_exp_f32 v98, v98
    v_exp_f32 v99, v99
    v_mfma_f32_32x32x16_bf16 v[144:159], v[64:67], v[88:91], v[144:159]
    ds_read_b64_tr_b16 v[78:79], v27 offset:768
    v_exp_f32 v100, v100
    v_exp_f32 v101, v101
    v_exp_f32 v102, v102
    v_exp_f32 v103, v103
    v_cvt_pk_bf16_f32 v80, v96, v97
    v_cvt_pk_bf16_f32 v81, v98, v99
    v_mfma_f32_32x32x8bf16_1k v[112:127], v[60:61], v[44:45], v[112:127]
    v_exp_f32 v104, v104
    v_exp_f32 v105, v105
    v_exp_f32 v106, v106
    v_exp_f32 v107, v107
    v_cvt_pk_bf16_f32 v82, v100, v101
    v_cvt_pk_bf16_f32 v83, v102, v103
    v_mfma_f32_32x32x16_bf16 v[144:159], v[68:71], v[92:95], v[144:159]
    v_exp_f32 v108, v108
    v_exp_f32 v109, v109
    v_exp_f32 v110, v110
    v_exp_f32 v111, v111
    v_cvt_pk_bf16_f32 v84, v104, v105
    v_cvt_pk_bf16_f32 v85, v106, v107
    v_cvt_pk_bf16_f32 v86, v108, v109
    v_cvt_pk_bf16_f32 v87, v110, v111
    s_waitcnt lgkmcnt(0)
    v_mfma_f32_32x32x16_bf16 v[96:111], v[48:51], v[32:35], 0
    ds_read_b128 v[56:59], v24 offset:7680
    v_exp_f32 v112, v112
    v_exp_f32 v113, v113
    v_exp_f32 v114, v114
    v_exp_f32 v115, v115
    v_mfma_f32_32x32x16_bf16 v[128:143], v[72:75], v[80:83], v[128:143]
    ds_read_b64 v[60:61], v25 offset:7680
    v_exp_f32 v116, v116
    v_exp_f32 v117, v117
    v_exp_f32 v118, v118
    v_exp_f32 v119, v119
    v_cvt_pk_bf16_f32 v88, v112, v113
    v_cvt_pk_bf16_f32 v89, v114, v115
    v_mfma_f32_32x32x8bf16_1k v[96:111], v[52:53], v[36:37], v[96:111]
    ds_read_b64_tr_b16 v[64:65], v26 offset:7168
    v_exp_f32 v120, v120
    v_exp_f32 v121, v121
    v_exp_f32 v122, v122
    v_exp_f32 v123, v123
    v_cvt_pk_bf16_f32 v90, v116, v117
    v_cvt_pk_bf16_f32 v91, v118, v119
    v_mfma_f32_32x32x16_bf16 v[128:143], v[76:79], v[84:87], v[128:143]
    ds_read_b64_tr_b16 v[66:67], v27 offset:7168
    v_exp_f32 v124, v124
    v_exp_f32 v125, v125
    v_exp_f32 v126, v126
    v_exp_f32 v127, v127
    v_cvt_pk_bf16_f32 v92, v120, v121
    v_cvt_pk_bf16_f32 v93, v122, v123
    v_cvt_pk_bf16_f32 v94, v124, v125
    v_cvt_pk_bf16_f32 v95, v126, v127
    v_mfma_f32_32x32x16_bf16 v[112:127], v[48:51], v[40:43], 0
    ds_read_b64_tr_b16 v[68:69], v26 offset:7424
    v_exp_f32 v96, v96
    v_exp_f32 v97, v97
    v_exp_f32 v98, v98
    v_exp_f32 v99, v99
    v_mfma_f32_32x32x16_bf16 v[144:159], v[72:75], v[88:91], v[144:159]
    ds_read_b64_tr_b16 v[70:71], v27 offset:7424
    v_exp_f32 v100, v100
    v_exp_f32 v101, v101
    v_exp_f32 v102, v102
    v_exp_f32 v103, v103
    v_cvt_pk_bf16_f32 v80, v96, v97
    v_cvt_pk_bf16_f32 v81, v98, v99
    v_mfma_f32_32x32x8bf16_1k v[112:127], v[52:53], v[44:45], v[112:127]
    v_exp_f32 v104, v104
    v_exp_f32 v105, v105
    v_exp_f32 v106, v106
    v_exp_f32 v107, v107
    v_cvt_pk_bf16_f32 v82, v100, v101
    v_cvt_pk_bf16_f32 v83, v102, v103
    v_mfma_f32_32x32x16_bf16 v[144:159], v[76:79], v[92:95], v[144:159]
    v_exp_f32 v108, v108
    v_exp_f32 v109, v109
    v_exp_f32 v110, v110
    v_exp_f32 v111, v111
    v_cvt_pk_bf16_f32 v84, v104, v105
    v_cvt_pk_bf16_f32 v85, v106, v107
    v_cvt_pk_bf16_f32 v86, v108, v109
    v_cvt_pk_bf16_f32 v87, v110, v111
    s_waitcnt lgkmcnt(0)
    s_barrier
    v_mfma_f32_32x32x16_bf16 v[96:111], v[56:59], v[32:35], 0
    ds_read_b128 v[48:51], v24 offset:14336
    v_exp_f32 v112, v112
    v_exp_f32 v113, v113
    v_exp_f32 v114, v114
    v_exp_f32 v115, v115
    v_mfma_f32_32x32x16_bf16 v[128:143], v[64:67], v[80:83], v[128:143]
    ds_read_b64 v[52:53], v25 offset:14336
    v_exp_f32 v116, v116
    v_exp_f32 v117, v117
    v_exp_f32 v118, v118
    v_exp_f32 v119, v119
    v_cvt_pk_bf16_f32 v88, v112, v113
    v_cvt_pk_bf16_f32 v89, v114, v115
    v_mfma_f32_32x32x8bf16_1k v[96:111], v[60:61], v[36:37], v[96:111]
    ds_read_b64_tr_b16 v[72:73], v26 offset:7680
    v_exp_f32 v120, v120
    v_exp_f32 v121, v121
    v_exp_f32 v122, v122
    v_exp_f32 v123, v123
    v_cvt_pk_bf16_f32 v90, v116, v117
    v_cvt_pk_bf16_f32 v91, v118, v119
    v_mfma_f32_32x32x16_bf16 v[128:143], v[68:71], v[84:87], v[128:143]
    ds_read_b64_tr_b16 v[74:75], v27 offset:7680
    v_exp_f32 v124, v124
    v_exp_f32 v125, v125
    v_exp_f32 v126, v126
    v_exp_f32 v127, v127
    v_cvt_pk_bf16_f32 v92, v120, v121
    v_cvt_pk_bf16_f32 v93, v122, v123
    v_cvt_pk_bf16_f32 v94, v124, v125
    v_cvt_pk_bf16_f32 v95, v126, v127
    v_mfma_f32_32x32x16_bf16 v[112:127], v[56:59], v[40:43], 0
    ds_read_b64_tr_b16 v[76:77], v26 offset:7936
    v_exp_f32 v96, v96
    v_exp_f32 v97, v97
    v_exp_f32 v98, v98
    v_exp_f32 v99, v99
    v_mfma_f32_32x32x16_bf16 v[144:159], v[64:67], v[88:91], v[144:159]
    ds_read_b64_tr_b16 v[78:79], v27 offset:7936
    v_exp_f32 v100, v100
    v_exp_f32 v101, v101
    v_exp_f32 v102, v102
    v_exp_f32 v103, v103
    v_cvt_pk_bf16_f32 v80, v96, v97
    v_cvt_pk_bf16_f32 v81, v98, v99
    v_mfma_f32_32x32x8bf16_1k v[112:127], v[60:61], v[44:45], v[112:127]
    ds_read_b128 v[176:179], v19 offset:0
    ds_read_b128 v[180:183], v19 offset:1024
    v_exp_f32 v104, v104
    v_exp_f32 v105, v105
    v_exp_f32 v106, v106
    v_exp_f32 v107, v107
    v_cvt_pk_bf16_f32 v82, v100, v101
    v_cvt_pk_bf16_f32 v83, v102, v103
    v_mfma_f32_32x32x16_bf16 v[144:159], v[68:71], v[92:95], v[144:159]
    ds_read_b128 v[184:187], v19 offset:2048
    ds_read_b128 v[188:191], v19 offset:3072
    v_exp_f32 v108, v108
    v_exp_f32 v109, v109
    v_exp_f32 v110, v110
    v_exp_f32 v111, v111
    v_cvt_pk_bf16_f32 v84, v104, v105
    v_cvt_pk_bf16_f32 v85, v106, v107
    v_cvt_pk_bf16_f32 v86, v108, v109
    v_cvt_pk_bf16_f32 v87, v110, v111
    s_waitcnt lgkmcnt(4)
    v_mfma_f32_32x32x16_bf16 v[96:111], v[48:51], v[32:35], 0
    ds_read_b128 v[56:59], v24 offset:14848
    v_exp_f32 v112, v112
    v_exp_f32 v113, v113
    v_exp_f32 v114, v114
    v_exp_f32 v115, v115
    v_mfma_f32_32x32x16_bf16 v[128:143], v[72:75], v[80:83], v[128:143]
    ds_read_b64 v[60:61], v25 offset:14848
    v_exp_f32 v116, v116
    v_exp_f32 v117, v117
    v_exp_f32 v118, v118
    v_exp_f32 v119, v119
    v_cvt_pk_bf16_f32 v88, v112, v113
    v_cvt_pk_bf16_f32 v89, v114, v115
    v_mfma_f32_32x32x8bf16_1k v[96:111], v[52:53], v[36:37], v[96:111]
    ds_read_b64_tr_b16 v[64:65], v26 offset:14336
    v_exp_f32 v120, v120
    v_exp_f32 v121, v121
    v_exp_f32 v122, v122
    v_exp_f32 v123, v123
    v_cvt_pk_bf16_f32 v90, v116, v117
    v_cvt_pk_bf16_f32 v91, v118, v119
    v_mfma_f32_32x32x16_bf16 v[128:143], v[76:79], v[84:87], v[128:143]
    ds_read_b64_tr_b16 v[66:67], v27 offset:14336
    v_exp_f32 v124, v124
    v_exp_f32 v125, v125
    v_exp_f32 v126, v126
    v_exp_f32 v127, v127
    v_cvt_pk_bf16_f32 v92, v120, v121
    v_cvt_pk_bf16_f32 v93, v122, v123
    v_cvt_pk_bf16_f32 v94, v124, v125
    v_cvt_pk_bf16_f32 v95, v126, v127
    v_mfma_f32_32x32x16_bf16 v[112:127], v[48:51], v[40:43], 0
    ds_read_b64_tr_b16 v[68:69], v26 offset:14592
    v_exp_f32 v96, v96
    v_exp_f32 v97, v97
    v_exp_f32 v98, v98
    v_exp_f32 v99, v99
    v_mfma_f32_32x32x16_bf16 v[144:159], v[72:75], v[88:91], v[144:159]
    ds_read_b64_tr_b16 v[70:71], v27 offset:14592
    v_exp_f32 v100, v100
    v_exp_f32 v101, v101
    v_exp_f32 v102, v102
    v_exp_f32 v103, v103
    v_cvt_pk_bf16_f32 v80, v96, v97
    v_cvt_pk_bf16_f32 v81, v98, v99
    v_mfma_f32_32x32x8bf16_1k v[112:127], v[52:53], v[44:45], v[112:127]
    ds_read_b128 v[192:195], v19 offset:4096
    ds_read_b128 v[196:199], v19 offset:5120
    v_exp_f32 v104, v104
    v_exp_f32 v105, v105
    v_exp_f32 v106, v106
    v_exp_f32 v107, v107
    v_cvt_pk_bf16_f32 v82, v100, v101
    v_cvt_pk_bf16_f32 v83, v102, v103
    v_mfma_f32_32x32x16_bf16 v[144:159], v[76:79], v[92:95], v[144:159]
    ds_read_b128 v[200:203], v19 offset:6144
    ds_read_b128 v[204:207], v19 offset:7168
    v_exp_f32 v108, v108
    v_exp_f32 v109, v109
    v_exp_f32 v110, v110
    v_exp_f32 v111, v111
    v_cvt_pk_bf16_f32 v84, v104, v105
    v_cvt_pk_bf16_f32 v85, v106, v107
    v_cvt_pk_bf16_f32 v86, v108, v109
    v_cvt_pk_bf16_f32 v87, v110, v111
    s_waitcnt lgkmcnt(4)
    v_mfma_f32_32x32x16_bf16 v[96:111], v[56:59], v[32:35], 0
    ds_read_b128 v[48:51], v24 offset:21504
    v_exp_f32 v112, v112
    v_exp_f32 v113, v113
    v_exp_f32 v114, v114
    v_exp_f32 v115, v115
    v_mfma_f32_32x32x16_bf16 v[128:143], v[64:67], v[80:83], v[128:143]
    ds_read_b64 v[52:53], v25 offset:21504
    v_exp_f32 v116, v116
    v_exp_f32 v117, v117
    v_exp_f32 v118, v118
    v_exp_f32 v119, v119
    v_cvt_pk_bf16_f32 v88, v112, v113
    v_cvt_pk_bf16_f32 v89, v114, v115
    v_mfma_f32_32x32x8bf16_1k v[96:111], v[60:61], v[36:37], v[96:111]
    ds_read_b64_tr_b16 v[72:73], v26 offset:14848
    v_exp_f32 v120, v120
    v_exp_f32 v121, v121
    v_exp_f32 v122, v122
    v_exp_f32 v123, v123
    v_cvt_pk_bf16_f32 v90, v116, v117
    v_cvt_pk_bf16_f32 v91, v118, v119
    v_mfma_f32_32x32x16_bf16 v[128:143], v[68:71], v[84:87], v[128:143]
    ds_read_b64_tr_b16 v[74:75], v27 offset:14848
    v_exp_f32 v124, v124
    v_exp_f32 v125, v125
    v_exp_f32 v126, v126
    v_exp_f32 v127, v127
    v_cvt_pk_bf16_f32 v92, v120, v121
    v_cvt_pk_bf16_f32 v93, v122, v123
    v_cvt_pk_bf16_f32 v94, v124, v125
    v_cvt_pk_bf16_f32 v95, v126, v127
    v_mfma_f32_32x32x16_bf16 v[112:127], v[56:59], v[40:43], 0
    ds_read_b64_tr_b16 v[76:77], v26 offset:15104
    v_exp_f32 v96, v96
    v_exp_f32 v97, v97
    v_exp_f32 v98, v98
    v_exp_f32 v99, v99
    v_mfma_f32_32x32x16_bf16 v[144:159], v[64:67], v[88:91], v[144:159]
    ds_read_b64_tr_b16 v[78:79], v27 offset:15104
    v_exp_f32 v100, v100
    v_exp_f32 v101, v101
    v_exp_f32 v102, v102
    v_exp_f32 v103, v103
    v_cvt_pk_bf16_f32 v80, v96, v97
    v_cvt_pk_bf16_f32 v81, v98, v99
    v_mfma_f32_32x32x8bf16_1k v[112:127], v[60:61], v[44:45], v[112:127]
    ds_read_b128 v[208:211], v19 offset:8192
    ds_read_b128 v[212:215], v19 offset:9216
    v_exp_f32 v104, v104
    v_exp_f32 v105, v105
    v_exp_f32 v106, v106
    v_exp_f32 v107, v107
    v_cvt_pk_bf16_f32 v82, v100, v101
    v_cvt_pk_bf16_f32 v83, v102, v103
    v_mfma_f32_32x32x16_bf16 v[144:159], v[68:71], v[92:95], v[144:159]
    ds_read_b128 v[216:219], v19 offset:10240
    ds_read_b128 v[220:223], v19 offset:11264
    v_exp_f32 v108, v108
    v_exp_f32 v109, v109
    v_exp_f32 v110, v110
    v_exp_f32 v111, v111
    v_cvt_pk_bf16_f32 v84, v104, v105
    v_cvt_pk_bf16_f32 v85, v106, v107
    v_cvt_pk_bf16_f32 v86, v108, v109
    v_cvt_pk_bf16_f32 v87, v110, v111
    s_waitcnt lgkmcnt(4)
    v_mfma_f32_32x32x16_bf16 v[96:111], v[48:51], v[32:35], 0
    ds_read_b128 v[56:59], v24 offset:22016
    v_exp_f32 v112, v112
    v_exp_f32 v113, v113
    v_exp_f32 v114, v114
    v_exp_f32 v115, v115
    v_mfma_f32_32x32x16_bf16 v[128:143], v[72:75], v[80:83], v[128:143]
    ds_read_b64 v[60:61], v25 offset:22016
    v_exp_f32 v116, v116
    v_exp_f32 v117, v117
    v_exp_f32 v118, v118
    v_exp_f32 v119, v119
    v_cvt_pk_bf16_f32 v88, v112, v113
    v_cvt_pk_bf16_f32 v89, v114, v115
    v_mfma_f32_32x32x8bf16_1k v[96:111], v[52:53], v[36:37], v[96:111]
    ds_read_b64_tr_b16 v[64:65], v26 offset:21504
    v_exp_f32 v120, v120
    v_exp_f32 v121, v121
    v_exp_f32 v122, v122
    v_exp_f32 v123, v123
    v_cvt_pk_bf16_f32 v90, v116, v117
    v_cvt_pk_bf16_f32 v91, v118, v119
    v_mfma_f32_32x32x16_bf16 v[128:143], v[76:79], v[84:87], v[128:143]
    ds_read_b64_tr_b16 v[66:67], v27 offset:21504
    v_exp_f32 v124, v124
    v_exp_f32 v125, v125
    v_exp_f32 v126, v126
    v_exp_f32 v127, v127
    v_cvt_pk_bf16_f32 v92, v120, v121
    v_cvt_pk_bf16_f32 v93, v122, v123
    v_cvt_pk_bf16_f32 v94, v124, v125
    v_cvt_pk_bf16_f32 v95, v126, v127
    v_mfma_f32_32x32x16_bf16 v[112:127], v[48:51], v[40:43], 0
    ds_read_b64_tr_b16 v[68:69], v26 offset:21760
L_pad1_1:
    s_cbranch_execz L_pad1_2
    v_exp_f32 v96, v96
    v_exp_f32 v97, v97
    v_exp_f32 v98, v98
    v_exp_f32 v99, v99
    v_mfma_f32_32x32x16_bf16 v[144:159], v[72:75], v[88:91], v[144:159]
    ds_read_b64_tr_b16 v[70:71], v27 offset:21760
    v_exp_f32 v100, v100
    v_exp_f32 v101, v101
    v_exp_f32 v102, v102
    v_exp_f32 v103, v103
    v_cvt_pk_bf16_f32 v80, v96, v97
    v_cvt_pk_bf16_f32 v81, v98, v99
    v_mfma_f32_32x32x8bf16_1k v[112:127], v[52:53], v[44:45], v[112:127]
    ds_read_b128 v[224:227], v19 offset:12288
    ds_read_b128 v[228:231], v19 offset:13312
    v_exp_f32 v104, v104
    v_exp_f32 v105, v105
    v_exp_f32 v106, v106
    v_exp_f32 v107, v107
    v_cvt_pk_bf16_f32 v82, v100, v101
    v_cvt_pk_bf16_f32 v83, v102, v103
    v_mfma_f32_32x32x16_bf16 v[144:159], v[76:79], v[92:95], v[144:159]
    ds_read_b128 v[232:235], v19 offset:14336
    ds_read_b128 v[236:239], v19 offset:15360
    v_exp_f32 v108, v108
    v_exp_f32 v109, v109
    v_exp_f32 v110, v110
    v_exp_f32 v111, v111
    v_cvt_pk_bf16_f32 v84, v104, v105
    v_cvt_pk_bf16_f32 v85, v106, v107
    v_cvt_pk_bf16_f32 v86, v108, v109
    v_cvt_pk_bf16_f32 v87, v110, v111
    s_waitcnt lgkmcnt(4)
    v_mfma_f32_32x32x16_bf16 v[96:111], v[56:59], v[32:35], 0
    ds_read_b128 v[48:51], v24 offset:28672
    v_exp_f32 v112, v112
    v_exp_f32 v113, v113
    v_exp_f32 v114, v114
    v_exp_f32 v115, v115
    v_mfma_f32_32x32x16_bf16 v[128:143], v[64:67], v[80:83], v[128:143]
    ds_read_b64 v[52:53], v25 offset:28672
    v_exp_f32 v116, v116
    v_exp_f32 v117, v117
    v_exp_f32 v118, v118
    v_exp_f32 v119, v119
    v_cvt_pk_bf16_f32 v88, v112, v113
    v_cvt_pk_bf16_f32 v89, v114, v115
    v_mfma_f32_32x32x8bf16_1k v[96:111], v[60:61], v[36:37], v[96:111]
    ds_read_b64_tr_b16 v[72:73], v26 offset:22016
    v_exp_f32 v120, v120
    v_exp_f32 v121, v121
    v_exp_f32 v122, v122
    v_exp_f32 v123, v123
    v_cvt_pk_bf16_f32 v90, v116, v117
    v_cvt_pk_bf16_f32 v91, v118, v119
    v_mfma_f32_32x32x16_bf16 v[128:143], v[68:71], v[84:87], v[128:143]
    ds_read_b64_tr_b16 v[74:75], v27 offset:22016
    v_exp_f32 v124, v124
    v_exp_f32 v125, v125
    v_exp_f32 v126, v126
    v_exp_f32 v127, v127
    v_cvt_pk_bf16_f32 v92, v120, v121
    v_cvt_pk_bf16_f32 v93, v122, v123
    v_cvt_pk_bf16_f32 v94, v124, v125
    v_cvt_pk_bf16_f32 v95, v126, v127
    v_mfma_f32_32x32x16_bf16 v[112:127], v[56:59], v[40:43], 0
    ds_read_b64_tr_b16 v[76:77], v26 offset:22272
    v_exp_f32 v96, v96
    v_exp_f32 v97, v97
    v_exp_f32 v98, v98
    v_exp_f32 v99, v99
    v_mfma_f32_32x32x16_bf16 v[144:159], v[64:67], v[88:91], v[144:159]
    ds_read_b64_tr_b16 v[78:79], v27 offset:22272
    v_exp_f32 v100, v100
    v_exp_f32 v101, v101
    v_exp_f32 v102, v102
    v_exp_f32 v103, v103
    v_cvt_pk_bf16_f32 v80, v96, v97
    v_cvt_pk_bf16_f32 v81, v98, v99
    v_mfma_f32_32x32x8bf16_1k v[112:127], v[60:61], v[44:45], v[112:127]
    ds_read_b128 v[240:243], v19 offset:16384
    ds_read_b128 v[244:247], v19 offset:17408
    v_exp_f32 v104, v104
    v_exp_f32 v105, v105
    v_exp_f32 v106, v106
    v_exp_f32 v107, v107
    v_cvt_pk_bf16_f32 v82, v100, v101
    v_cvt_pk_bf16_f32 v83, v102, v103
    v_mfma_f32_32x32x16_bf16 v[144:159], v[68:71], v[92:95], v[144:159]
    ds_read_b128 v[248:251], v19 offset:18432
    ds_read_b128 v[252:255], v19 offset:19456
    v_exp_f32 v108, v108
    v_exp_f32 v109, v109
    v_exp_f32 v110, v110
    v_exp_f32 v111, v111
    v_cvt_pk_bf16_f32 v84, v104, v105
    v_cvt_pk_bf16_f32 v85, v106, v107
    v_cvt_pk_bf16_f32 v86, v108, v109
    v_cvt_pk_bf16_f32 v87, v110, v111
    s_waitcnt lgkmcnt(4)
    v_mfma_f32_32x32x16_bf16 v[96:111], v[48:51], v[32:35], 0
    ds_read_b128 v[56:59], v24 offset:29184
    v_exp_f32 v112, v112
    v_exp_f32 v113, v113
    v_exp_f32 v114, v114
    v_exp_f32 v115, v115
    v_mfma_f32_32x32x16_bf16 v[128:143], v[72:75], v[80:83], v[128:143]
    ds_read_b64 v[60:61], v25 offset:29184
    v_exp_f32 v116, v116
    v_exp_f32 v117, v117
    v_exp_f32 v118, v118
    v_exp_f32 v119, v119
    v_cvt_pk_bf16_f32 v88, v112, v113
    v_cvt_pk_bf16_f32 v89, v114, v115
    v_mfma_f32_32x32x8bf16_1k v[96:111], v[52:53], v[36:37], v[96:111]
    ds_read_b64_tr_b16 v[64:65], v26 offset:28672
    v_exp_f32 v120, v120
    v_exp_f32 v121, v121
    v_exp_f32 v122, v122
    v_exp_f32 v123, v123
    v_cvt_pk_bf16_f32 v90, v116, v117
    v_cvt_pk_bf16_f32 v91, v118, v119
    v_mfma_f32_32x32x16_bf16 v[128:143], v[76:79], v[84:87], v[128:143]
    ds_read_b64_tr_b16 v[66:67], v27 offset:28672
    v_exp_f32 v124, v124
    v_exp_f32 v125, v125
    v_exp_f32 v126, v126
    v_exp_f32 v127, v127
    v_cvt_pk_bf16_f32 v92, v120, v121
    v_cvt_pk_bf16_f32 v93, v122, v123
    v_cvt_pk_bf16_f32 v94, v124, v125
    v_cvt_pk_bf16_f32 v95, v126, v127
    v_mfma_f32_32x32x16_bf16 v[112:127], v[48:51], v[40:43], 0
    ds_read_b64_tr_b16 v[68:69], v26 offset:28928
    v_exp_f32 v96, v96
    v_exp_f32 v97, v97
    v_exp_f32 v98, v98
    v_exp_f32 v99, v99
    v_mfma_f32_32x32x16_bf16 v[144:159], v[72:75], v[88:91], v[144:159]
    ds_read_b64_tr_b16 v[70:71], v27 offset:28928
    v_exp_f32 v100, v100
    v_exp_f32 v101, v101
    v_exp_f32 v102, v102
    v_exp_f32 v103, v103
    v_cvt_pk_bf16_f32 v80, v96, v97
    v_cvt_pk_bf16_f32 v81, v98, v99
    v_mfma_f32_32x32x8bf16_1k v[112:127], v[52:53], v[44:45], v[112:127]
    ds_read_b64 v[160:161], v14 offset:0
    ds_read_b64 v[162:163], v14 offset:32
    v_exp_f32 v104, v104
    v_exp_f32 v105, v105
    v_exp_f32 v106, v106
    v_exp_f32 v107, v107
    v_cvt_pk_bf16_f32 v82, v100, v101
    v_cvt_pk_bf16_f32 v83, v102, v103
    v_mfma_f32_32x32x16_bf16 v[144:159], v[76:79], v[92:95], v[144:159]
    ds_read_b64 v[164:165], v14 offset:64
    ds_read_b64 v[166:167], v14 offset:96
    v_exp_f32 v108, v108
    v_exp_f32 v109, v109
    v_exp_f32 v110, v110
    v_exp_f32 v111, v111
    v_cvt_pk_bf16_f32 v84, v104, v105
    v_cvt_pk_bf16_f32 v85, v106, v107
    v_cvt_pk_bf16_f32 v86, v108, v109
    v_cvt_pk_bf16_f32 v87, v110, v111
    s_waitcnt lgkmcnt(4)
    v_mfma_f32_32x32x16_bf16 v[96:111], v[56:59], v[32:35], 0
    ds_read_b128 v[48:51], v24 offset:35840
    v_exp_f32 v112, v112
    v_exp_f32 v113, v113
    v_exp_f32 v114, v114
    v_exp_f32 v115, v115
    v_mfma_f32_32x32x16_bf16 v[128:143], v[64:67], v[80:83], v[128:143]
    ds_read_b64 v[52:53], v25 offset:35840
    v_exp_f32 v116, v116
    v_exp_f32 v117, v117
    v_exp_f32 v118, v118
    v_exp_f32 v119, v119
    v_cvt_pk_bf16_f32 v88, v112, v113
    v_cvt_pk_bf16_f32 v89, v114, v115
    v_mfma_f32_32x32x8bf16_1k v[96:111], v[60:61], v[36:37], v[96:111]
    ds_read_b64_tr_b16 v[72:73], v26 offset:29184
    v_exp_f32 v120, v120
    v_exp_f32 v121, v121
    v_exp_f32 v122, v122
    v_exp_f32 v123, v123
    v_cvt_pk_bf16_f32 v90, v116, v117
    v_cvt_pk_bf16_f32 v91, v118, v119
    v_mfma_f32_32x32x16_bf16 v[128:143], v[68:71], v[84:87], v[128:143]
    ds_read_b64_tr_b16 v[74:75], v27 offset:29184
    v_exp_f32 v124, v124
    v_exp_f32 v125, v125
    v_exp_f32 v126, v126
    v_exp_f32 v127, v127
    v_cvt_pk_bf16_f32 v92, v120, v121
    v_cvt_pk_bf16_f32 v93, v122, v123
    v_cvt_pk_bf16_f32 v94, v124, v125
    v_cvt_pk_bf16_f32 v95, v126, v127
    v_mfma_f32_32x32x16_bf16 v[112:127], v[56:59], v[40:43], 0
    ds_read_b64_tr_b16 v[76:77], v26 offset:29440
    v_exp_f32 v96, v96
    v_exp_f32 v97, v97
    v_exp_f32 v98, v98
    v_exp_f32 v99, v99
    v_mfma_f32_32x32x16_bf16 v[144:159], v[64:67], v[88:91], v[144:159]
    ds_read_b64_tr_b16 v[78:79], v27 offset:29440
    v_exp_f32 v100, v100
    v_exp_f32 v101, v101
    v_exp_f32 v102, v102
    v_exp_f32 v103, v103
    v_cvt_pk_bf16_f32 v80, v96, v97
    v_cvt_pk_bf16_f32 v81, v98, v99
    v_mfma_f32_32x32x8bf16_1k v[112:127], v[60:61], v[44:45], v[112:127]
    ds_read_b64 v[168:169], v14 offset:128
    v_exp_f32 v104, v104
    v_exp_f32 v105, v105
    v_exp_f32 v106, v106
    v_exp_f32 v107, v107
    v_cvt_pk_bf16_f32 v82, v100, v101
    v_cvt_pk_bf16_f32 v83, v102, v103
    v_mfma_f32_32x32x16_bf16 v[144:159], v[68:71], v[92:95], v[144:159]
    v_exp_f32 v108, v108
    v_exp_f32 v109, v109
    v_exp_f32 v110, v110
    v_exp_f32 v111, v111
    v_cvt_pk_bf16_f32 v84, v104, v105
    v_cvt_pk_bf16_f32 v85, v106, v107
    v_cvt_pk_bf16_f32 v86, v108, v109
    v_cvt_pk_bf16_f32 v87, v110, v111
    s_waitcnt lgkmcnt(1)
    v_mfma_f32_32x32x16_bf16 v[96:111], v[48:51], v[32:35], 0
    ds_read_b128 v[56:59], v24 offset:36352
    v_exp_f32 v112, v112
    v_exp_f32 v113, v113
    v_exp_f32 v114, v114
    v_exp_f32 v115, v115
    v_mfma_f32_32x32x16_bf16 v[128:143], v[72:75], v[80:83], v[128:143]
    ds_read_b64 v[60:61], v25 offset:36352
    v_exp_f32 v116, v116
    v_exp_f32 v117, v117
    v_exp_f32 v118, v118
    v_exp_f32 v119, v119
    v_cvt_pk_bf16_f32 v88, v112, v113
    v_cvt_pk_bf16_f32 v89, v114, v115
    v_mfma_f32_32x32x8bf16_1k v[96:111], v[52:53], v[36:37], v[96:111]
    ds_read_b64_tr_b16 v[64:65], v26 offset:35840
    v_exp_f32 v120, v120
    v_exp_f32 v121, v121
    v_exp_f32 v122, v122
    v_exp_f32 v123, v123
    v_cvt_pk_bf16_f32 v90, v116, v117
    v_cvt_pk_bf16_f32 v91, v118, v119
    v_mfma_f32_32x32x16_bf16 v[128:143], v[76:79], v[84:87], v[128:143]
    ds_read_b64_tr_b16 v[66:67], v27 offset:35840
    v_exp_f32 v124, v124
    v_exp_f32 v125, v125
    v_exp_f32 v126, v126
    v_exp_f32 v127, v127
    v_cvt_pk_bf16_f32 v92, v120, v121
    v_cvt_pk_bf16_f32 v93, v122, v123
    v_cvt_pk_bf16_f32 v94, v124, v125
    v_cvt_pk_bf16_f32 v95, v126, v127
    v_mfma_f32_32x32x16_bf16 v[112:127], v[48:51], v[40:43], 0
    ds_read_b64_tr_b16 v[68:69], v26 offset:36096
    v_exp_f32 v96, v96
    v_exp_f32 v97, v97
    v_exp_f32 v98, v98
    v_exp_f32 v99, v99
    v_mfma_f32_32x32x16_bf16 v[144:159], v[72:75], v[88:91], v[144:159]
    ds_read_b64_tr_b16 v[70:71], v27 offset:36096
    v_exp_f32 v100, v100
    v_exp_f32 v101, v101
    v_exp_f32 v102, v102
    v_exp_f32 v103, v103
    v_cvt_pk_bf16_f32 v80, v96, v97
    v_cvt_pk_bf16_f32 v81, v98, v99
    v_mfma_f32_32x32x8bf16_1k v[112:127], v[52:53], v[44:45], v[112:127]
    v_exp_f32 v104, v104
    v_exp_f32 v105, v105
    v_exp_f32 v106, v106
    v_exp_f32 v107, v107
    v_cvt_pk_bf16_f32 v82, v100, v101
    v_cvt_pk_bf16_f32 v83, v102, v103
    v_mfma_f32_32x32x16_bf16 v[144:159], v[76:79], v[92:95], v[144:159]
    v_exp_f32 v108, v108
    v_exp_f32 v109, v109
    v_exp_f32 v110, v110
    v_exp_f32 v111, v111
    v_cvt_pk_bf16_f32 v84, v104, v105
    v_cvt_pk_bf16_f32 v85, v106, v107
    v_cvt_pk_bf16_f32 v86, v108, v109
    v_cvt_pk_bf16_f32 v87, v110, v111
    s_waitcnt lgkmcnt(0)
    s_barrier
    v_mfma_f32_32x32x16_bf16 v[96:111], v[56:59], v[32:35], 0
    ds_read_b128 v[48:51], v24 offset:43008
    v_exp_f32 v112, v112
    v_exp_f32 v113, v113
    v_exp_f32 v114, v114
    v_exp_f32 v115, v115
    v_mfma_f32_32x32x16_bf16 v[128:143], v[64:67], v[80:83], v[128:143]
    ds_read_b64 v[52:53], v25 offset:43008
    v_exp_f32 v116, v116
    v_exp_f32 v117, v117
    v_exp_f32 v118, v118
    v_exp_f32 v119, v119
    v_cvt_pk_bf16_f32 v88, v112, v113
    v_cvt_pk_bf16_f32 v89, v114, v115
    v_mfma_f32_32x32x8bf16_1k v[96:111], v[60:61], v[36:37], v[96:111]
    ds_read_b64_tr_b16 v[72:73], v26 offset:36352
    v_exp_f32 v120, v120
    v_exp_f32 v121, v121
    v_exp_f32 v122, v122
    v_exp_f32 v123, v123
    v_cvt_pk_bf16_f32 v90, v116, v117
    v_cvt_pk_bf16_f32 v91, v118, v119
    v_mfma_f32_32x32x16_bf16 v[128:143], v[68:71], v[84:87], v[128:143]
    ds_read_b64_tr_b16 v[74:75], v27 offset:36352
    v_exp_f32 v124, v124
    v_exp_f32 v125, v125
    v_exp_f32 v126, v126
    v_exp_f32 v127, v127
    v_cvt_pk_bf16_f32 v92, v120, v121
    v_cvt_pk_bf16_f32 v93, v122, v123
    v_cvt_pk_bf16_f32 v94, v124, v125
    v_cvt_pk_bf16_f32 v95, v126, v127
    v_mfma_f32_32x32x16_bf16 v[112:127], v[56:59], v[40:43], 0
    ds_read_b64_tr_b16 v[76:77], v26 offset:36608
    v_exp_f32 v96, v96
    v_exp_f32 v97, v97
    v_exp_f32 v98, v98
    v_exp_f32 v99, v99
    v_mfma_f32_32x32x16_bf16 v[144:159], v[64:67], v[88:91], v[144:159]
    ds_read_b64_tr_b16 v[78:79], v27 offset:36608
    v_exp_f32 v100, v100
    v_exp_f32 v101, v101
    v_exp_f32 v102, v102
    v_exp_f32 v103, v103
    v_cvt_pk_bf16_f32 v80, v96, v97
    v_cvt_pk_bf16_f32 v81, v98, v99
    v_mfma_f32_32x32x8bf16_1k v[112:127], v[60:61], v[44:45], v[112:127]
    v_exp_f32 v104, v104
    v_exp_f32 v105, v105
    v_exp_f32 v106, v106
    v_exp_f32 v107, v107
    v_cvt_pk_bf16_f32 v82, v100, v101
    v_cvt_pk_bf16_f32 v83, v102, v103
    v_mfma_f32_32x32x16_bf16 v[144:159], v[68:71], v[92:95], v[144:159]
    v_exp_f32 v108, v108
    v_exp_f32 v109, v109
    v_exp_f32 v110, v110
    v_exp_f32 v111, v111
    v_cvt_pk_bf16_f32 v84, v104, v105
    v_cvt_pk_bf16_f32 v85, v106, v107
    v_cvt_pk_bf16_f32 v86, v108, v109
    v_cvt_pk_bf16_f32 v87, v110, v111
    s_waitcnt lgkmcnt(0)
    v_mfma_f32_32x32x16_bf16 v[96:111], v[48:51], v[32:35], 0
    ds_read_b128 v[56:59], v24 offset:43520
    v_exp_f32 v112, v112
    v_exp_f32 v113, v113
    v_exp_f32 v114, v114
    v_exp_f32 v115, v115
    v_mfma_f32_32x32x16_bf16 v[128:143], v[72:75], v[80:83], v[128:143]
    ds_read_b64 v[60:61], v25 offset:43520
    v_exp_f32 v116, v116
    v_exp_f32 v117, v117
    v_exp_f32 v118, v118
    v_exp_f32 v119, v119
    v_cvt_pk_bf16_f32 v88, v112, v113
    v_cvt_pk_bf16_f32 v89, v114, v115
    v_mfma_f32_32x32x8bf16_1k v[96:111], v[52:53], v[36:37], v[96:111]
    ds_read_b64_tr_b16 v[64:65], v26 offset:43008
    v_exp_f32 v120, v120
    v_exp_f32 v121, v121
    v_exp_f32 v122, v122
    v_exp_f32 v123, v123
    v_cvt_pk_bf16_f32 v90, v116, v117
    v_cvt_pk_bf16_f32 v91, v118, v119
    v_mfma_f32_32x32x16_bf16 v[128:143], v[76:79], v[84:87], v[128:143]
    ds_read_b64_tr_b16 v[66:67], v27 offset:43008
    v_exp_f32 v124, v124
    v_exp_f32 v125, v125
    v_exp_f32 v126, v126
    v_exp_f32 v127, v127
    v_cvt_pk_bf16_f32 v92, v120, v121
    v_cvt_pk_bf16_f32 v93, v122, v123
    v_cvt_pk_bf16_f32 v94, v124, v125
    v_cvt_pk_bf16_f32 v95, v126, v127
    v_mfma_f32_32x32x16_bf16 v[112:127], v[48:51], v[40:43], 0
    ds_read_b64_tr_b16 v[68:69], v26 offset:43264
    v_exp_f32 v96, v96
    v_exp_f32 v97, v97
    v_exp_f32 v98, v98
    v_exp_f32 v99, v99
    v_mfma_f32_32x32x16_bf16 v[144:159], v[72:75], v[88:91], v[144:159]
    ds_read_b64_tr_b16 v[70:71], v27 offset:43264
    v_exp_f32 v100, v100
    v_exp_f32 v101, v101
    v_exp_f32 v102, v102
    v_exp_f32 v103, v103
    v_cvt_pk_bf16_f32 v80, v96, v97
    v_cvt_pk_bf16_f32 v81, v98, v99
    v_mfma_f32_32x32x8bf16_1k v[112:127], v[52:53], v[44:45], v[112:127]
    v_exp_f32 v104, v104
    v_exp_f32 v105, v105
    v_exp_f32 v106, v106
    v_exp_f32 v107, v107
    v_cvt_pk_bf16_f32 v82, v100, v101
    v_cvt_pk_bf16_f32 v83, v102, v103
    v_mfma_f32_32x32x16_bf16 v[144:159], v[76:79], v[92:95], v[144:159]
    v_exp_f32 v108, v108
    v_exp_f32 v109, v109
    v_exp_f32 v110, v110
    v_exp_f32 v111, v111
    v_cvt_pk_bf16_f32 v84, v104, v105
    v_cvt_pk_bf16_f32 v85, v106, v107
    v_cvt_pk_bf16_f32 v86, v108, v109
    v_cvt_pk_bf16_f32 v87, v110, v111
    s_waitcnt lgkmcnt(0)
    v_mfma_f32_32x32x16_bf16 v[96:111], v[56:59], v[32:35], 0
    ds_read_b128 v[48:51], v24 offset:50176
    v_exp_f32 v112, v112
    v_exp_f32 v113, v113
    v_exp_f32 v114, v114
    v_exp_f32 v115, v115
    v_mfma_f32_32x32x16_bf16 v[128:143], v[64:67], v[80:83], v[128:143]
    ds_read_b64 v[52:53], v25 offset:50176
    v_exp_f32 v116, v116
    v_exp_f32 v117, v117
    v_exp_f32 v118, v118
    v_exp_f32 v119, v119
    v_cvt_pk_bf16_f32 v88, v112, v113
    v_cvt_pk_bf16_f32 v89, v114, v115
    v_mfma_f32_32x32x8bf16_1k v[96:111], v[60:61], v[36:37], v[96:111]
    ds_read_b64_tr_b16 v[72:73], v26 offset:43520
    v_exp_f32 v120, v120
    v_exp_f32 v121, v121
    v_exp_f32 v122, v122
    v_exp_f32 v123, v123
    v_cvt_pk_bf16_f32 v90, v116, v117
    v_cvt_pk_bf16_f32 v91, v118, v119
    v_mfma_f32_32x32x16_bf16 v[128:143], v[68:71], v[84:87], v[128:143]
    ds_read_b64_tr_b16 v[74:75], v27 offset:43520
    v_exp_f32 v124, v124
    v_exp_f32 v125, v125
    v_exp_f32 v126, v126
    v_exp_f32 v127, v127
    v_cvt_pk_bf16_f32 v92, v120, v121
    v_cvt_pk_bf16_f32 v93, v122, v123
    v_cvt_pk_bf16_f32 v94, v124, v125
    v_cvt_pk_bf16_f32 v95, v126, v127
    v_mfma_f32_32x32x16_bf16 v[112:127], v[56:59], v[40:43], 0
    ds_read_b64_tr_b16 v[76:77], v26 offset:43776
    v_exp_f32 v96, v96
    v_exp_f32 v97, v97
    v_exp_f32 v98, v98
    v_exp_f32 v99, v99
    v_mfma_f32_32x32x16_bf16 v[144:159], v[64:67], v[88:91], v[144:159]
    ds_read_b64_tr_b16 v[78:79], v27 offset:43776
    v_exp_f32 v100, v100
    v_exp_f32 v101, v101
    v_exp_f32 v102, v102
    v_exp_f32 v103, v103
    v_cvt_pk_bf16_f32 v80, v96, v97
    v_cvt_pk_bf16_f32 v81, v98, v99
    v_mfma_f32_32x32x8bf16_1k v[112:127], v[60:61], v[44:45], v[112:127]
    v_exp_f32 v104, v104
    v_exp_f32 v105, v105
    v_exp_f32 v106, v106
    v_exp_f32 v107, v107
    v_cvt_pk_bf16_f32 v82, v100, v101
    v_cvt_pk_bf16_f32 v83, v102, v103
    v_mfma_f32_32x32x16_bf16 v[144:159], v[68:71], v[92:95], v[144:159]
    v_exp_f32 v108, v108
    v_exp_f32 v109, v109
    v_exp_f32 v110, v110
    v_exp_f32 v111, v111
    v_cvt_pk_bf16_f32 v84, v104, v105
    v_cvt_pk_bf16_f32 v85, v106, v107
    v_cvt_pk_bf16_f32 v86, v108, v109
    v_cvt_pk_bf16_f32 v87, v110, v111
    s_waitcnt lgkmcnt(0)
    v_mfma_f32_32x32x16_bf16 v[96:111], v[48:51], v[32:35], 0
    ds_read_b128 v[56:59], v24 offset:50688
    v_exp_f32 v112, v112
    v_exp_f32 v113, v113
    v_exp_f32 v114, v114
    v_exp_f32 v115, v115
    v_mfma_f32_32x32x16_bf16 v[128:143], v[72:75], v[80:83], v[128:143]
    ds_read_b64 v[60:61], v25 offset:50688
    v_exp_f32 v116, v116
    v_exp_f32 v117, v117
    v_exp_f32 v118, v118
    v_exp_f32 v119, v119
    v_cvt_pk_bf16_f32 v88, v112, v113
    v_cvt_pk_bf16_f32 v89, v114, v115
    v_mfma_f32_32x32x8bf16_1k v[96:111], v[52:53], v[36:37], v[96:111]
    ds_read_b64_tr_b16 v[64:65], v26 offset:50176
    v_exp_f32 v120, v120
    v_exp_f32 v121, v121
    v_exp_f32 v122, v122
    v_exp_f32 v123, v123
    v_cvt_pk_bf16_f32 v90, v116, v117
    v_cvt_pk_bf16_f32 v91, v118, v119
    v_mfma_f32_32x32x16_bf16 v[128:143], v[76:79], v[84:87], v[128:143]
    ds_read_b64_tr_b16 v[66:67], v27 offset:50176
    v_exp_f32 v124, v124
    v_exp_f32 v125, v125
    v_exp_f32 v126, v126
    v_exp_f32 v127, v127
    v_cvt_pk_bf16_f32 v92, v120, v121
    v_cvt_pk_bf16_f32 v93, v122, v123
    v_cvt_pk_bf16_f32 v94, v124, v125
    v_cvt_pk_bf16_f32 v95, v126, v127
    v_mfma_f32_32x32x16_bf16 v[112:127], v[48:51], v[40:43], 0
    ds_read_b64_tr_b16 v[68:69], v26 offset:50432
    v_exp_f32 v96, v96
    v_exp_f32 v97, v97
    v_exp_f32 v98, v98
    v_exp_f32 v99, v99
    v_mfma_f32_32x32x16_bf16 v[144:159], v[72:75], v[88:91], v[144:159]
    ds_read_b64_tr_b16 v[70:71], v27 offset:50432
    v_exp_f32 v100, v100
    v_exp_f32 v101, v101
    v_exp_f32 v102, v102
    v_exp_f32 v103, v103
    v_cvt_pk_bf16_f32 v80, v96, v97
    v_cvt_pk_bf16_f32 v81, v98, v99
    v_mfma_f32_32x32x8bf16_1k v[112:127], v[52:53], v[44:45], v[112:127]
    v_exp_f32 v104, v104
    v_exp_f32 v105, v105
    v_exp_f32 v106, v106
    v_exp_f32 v107, v107
    v_cvt_pk_bf16_f32 v82, v100, v101
    v_cvt_pk_bf16_f32 v83, v102, v103
    v_mfma_f32_32x32x16_bf16 v[144:159], v[76:79], v[92:95], v[144:159]
    v_exp_f32 v108, v108
    v_exp_f32 v109, v109
    v_exp_f32 v110, v110
    v_exp_f32 v111, v111
    v_cvt_pk_bf16_f32 v84, v104, v105
    v_cvt_pk_bf16_f32 v85, v106, v107
    v_cvt_pk_bf16_f32 v86, v108, v109
    v_cvt_pk_bf16_f32 v87, v110, v111
    s_waitcnt lgkmcnt(0)
    v_mfma_f32_32x32x16_bf16 v[96:111], v[56:59], v[32:35], 0
    ds_read_b128 v[48:51], v24 offset:57344
    v_exp_f32 v112, v112
    v_exp_f32 v113, v113
    v_exp_f32 v114, v114
    v_exp_f32 v115, v115
    v_mfma_f32_32x32x16_bf16 v[128:143], v[64:67], v[80:83], v[128:143]
    ds_read_b64 v[52:53], v25 offset:57344
    v_exp_f32 v116, v116
    v_exp_f32 v117, v117
    v_exp_f32 v118, v118
    v_exp_f32 v119, v119
    v_cvt_pk_bf16_f32 v88, v112, v113
    v_cvt_pk_bf16_f32 v89, v114, v115
    v_mfma_f32_32x32x8bf16_1k v[96:111], v[60:61], v[36:37], v[96:111]
    ds_read_b64_tr_b16 v[72:73], v26 offset:50688
    v_exp_f32 v120, v120
    v_exp_f32 v121, v121
    v_exp_f32 v122, v122
    v_exp_f32 v123, v123
    v_cvt_pk_bf16_f32 v90, v116, v117
    v_cvt_pk_bf16_f32 v91, v118, v119
    v_mfma_f32_32x32x16_bf16 v[128:143], v[68:71], v[84:87], v[128:143]
    ds_read_b64_tr_b16 v[74:75], v27 offset:50688
    v_exp_f32 v124, v124
    v_exp_f32 v125, v125
    v_exp_f32 v126, v126
    v_exp_f32 v127, v127
    v_cvt_pk_bf16_f32 v92, v120, v121
    v_cvt_pk_bf16_f32 v93, v122, v123
    v_cvt_pk_bf16_f32 v94, v124, v125
    v_cvt_pk_bf16_f32 v95, v126, v127
    v_mfma_f32_32x32x16_bf16 v[112:127], v[56:59], v[40:43], 0
    ds_read_b64_tr_b16 v[76:77], v26 offset:50944
    v_exp_f32 v96, v96
    v_exp_f32 v97, v97
    v_exp_f32 v98, v98
    v_exp_f32 v99, v99
    v_mfma_f32_32x32x16_bf16 v[144:159], v[64:67], v[88:91], v[144:159]
    ds_read_b64_tr_b16 v[78:79], v27 offset:50944
    v_exp_f32 v100, v100
    v_exp_f32 v101, v101
    v_exp_f32 v102, v102
    v_exp_f32 v103, v103
    v_cvt_pk_bf16_f32 v80, v96, v97
    v_cvt_pk_bf16_f32 v81, v98, v99
    v_mfma_f32_32x32x8bf16_1k v[112:127], v[60:61], v[44:45], v[112:127]
    v_exp_f32 v104, v104
    v_exp_f32 v105, v105
    v_exp_f32 v106, v106
    v_exp_f32 v107, v107
    v_cvt_pk_bf16_f32 v82, v100, v101
    v_cvt_pk_bf16_f32 v83, v102, v103
    v_mfma_f32_32x32x16_bf16 v[144:159], v[68:71], v[92:95], v[144:159]
    v_exp_f32 v108, v108
    v_exp_f32 v109, v109
    v_exp_f32 v110, v110
    v_exp_f32 v111, v111
    v_cvt_pk_bf16_f32 v84, v104, v105
    v_cvt_pk_bf16_f32 v85, v106, v107
    v_cvt_pk_bf16_f32 v86, v108, v109
    v_cvt_pk_bf16_f32 v87, v110, v111
    s_waitcnt lgkmcnt(0)
    v_mfma_f32_32x32x16_bf16 v[96:111], v[48:51], v[32:35], 0
    ds_read_b128 v[56:59], v24 offset:57856
    v_exp_f32 v112, v112
    v_exp_f32 v113, v113
    v_exp_f32 v114, v114
    v_exp_f32 v115, v115
    v_mfma_f32_32x32x16_bf16 v[128:143], v[72:75], v[80:83], v[128:143]
    ds_read_b64 v[60:61], v25 offset:57856
    v_exp_f32 v116, v116
    v_exp_f32 v117, v117
    v_exp_f32 v118, v118
    v_exp_f32 v119, v119
    v_cvt_pk_bf16_f32 v88, v112, v113
    v_cvt_pk_bf16_f32 v89, v114, v115
    v_mfma_f32_32x32x8bf16_1k v[96:111], v[52:53], v[36:37], v[96:111]
    ds_read_b64_tr_b16 v[64:65], v26 offset:57344
    v_exp_f32 v120, v120
    v_exp_f32 v121, v121
    v_exp_f32 v122, v122
    v_exp_f32 v123, v123
    v_cvt_pk_bf16_f32 v90, v116, v117
    v_cvt_pk_bf16_f32 v91, v118, v119
    v_mfma_f32_32x32x16_bf16 v[128:143], v[76:79], v[84:87], v[128:143]
    ds_read_b64_tr_b16 v[66:67], v27 offset:57344
    v_exp_f32 v124, v124
    v_exp_f32 v125, v125
    v_exp_f32 v126, v126
    v_exp_f32 v127, v127
    v_cvt_pk_bf16_f32 v92, v120, v121
    v_cvt_pk_bf16_f32 v93, v122, v123
    v_cvt_pk_bf16_f32 v94, v124, v125
    v_cvt_pk_bf16_f32 v95, v126, v127
    v_mfma_f32_32x32x16_bf16 v[112:127], v[48:51], v[40:43], 0
    ds_read_b64_tr_b16 v[68:69], v26 offset:57600
    v_exp_f32 v96, v96
    v_exp_f32 v97, v97
    v_exp_f32 v98, v98
    v_exp_f32 v99, v99
    v_mfma_f32_32x32x16_bf16 v[144:159], v[72:75], v[88:91], v[144:159]
    ds_read_b64_tr_b16 v[70:71], v27 offset:57600
    v_exp_f32 v100, v100
    v_exp_f32 v101, v101
    v_exp_f32 v102, v102
    v_exp_f32 v103, v103
    v_cvt_pk_bf16_f32 v80, v96, v97
    v_cvt_pk_bf16_f32 v81, v98, v99
    v_mfma_f32_32x32x8bf16_1k v[112:127], v[52:53], v[44:45], v[112:127]
    v_exp_f32 v104, v104
    v_exp_f32 v105, v105
    v_exp_f32 v106, v106
    v_exp_f32 v107, v107
    v_cvt_pk_bf16_f32 v82, v100, v101
    v_cvt_pk_bf16_f32 v83, v102, v103
    v_mfma_f32_32x32x16_bf16 v[144:159], v[76:79], v[92:95], v[144:159]
    v_exp_f32 v108, v108
    v_exp_f32 v109, v109
    v_exp_f32 v110, v110
    v_exp_f32 v111, v111
    v_cvt_pk_bf16_f32 v84, v104, v105
    v_cvt_pk_bf16_f32 v85, v106, v107
    v_cvt_pk_bf16_f32 v86, v108, v109
    v_cvt_pk_bf16_f32 v87, v110, v111
    s_waitcnt lgkmcnt(0)
    v_mfma_f32_32x32x16_bf16 v[96:111], v[56:59], v[32:35], 0
    ds_read_b128 v[48:51], v24 offset:64512
    v_exp_f32 v112, v112
    v_exp_f32 v113, v113
    v_exp_f32 v114, v114
    v_exp_f32 v115, v115
    v_mfma_f32_32x32x16_bf16 v[128:143], v[64:67], v[80:83], v[128:143]
    ds_read_b64 v[52:53], v25 offset:64512
    v_exp_f32 v116, v116
    v_exp_f32 v117, v117
    v_exp_f32 v118, v118
    v_exp_f32 v119, v119
    v_cvt_pk_bf16_f32 v88, v112, v113
    v_cvt_pk_bf16_f32 v89, v114, v115
    v_mfma_f32_32x32x8bf16_1k v[96:111], v[60:61], v[36:37], v[96:111]
    ds_read_b64_tr_b16 v[72:73], v26 offset:57856
L_pad1_2:
    s_cbranch_execz L_pad1_3
    v_exp_f32 v120, v120
    v_exp_f32 v121, v121
    v_exp_f32 v122, v122
    v_exp_f32 v123, v123
    v_cvt_pk_bf16_f32 v90, v116, v117
    v_cvt_pk_bf16_f32 v91, v118, v119
    v_mfma_f32_32x32x16_bf16 v[128:143], v[68:71], v[84:87], v[128:143]
    ds_read_b64_tr_b16 v[74:75], v27 offset:57856
    v_exp_f32 v124, v124
    v_exp_f32 v125, v125
    v_exp_f32 v126, v126
    v_exp_f32 v127, v127
    v_cvt_pk_bf16_f32 v92, v120, v121
    v_cvt_pk_bf16_f32 v93, v122, v123
    v_cvt_pk_bf16_f32 v94, v124, v125
    v_cvt_pk_bf16_f32 v95, v126, v127
    v_mfma_f32_32x32x16_bf16 v[112:127], v[56:59], v[40:43], 0
    ds_read_b64_tr_b16 v[76:77], v26 offset:58112
    v_exp_f32 v96, v96
    v_exp_f32 v97, v97
    v_exp_f32 v98, v98
    v_exp_f32 v99, v99
    v_mfma_f32_32x32x16_bf16 v[144:159], v[64:67], v[88:91], v[144:159]
    ds_read_b64_tr_b16 v[78:79], v27 offset:58112
    v_exp_f32 v100, v100
    v_exp_f32 v101, v101
    v_exp_f32 v102, v102
    v_exp_f32 v103, v103
    v_cvt_pk_bf16_f32 v80, v96, v97
    v_cvt_pk_bf16_f32 v81, v98, v99
    v_mfma_f32_32x32x8bf16_1k v[112:127], v[60:61], v[44:45], v[112:127]
    v_exp_f32 v104, v104
    v_exp_f32 v105, v105
    v_exp_f32 v106, v106
    v_exp_f32 v107, v107
    v_cvt_pk_bf16_f32 v82, v100, v101
    v_cvt_pk_bf16_f32 v83, v102, v103
    v_mfma_f32_32x32x16_bf16 v[144:159], v[68:71], v[92:95], v[144:159]
    v_exp_f32 v108, v108
    v_exp_f32 v109, v109
    v_exp_f32 v110, v110
    v_exp_f32 v111, v111
    v_cvt_pk_bf16_f32 v84, v104, v105
    v_cvt_pk_bf16_f32 v85, v106, v107
    v_cvt_pk_bf16_f32 v86, v108, v109
    v_cvt_pk_bf16_f32 v87, v110, v111
    s_waitcnt lgkmcnt(0)
    v_mfma_f32_32x32x16_bf16 v[96:111], v[48:51], v[32:35], 0
    ds_read_b128 v[56:59], v24 offset:65024
    v_exp_f32 v112, v112
    v_exp_f32 v113, v113
    v_exp_f32 v114, v114
    v_exp_f32 v115, v115
    v_mfma_f32_32x32x16_bf16 v[128:143], v[72:75], v[80:83], v[128:143]
    ds_read_b64 v[60:61], v25 offset:65024
    v_exp_f32 v116, v116
    v_exp_f32 v117, v117
    v_exp_f32 v118, v118
    v_exp_f32 v119, v119
    v_cvt_pk_bf16_f32 v88, v112, v113
    v_cvt_pk_bf16_f32 v89, v114, v115
    v_mfma_f32_32x32x8bf16_1k v[96:111], v[52:53], v[36:37], v[96:111]
    ds_read_b64_tr_b16 v[64:65], v26 offset:64512
    v_exp_f32 v120, v120
    v_exp_f32 v121, v121
    v_exp_f32 v122, v122
    v_exp_f32 v123, v123
    v_cvt_pk_bf16_f32 v90, v116, v117
    v_cvt_pk_bf16_f32 v91, v118, v119
    v_mfma_f32_32x32x16_bf16 v[128:143], v[76:79], v[84:87], v[128:143]
    ds_read_b64_tr_b16 v[66:67], v27 offset:64512
    v_exp_f32 v124, v124
    v_exp_f32 v125, v125
    v_exp_f32 v126, v126
    v_exp_f32 v127, v127
    v_cvt_pk_bf16_f32 v92, v120, v121
    v_cvt_pk_bf16_f32 v93, v122, v123
    v_cvt_pk_bf16_f32 v94, v124, v125
    v_cvt_pk_bf16_f32 v95, v126, v127
    v_mfma_f32_32x32x16_bf16 v[112:127], v[48:51], v[40:43], 0
    ds_read_b64_tr_b16 v[68:69], v26 offset:64768
    v_exp_f32 v96, v96
    v_exp_f32 v97, v97
    v_exp_f32 v98, v98
    v_exp_f32 v99, v99
    v_mfma_f32_32x32x16_bf16 v[144:159], v[72:75], v[88:91], v[144:159]
    ds_read_b64_tr_b16 v[70:71], v27 offset:64768
    v_exp_f32 v100, v100
    v_exp_f32 v101, v101
    v_exp_f32 v102, v102
    v_exp_f32 v103, v103
    v_cvt_pk_bf16_f32 v80, v96, v97
    v_cvt_pk_bf16_f32 v81, v98, v99
    v_mfma_f32_32x32x8bf16_1k v[112:127], v[52:53], v[44:45], v[112:127]
    v_exp_f32 v104, v104
    v_exp_f32 v105, v105
    v_exp_f32 v106, v106
    v_exp_f32 v107, v107
    v_cvt_pk_bf16_f32 v82, v100, v101
    v_cvt_pk_bf16_f32 v83, v102, v103
    v_mfma_f32_32x32x16_bf16 v[144:159], v[76:79], v[92:95], v[144:159]
    v_exp_f32 v108, v108
    v_exp_f32 v109, v109
    v_exp_f32 v110, v110
    v_exp_f32 v111, v111
    v_cvt_pk_bf16_f32 v84, v104, v105
    v_cvt_pk_bf16_f32 v85, v106, v107
    v_cvt_pk_bf16_f32 v86, v108, v109
    v_cvt_pk_bf16_f32 v87, v110, v111
    s_waitcnt lgkmcnt(0)
    s_barrier
    v_mfma_f32_32x32x16_bf16 v[96:111], v[56:59], v[32:35], 0
    ds_read_b128 v[48:51], v24 offset:0
    v_exp_f32 v112, v112
    v_exp_f32 v113, v113
    v_exp_f32 v114, v114
    v_exp_f32 v115, v115
    v_mfma_f32_32x32x16_bf16 v[128:143], v[64:67], v[80:83], v[128:143]
    ds_read_b64 v[52:53], v25 offset:0
    v_exp_f32 v116, v116
    v_exp_f32 v117, v117
    v_exp_f32 v118, v118
    v_exp_f32 v119, v119
    v_cvt_pk_bf16_f32 v88, v112, v113
    v_cvt_pk_bf16_f32 v89, v114, v115
    v_mfma_f32_32x32x8bf16_1k v[96:111], v[60:61], v[36:37], v[96:111]
    ds_read_b64_tr_b16 v[72:73], v26 offset:65024
    v_exp_f32 v120, v120
    v_exp_f32 v121, v121
    v_exp_f32 v122, v122
    v_exp_f32 v123, v123
    v_cvt_pk_bf16_f32 v90, v116, v117
    v_cvt_pk_bf16_f32 v91, v118, v119
    v_mfma_f32_32x32x16_bf16 v[128:143], v[68:71], v[84:87], v[128:143]
    ds_read_b64_tr_b16 v[74:75], v27 offset:65024
    v_exp_f32 v124, v124
    v_exp_f32 v125, v125
    v_exp_f32 v126, v126
    v_exp_f32 v127, v127
    v_cvt_pk_bf16_f32 v92, v120, v121
    v_cvt_pk_bf16_f32 v93, v122, v123
    v_cvt_pk_bf16_f32 v94, v124, v125
    v_cvt_pk_bf16_f32 v95, v126, v127
    v_mfma_f32_32x32x16_bf16 v[112:127], v[56:59], v[40:43], 0
    ds_read_b64_tr_b16 v[76:77], v26 offset:65280
    v_exp_f32 v96, v96
    v_exp_f32 v97, v97
    v_exp_f32 v98, v98
    v_exp_f32 v99, v99
    v_mfma_f32_32x32x16_bf16 v[144:159], v[64:67], v[88:91], v[144:159]
    ds_read_b64_tr_b16 v[78:79], v27 offset:65280
    v_exp_f32 v100, v100
    v_exp_f32 v101, v101
    v_exp_f32 v102, v102
    v_exp_f32 v103, v103
    v_cvt_pk_bf16_f32 v80, v96, v97
    v_cvt_pk_bf16_f32 v81, v98, v99
    v_mfma_f32_32x32x8bf16_1k v[112:127], v[60:61], v[44:45], v[112:127]
    v_exp_f32 v104, v104
    v_exp_f32 v105, v105
    v_exp_f32 v106, v106
    v_exp_f32 v107, v107
    v_cvt_pk_bf16_f32 v82, v100, v101
    v_cvt_pk_bf16_f32 v83, v102, v103
    v_mfma_f32_32x32x16_bf16 v[144:159], v[68:71], v[92:95], v[144:159]
    v_exp_f32 v108, v108
    v_exp_f32 v109, v109
    v_exp_f32 v110, v110
    v_exp_f32 v111, v111
    v_cvt_pk_bf16_f32 v84, v104, v105
    v_cvt_pk_bf16_f32 v85, v106, v107
    v_cvt_pk_bf16_f32 v86, v108, v109
    v_cvt_pk_bf16_f32 v87, v110, v111
    s_waitcnt lgkmcnt(0)
    v_mfma_f32_32x32x16_bf16 v[96:111], v[48:51], v[32:35], 0
    ds_read_b128 v[56:59], v24 offset:512
    v_exp_f32 v112, v112
    v_exp_f32 v113, v113
    v_exp_f32 v114, v114
    v_exp_f32 v115, v115
    v_mfma_f32_32x32x16_bf16 v[128:143], v[72:75], v[80:83], v[128:143]
    ds_read_b64 v[60:61], v25 offset:512
    v_exp_f32 v116, v116
    v_exp_f32 v117, v117
    v_exp_f32 v118, v118
    v_exp_f32 v119, v119
    v_cvt_pk_bf16_f32 v88, v112, v113
    v_cvt_pk_bf16_f32 v89, v114, v115
    v_mfma_f32_32x32x8bf16_1k v[96:111], v[52:53], v[36:37], v[96:111]
    ds_read_b64_tr_b16 v[64:65], v26 offset:0
    v_exp_f32 v120, v120
    v_exp_f32 v121, v121
    v_exp_f32 v122, v122
    v_exp_f32 v123, v123
    v_cvt_pk_bf16_f32 v90, v116, v117
    v_cvt_pk_bf16_f32 v91, v118, v119
    v_mfma_f32_32x32x16_bf16 v[128:143], v[76:79], v[84:87], v[128:143]
    ds_read_b64_tr_b16 v[66:67], v27 offset:0
    v_exp_f32 v124, v124
    v_exp_f32 v125, v125
    v_exp_f32 v126, v126
    v_exp_f32 v127, v127
    v_cvt_pk_bf16_f32 v92, v120, v121
    v_cvt_pk_bf16_f32 v93, v122, v123
    v_cvt_pk_bf16_f32 v94, v124, v125
    v_cvt_pk_bf16_f32 v95, v126, v127
    v_mfma_f32_32x32x16_bf16 v[112:127], v[48:51], v[40:43], 0
    ds_read_b64_tr_b16 v[68:69], v26 offset:256
    v_exp_f32 v96, v96
    v_exp_f32 v97, v97
    v_exp_f32 v98, v98
    v_exp_f32 v99, v99
    v_mfma_f32_32x32x16_bf16 v[144:159], v[72:75], v[88:91], v[144:159]
    ds_read_b64_tr_b16 v[70:71], v27 offset:256
    v_exp_f32 v100, v100
    v_exp_f32 v101, v101
    v_exp_f32 v102, v102
    v_exp_f32 v103, v103
    v_cvt_pk_bf16_f32 v80, v96, v97
    v_cvt_pk_bf16_f32 v81, v98, v99
    v_mfma_f32_32x32x8bf16_1k v[112:127], v[52:53], v[44:45], v[112:127]
    v_exp_f32 v104, v104
    v_exp_f32 v105, v105
    v_exp_f32 v106, v106
    v_exp_f32 v107, v107
    v_cvt_pk_bf16_f32 v82, v100, v101
    v_cvt_pk_bf16_f32 v83, v102, v103
    v_mfma_f32_32x32x16_bf16 v[144:159], v[76:79], v[92:95], v[144:159]
    v_exp_f32 v108, v108
    v_exp_f32 v109, v109
    v_exp_f32 v110, v110
    v_exp_f32 v111, v111
    v_cvt_pk_bf16_f32 v84, v104, v105
    v_cvt_pk_bf16_f32 v85, v106, v107
    v_cvt_pk_bf16_f32 v86, v108, v109
    v_cvt_pk_bf16_f32 v87, v110, v111
    s_waitcnt lgkmcnt(0)
    v_mfma_f32_32x32x16_bf16 v[96:111], v[56:59], v[32:35], 0
    ds_read_b128 v[48:51], v24 offset:7168
    v_exp_f32 v112, v112
    v_exp_f32 v113, v113
    v_exp_f32 v114, v114
    v_exp_f32 v115, v115
    v_mfma_f32_32x32x16_bf16 v[128:143], v[64:67], v[80:83], v[128:143]
    ds_read_b64 v[52:53], v25 offset:7168
    v_exp_f32 v116, v116
    v_exp_f32 v117, v117
    v_exp_f32 v118, v118
    v_exp_f32 v119, v119
    v_cvt_pk_bf16_f32 v88, v112, v113
    v_cvt_pk_bf16_f32 v89, v114, v115
    v_mfma_f32_32x32x8bf16_1k v[96:111], v[60:61], v[36:37], v[96:111]
    ds_read_b64_tr_b16 v[72:73], v26 offset:512
    v_exp_f32 v120, v120
    v_exp_f32 v121, v121
    v_exp_f32 v122, v122
    v_exp_f32 v123, v123
    v_cvt_pk_bf16_f32 v90, v116, v117
    v_cvt_pk_bf16_f32 v91, v118, v119
    v_mfma_f32_32x32x16_bf16 v[128:143], v[68:71], v[84:87], v[128:143]
    ds_read_b64_tr_b16 v[74:75], v27 offset:512
    v_exp_f32 v124, v124
    v_exp_f32 v125, v125
    v_exp_f32 v126, v126
    v_exp_f32 v127, v127
    v_cvt_pk_bf16_f32 v92, v120, v121
    v_cvt_pk_bf16_f32 v93, v122, v123
    v_cvt_pk_bf16_f32 v94, v124, v125
    v_cvt_pk_bf16_f32 v95, v126, v127
    v_mfma_f32_32x32x16_bf16 v[112:127], v[56:59], v[40:43], 0
    ds_read_b64_tr_b16 v[76:77], v26 offset:768
    v_exp_f32 v96, v96
    v_exp_f32 v97, v97
    v_exp_f32 v98, v98
    v_exp_f32 v99, v99
    v_mfma_f32_32x32x16_bf16 v[144:159], v[64:67], v[88:91], v[144:159]
    ds_read_b64_tr_b16 v[78:79], v27 offset:768
    v_exp_f32 v100, v100
    v_exp_f32 v101, v101
    v_exp_f32 v102, v102
    v_exp_f32 v103, v103
    v_cvt_pk_bf16_f32 v80, v96, v97
    v_cvt_pk_bf16_f32 v81, v98, v99
    v_mfma_f32_32x32x8bf16_1k v[112:127], v[60:61], v[44:45], v[112:127]
    v_exp_f32 v104, v104
    v_exp_f32 v105, v105
    v_exp_f32 v106, v106
    v_exp_f32 v107, v107
    v_cvt_pk_bf16_f32 v82, v100, v101
    v_cvt_pk_bf16_f32 v83, v102, v103
    v_mfma_f32_32x32x16_bf16 v[144:159], v[68:71], v[92:95], v[144:159]
    v_exp_f32 v108, v108
    v_exp_f32 v109, v109
    v_exp_f32 v110, v110
    v_exp_f32 v111, v111
    v_cvt_pk_bf16_f32 v84, v104, v105
    v_cvt_pk_bf16_f32 v85, v106, v107
    v_cvt_pk_bf16_f32 v86, v108, v109
    v_cvt_pk_bf16_f32 v87, v110, v111
    s_waitcnt lgkmcnt(0)
    v_mfma_f32_32x32x16_bf16 v[96:111], v[48:51], v[32:35], 0
    ds_read_b128 v[56:59], v24 offset:7680
    v_exp_f32 v112, v112
    v_exp_f32 v113, v113
    v_exp_f32 v114, v114
    v_exp_f32 v115, v115
    v_mfma_f32_32x32x16_bf16 v[128:143], v[72:75], v[80:83], v[128:143]
    ds_read_b64 v[60:61], v25 offset:7680
    v_exp_f32 v116, v116
    v_exp_f32 v117, v117
    v_exp_f32 v118, v118
    v_exp_f32 v119, v119
    v_cvt_pk_bf16_f32 v88, v112, v113
    v_cvt_pk_bf16_f32 v89, v114, v115
    v_mfma_f32_32x32x8bf16_1k v[96:111], v[52:53], v[36:37], v[96:111]
    ds_read_b64_tr_b16 v[64:65], v26 offset:7168
    v_exp_f32 v120, v120
    v_exp_f32 v121, v121
    v_exp_f32 v122, v122
    v_exp_f32 v123, v123
    v_cvt_pk_bf16_f32 v90, v116, v117
    v_cvt_pk_bf16_f32 v91, v118, v119
    v_mfma_f32_32x32x16_bf16 v[128:143], v[76:79], v[84:87], v[128:143]
    ds_read_b64_tr_b16 v[66:67], v27 offset:7168
    v_exp_f32 v124, v124
    v_exp_f32 v125, v125
    v_exp_f32 v126, v126
    v_exp_f32 v127, v127
    v_cvt_pk_bf16_f32 v92, v120, v121
    v_cvt_pk_bf16_f32 v93, v122, v123
    v_cvt_pk_bf16_f32 v94, v124, v125
    v_cvt_pk_bf16_f32 v95, v126, v127
    v_mfma_f32_32x32x16_bf16 v[112:127], v[48:51], v[40:43], 0
    ds_read_b64_tr_b16 v[68:69], v26 offset:7424
    v_exp_f32 v96, v96
    v_exp_f32 v97, v97
    v_exp_f32 v98, v98
    v_exp_f32 v99, v99
    v_mfma_f32_32x32x16_bf16 v[144:159], v[72:75], v[88:91], v[144:159]
    ds_read_b64_tr_b16 v[70:71], v27 offset:7424
    v_exp_f32 v100, v100
    v_exp_f32 v101, v101
    v_exp_f32 v102, v102
    v_exp_f32 v103, v103
    v_cvt_pk_bf16_f32 v80, v96, v97
    v_cvt_pk_bf16_f32 v81, v98, v99
    v_mfma_f32_32x32x8bf16_1k v[112:127], v[52:53], v[44:45], v[112:127]
    v_exp_f32 v104, v104
    v_exp_f32 v105, v105
    v_exp_f32 v106, v106
    v_exp_f32 v107, v107
    v_cvt_pk_bf16_f32 v82, v100, v101
    v_cvt_pk_bf16_f32 v83, v102, v103
    v_mfma_f32_32x32x16_bf16 v[144:159], v[76:79], v[92:95], v[144:159]
    v_exp_f32 v108, v108
    v_exp_f32 v109, v109
    v_exp_f32 v110, v110
    v_exp_f32 v111, v111
    v_cvt_pk_bf16_f32 v84, v104, v105
    v_cvt_pk_bf16_f32 v85, v106, v107
    v_cvt_pk_bf16_f32 v86, v108, v109
    v_cvt_pk_bf16_f32 v87, v110, v111
    s_waitcnt lgkmcnt(0)
    v_mfma_f32_32x32x16_bf16 v[96:111], v[56:59], v[32:35], 0
    ds_read_b128 v[48:51], v24 offset:14336
    v_exp_f32 v112, v112
    v_exp_f32 v113, v113
    v_exp_f32 v114, v114
    v_exp_f32 v115, v115
    v_mfma_f32_32x32x16_bf16 v[128:143], v[64:67], v[80:83], v[128:143]
    ds_read_b64 v[52:53], v25 offset:14336
    v_exp_f32 v116, v116
    v_exp_f32 v117, v117
    v_exp_f32 v118, v118
    v_exp_f32 v119, v119
    v_cvt_pk_bf16_f32 v88, v112, v113
    v_cvt_pk_bf16_f32 v89, v114, v115
    v_mfma_f32_32x32x8bf16_1k v[96:111], v[60:61], v[36:37], v[96:111]
    ds_read_b64_tr_b16 v[72:73], v26 offset:7680
    v_exp_f32 v120, v120
    v_exp_f32 v121, v121
    v_exp_f32 v122, v122
    v_exp_f32 v123, v123
    v_cvt_pk_bf16_f32 v90, v116, v117
    v_cvt_pk_bf16_f32 v91, v118, v119
    v_mfma_f32_32x32x16_bf16 v[128:143], v[68:71], v[84:87], v[128:143]
    ds_read_b64_tr_b16 v[74:75], v27 offset:7680
    v_exp_f32 v124, v124
    v_exp_f32 v125, v125
    v_exp_f32 v126, v126
    v_exp_f32 v127, v127
    v_cvt_pk_bf16_f32 v92, v120, v121
    v_cvt_pk_bf16_f32 v93, v122, v123
    v_cvt_pk_bf16_f32 v94, v124, v125
    v_cvt_pk_bf16_f32 v95, v126, v127
    v_mfma_f32_32x32x16_bf16 v[112:127], v[56:59], v[40:43], 0
    ds_read_b64_tr_b16 v[76:77], v26 offset:7936
    v_exp_f32 v96, v96
    v_exp_f32 v97, v97
    v_exp_f32 v98, v98
    v_exp_f32 v99, v99
    v_mfma_f32_32x32x16_bf16 v[144:159], v[64:67], v[88:91], v[144:159]
    ds_read_b64_tr_b16 v[78:79], v27 offset:7936
    v_exp_f32 v100, v100
    v_exp_f32 v101, v101
    v_exp_f32 v102, v102
    v_exp_f32 v103, v103
    v_cvt_pk_bf16_f32 v80, v96, v97
    v_cvt_pk_bf16_f32 v81, v98, v99
    v_mfma_f32_32x32x8bf16_1k v[112:127], v[60:61], v[44:45], v[112:127]
    v_exp_f32 v104, v104
    v_exp_f32 v105, v105
    v_exp_f32 v106, v106
    v_exp_f32 v107, v107
    v_cvt_pk_bf16_f32 v82, v100, v101
    v_cvt_pk_bf16_f32 v83, v102, v103
    v_mfma_f32_32x32x16_bf16 v[144:159], v[68:71], v[92:95], v[144:159]
    v_exp_f32 v108, v108
    v_exp_f32 v109, v109
    v_exp_f32 v110, v110
    v_exp_f32 v111, v111
    v_cvt_pk_bf16_f32 v84, v104, v105
    v_cvt_pk_bf16_f32 v85, v106, v107
    v_cvt_pk_bf16_f32 v86, v108, v109
    v_cvt_pk_bf16_f32 v87, v110, v111
    s_waitcnt lgkmcnt(0)
    v_mfma_f32_32x32x16_bf16 v[96:111], v[48:51], v[32:35], 0
    ds_read_b128 v[56:59], v24 offset:14848
    v_exp_f32 v112, v112
    v_exp_f32 v113, v113
    v_exp_f32 v114, v114
    v_exp_f32 v115, v115
    v_mfma_f32_32x32x16_bf16 v[128:143], v[72:75], v[80:83], v[128:143]
    ds_read_b64 v[60:61], v25 offset:14848
    v_exp_f32 v116, v116
    v_exp_f32 v117, v117
    v_exp_f32 v118, v118
    v_exp_f32 v119, v119
    v_cvt_pk_bf16_f32 v88, v112, v113
    v_cvt_pk_bf16_f32 v89, v114, v115
    v_mfma_f32_32x32x8bf16_1k v[96:111], v[52:53], v[36:37], v[96:111]
    ds_read_b64_tr_b16 v[64:65], v26 offset:14336
    v_exp_f32 v120, v120
    v_exp_f32 v121, v121
    v_exp_f32 v122, v122
    v_exp_f32 v123, v123
    v_cvt_pk_bf16_f32 v90, v116, v117
    v_cvt_pk_bf16_f32 v91, v118, v119
    v_mfma_f32_32x32x16_bf16 v[128:143], v[76:79], v[84:87], v[128:143]
    ds_read_b64_tr_b16 v[66:67], v27 offset:14336
    v_exp_f32 v124, v124
    v_exp_f32 v125, v125
    v_exp_f32 v126, v126
    v_exp_f32 v127, v127
    v_cvt_pk_bf16_f32 v92, v120, v121
    v_cvt_pk_bf16_f32 v93, v122, v123
    v_cvt_pk_bf16_f32 v94, v124, v125
    v_cvt_pk_bf16_f32 v95, v126, v127
    v_mfma_f32_32x32x16_bf16 v[112:127], v[48:51], v[40:43], 0
    ds_read_b64_tr_b16 v[68:69], v26 offset:14592
    v_exp_f32 v96, v96
    v_exp_f32 v97, v97
    v_exp_f32 v98, v98
    v_exp_f32 v99, v99
    v_mfma_f32_32x32x16_bf16 v[144:159], v[72:75], v[88:91], v[144:159]
    ds_read_b64_tr_b16 v[70:71], v27 offset:14592
    v_exp_f32 v100, v100
    v_exp_f32 v101, v101
    v_exp_f32 v102, v102
    v_exp_f32 v103, v103
    v_cvt_pk_bf16_f32 v80, v96, v97
    v_cvt_pk_bf16_f32 v81, v98, v99
    v_mfma_f32_32x32x8bf16_1k v[112:127], v[52:53], v[44:45], v[112:127]
    v_exp_f32 v104, v104
    v_exp_f32 v105, v105
    v_exp_f32 v106, v106
    v_exp_f32 v107, v107
    v_cvt_pk_bf16_f32 v82, v100, v101
    v_cvt_pk_bf16_f32 v83, v102, v103
    v_mfma_f32_32x32x16_bf16 v[144:159], v[76:79], v[92:95], v[144:159]
    v_exp_f32 v108, v108
    v_exp_f32 v109, v109
    v_exp_f32 v110, v110
    v_exp_f32 v111, v111
    v_cvt_pk_bf16_f32 v84, v104, v105
    v_cvt_pk_bf16_f32 v85, v106, v107
    v_cvt_pk_bf16_f32 v86, v108, v109
    v_cvt_pk_bf16_f32 v87, v110, v111
    s_waitcnt lgkmcnt(0)
    v_mfma_f32_32x32x16_bf16 v[96:111], v[56:59], v[32:35], 0
    ds_read_b128 v[48:51], v24 offset:21504
    v_exp_f32 v112, v112
    v_exp_f32 v113, v113
    v_exp_f32 v114, v114
    v_exp_f32 v115, v115
    v_mfma_f32_32x32x16_bf16 v[128:143], v[64:67], v[80:83], v[128:143]
    ds_read_b64 v[52:53], v25 offset:21504
    v_exp_f32 v116, v116
    v_exp_f32 v117, v117
    v_exp_f32 v118, v118
    v_exp_f32 v119, v119
    v_cvt_pk_bf16_f32 v88, v112, v113
    v_cvt_pk_bf16_f32 v89, v114, v115
    v_mfma_f32_32x32x8bf16_1k v[96:111], v[60:61], v[36:37], v[96:111]
    ds_read_b64_tr_b16 v[72:73], v26 offset:14848
    v_exp_f32 v120, v120
    v_exp_f32 v121, v121
    v_exp_f32 v122, v122
    v_exp_f32 v123, v123
    v_cvt_pk_bf16_f32 v90, v116, v117
    v_cvt_pk_bf16_f32 v91, v118, v119
    v_mfma_f32_32x32x16_bf16 v[128:143], v[68:71], v[84:87], v[128:143]
    ds_read_b64_tr_b16 v[74:75], v27 offset:14848
    v_exp_f32 v124, v124
    v_exp_f32 v125, v125
    v_exp_f32 v126, v126
    v_exp_f32 v127, v127
    v_cvt_pk_bf16_f32 v92, v120, v121
    v_cvt_pk_bf16_f32 v93, v122, v123
    v_cvt_pk_bf16_f32 v94, v124, v125
    v_cvt_pk_bf16_f32 v95, v126, v127
    v_mfma_f32_32x32x16_bf16 v[112:127], v[56:59], v[40:43], 0
    ds_read_b64_tr_b16 v[76:77], v26 offset:15104
    v_exp_f32 v96, v96
    v_exp_f32 v97, v97
    v_exp_f32 v98, v98
    v_exp_f32 v99, v99
    v_mfma_f32_32x32x16_bf16 v[144:159], v[64:67], v[88:91], v[144:159]
    ds_read_b64_tr_b16 v[78:79], v27 offset:15104
    v_exp_f32 v100, v100
    v_exp_f32 v101, v101
    v_exp_f32 v102, v102
    v_exp_f32 v103, v103
    v_cvt_pk_bf16_f32 v80, v96, v97
    v_cvt_pk_bf16_f32 v81, v98, v99
    v_mfma_f32_32x32x8bf16_1k v[112:127], v[60:61], v[44:45], v[112:127]
    v_exp_f32 v104, v104
    v_exp_f32 v105, v105
    v_exp_f32 v106, v106
    v_exp_f32 v107, v107
    v_cvt_pk_bf16_f32 v82, v100, v101
    v_cvt_pk_bf16_f32 v83, v102, v103
    v_mfma_f32_32x32x16_bf16 v[144:159], v[68:71], v[92:95], v[144:159]
    v_exp_f32 v108, v108
    v_exp_f32 v109, v109
    v_exp_f32 v110, v110
    v_exp_f32 v111, v111
    v_cvt_pk_bf16_f32 v84, v104, v105
    v_cvt_pk_bf16_f32 v85, v106, v107
    v_cvt_pk_bf16_f32 v86, v108, v109
    v_cvt_pk_bf16_f32 v87, v110, v111
    s_waitcnt lgkmcnt(0)
    v_mfma_f32_32x32x16_bf16 v[96:111], v[48:51], v[32:35], 0
    ds_read_b128 v[56:59], v24 offset:22016
    v_exp_f32 v112, v112
    v_exp_f32 v113, v113
    v_exp_f32 v114, v114
    v_exp_f32 v115, v115
    v_mfma_f32_32x32x16_bf16 v[128:143], v[72:75], v[80:83], v[128:143]
    ds_read_b64 v[60:61], v25 offset:22016
    v_exp_f32 v116, v116
    v_exp_f32 v117, v117
    v_exp_f32 v118, v118
    v_exp_f32 v119, v119
    v_cvt_pk_bf16_f32 v88, v112, v113
    v_cvt_pk_bf16_f32 v89, v114, v115
    v_mfma_f32_32x32x8bf16_1k v[96:111], v[52:53], v[36:37], v[96:111]
    ds_read_b64_tr_b16 v[64:65], v26 offset:21504
    v_exp_f32 v120, v120
    v_exp_f32 v121, v121
    v_exp_f32 v122, v122
    v_exp_f32 v123, v123
    v_cvt_pk_bf16_f32 v90, v116, v117
    v_cvt_pk_bf16_f32 v91, v118, v119
    v_mfma_f32_32x32x16_bf16 v[128:143], v[76:79], v[84:87], v[128:143]
    ds_read_b64_tr_b16 v[66:67], v27 offset:21504
    v_exp_f32 v124, v124
    v_exp_f32 v125, v125
    v_exp_f32 v126, v126
    v_exp_f32 v127, v127
    v_cvt_pk_bf16_f32 v92, v120, v121
    v_cvt_pk_bf16_f32 v93, v122, v123
    v_cvt_pk_bf16_f32 v94, v124, v125
    v_cvt_pk_bf16_f32 v95, v126, v127
    v_mfma_f32_32x32x16_bf16 v[112:127], v[48:51], v[40:43], 0
    ds_read_b64_tr_b16 v[68:69], v26 offset:21760
    v_exp_f32 v96, v96
    v_exp_f32 v97, v97
    v_exp_f32 v98, v98
    v_exp_f32 v99, v99
    v_mfma_f32_32x32x16_bf16 v[144:159], v[72:75], v[88:91], v[144:159]
    ds_read_b64_tr_b16 v[70:71], v27 offset:21760
    v_exp_f32 v100, v100
    v_exp_f32 v101, v101
    v_exp_f32 v102, v102
    v_exp_f32 v103, v103
    v_cvt_pk_bf16_f32 v80, v96, v97
    v_cvt_pk_bf16_f32 v81, v98, v99
    v_mfma_f32_32x32x8bf16_1k v[112:127], v[52:53], v[44:45], v[112:127]
    v_exp_f32 v104, v104
    v_exp_f32 v105, v105
    v_exp_f32 v106, v106
    v_exp_f32 v107, v107
    v_cvt_pk_bf16_f32 v82, v100, v101
    v_cvt_pk_bf16_f32 v83, v102, v103
    v_mfma_f32_32x32x16_bf16 v[144:159], v[76:79], v[92:95], v[144:159]
    v_exp_f32 v108, v108
    v_exp_f32 v109, v109
    v_exp_f32 v110, v110
    v_exp_f32 v111, v111
    v_cvt_pk_bf16_f32 v84, v104, v105
    v_cvt_pk_bf16_f32 v85, v106, v107
    v_cvt_pk_bf16_f32 v86, v108, v109
    v_cvt_pk_bf16_f32 v87, v110, v111
    s_waitcnt lgkmcnt(0)
    s_barrier
    v_mfma_f32_32x32x16_bf16 v[96:111], v[56:59], v[32:35], 0
    ds_read_b128 v[48:51], v24 offset:28672
    v_exp_f32 v112, v112
    v_exp_f32 v113, v113
    v_exp_f32 v114, v114
    v_exp_f32 v115, v115
    v_mfma_f32_32x32x16_bf16 v[128:143], v[64:67], v[80:83], v[128:143]
    ds_read_b64 v[52:53], v25 offset:28672
    v_exp_f32 v116, v116
    v_exp_f32 v117, v117
    v_exp_f32 v118, v118
    v_exp_f32 v119, v119
    v_cvt_pk_bf16_f32 v88, v112, v113
    v_cvt_pk_bf16_f32 v89, v114, v115
    v_mfma_f32_32x32x8bf16_1k v[96:111], v[60:61], v[36:37], v[96:111]
    ds_read_b64_tr_b16 v[72:73], v26 offset:22016
    v_exp_f32 v120, v120
    v_exp_f32 v121, v121
    v_exp_f32 v122, v122
    v_exp_f32 v123, v123
    v_cvt_pk_bf16_f32 v90, v116, v117
    v_cvt_pk_bf16_f32 v91, v118, v119
    v_mfma_f32_32x32x16_bf16 v[128:143], v[68:71], v[84:87], v[128:143]
    ds_read_b64_tr_b16 v[74:75], v27 offset:22016
    v_exp_f32 v124, v124
    v_exp_f32 v125, v125
    v_exp_f32 v126, v126
    v_exp_f32 v127, v127
    v_cvt_pk_bf16_f32 v92, v120, v121
    v_cvt_pk_bf16_f32 v93, v122, v123
    v_cvt_pk_bf16_f32 v94, v124, v125
    v_cvt_pk_bf16_f32 v95, v126, v127
    v_mfma_f32_32x32x16_bf16 v[112:127], v[56:59], v[40:43], 0
    ds_read_b64_tr_b16 v[76:77], v26 offset:22272
    v_exp_f32 v96, v96
    v_exp_f32 v97, v97
    v_exp_f32 v98, v98
    v_exp_f32 v99, v99
    v_mfma_f32_32x32x16_bf16 v[144:159], v[64:67], v[88:91], v[144:159]
    ds_read_b64_tr_b16 v[78:79], v27 offset:22272
    v_exp_f32 v100, v100
    v_exp_f32 v101, v101
    v_exp_f32 v102, v102
    v_exp_f32 v103, v103
    v_cvt_pk_bf16_f32 v80, v96, v97
    v_cvt_pk_bf16_f32 v81, v98, v99
    v_mfma_f32_32x32x8bf16_1k v[112:127], v[60:61], v[44:45], v[112:127]
    v_exp_f32 v104, v104
    v_exp_f32 v105, v105
    v_exp_f32 v106, v106
    v_exp_f32 v107, v107
    v_cvt_pk_bf16_f32 v82, v100, v101
    v_cvt_pk_bf16_f32 v83, v102, v103
    v_mfma_f32_32x32x16_bf16 v[144:159], v[68:71], v[92:95], v[144:159]
    v_exp_f32 v108, v108
    v_exp_f32 v109, v109
    v_exp_f32 v110, v110
    v_exp_f32 v111, v111
    v_cvt_pk_bf16_f32 v84, v104, v105
    v_cvt_pk_bf16_f32 v85, v106, v107
    v_cvt_pk_bf16_f32 v86, v108, v109
    v_cvt_pk_bf16_f32 v87, v110, v111
    s_waitcnt lgkmcnt(0)
    v_mfma_f32_32x32x16_bf16 v[96:111], v[48:51], v[32:35], 0
    ds_read_b128 v[56:59], v24 offset:29184
    v_exp_f32 v112, v112
    v_exp_f32 v113, v113
    v_exp_f32 v114, v114
    v_exp_f32 v115, v115
    v_mfma_f32_32x32x16_bf16 v[128:143], v[72:75], v[80:83], v[128:143]
    ds_read_b64 v[60:61], v25 offset:29184
    v_exp_f32 v116, v116
    v_exp_f32 v117, v117
    v_exp_f32 v118, v118
    v_exp_f32 v119, v119
    v_cvt_pk_bf16_f32 v88, v112, v113
    v_cvt_pk_bf16_f32 v89, v114, v115
    v_mfma_f32_32x32x8bf16_1k v[96:111], v[52:53], v[36:37], v[96:111]
L_pad1_3:
    s_cbranch_execz L_chain1_ret
    ds_read_b64_tr_b16 v[64:65], v26 offset:28672
    v_exp_f32 v120, v120
    v_exp_f32 v121, v121
    v_exp_f32 v122, v122
    v_exp_f32 v123, v123
    v_cvt_pk_bf16_f32 v90, v116, v117
    v_cvt_pk_bf16_f32 v91, v118, v119
    v_mfma_f32_32x32x16_bf16 v[128:143], v[76:79], v[84:87], v[128:143]
    ds_read_b64_tr_b16 v[66:67], v27 offset:28672
    v_exp_f32 v124, v124
    v_exp_f32 v125, v125
    v_exp_f32 v126, v126
    v_exp_f32 v127, v127
    v_cvt_pk_bf16_f32 v92, v120, v121
    v_cvt_pk_bf16_f32 v93, v122, v123
    v_cvt_pk_bf16_f32 v94, v124, v125
    v_cvt_pk_bf16_f32 v95, v126, v127
    v_mfma_f32_32x32x16_bf16 v[112:127], v[48:51], v[40:43], 0
    ds_read_b64_tr_b16 v[68:69], v26 offset:28928
    v_exp_f32 v96, v96
    v_exp_f32 v97, v97
    v_exp_f32 v98, v98
    v_exp_f32 v99, v99
    v_mfma_f32_32x32x16_bf16 v[144:159], v[72:75], v[88:91], v[144:159]
    ds_read_b64_tr_b16 v[70:71], v27 offset:28928
    v_exp_f32 v100, v100
    v_exp_f32 v101, v101
    v_exp_f32 v102, v102
    v_exp_f32 v103, v103
    v_cvt_pk_bf16_f32 v80, v96, v97
    v_cvt_pk_bf16_f32 v81, v98, v99
    v_mfma_f32_32x32x8bf16_1k v[112:127], v[52:53], v[44:45], v[112:127]
    v_exp_f32 v104, v104
    v_exp_f32 v105, v105
    v_exp_f32 v106, v106
    v_exp_f32 v107, v107
    v_cvt_pk_bf16_f32 v82, v100, v101
    v_cvt_pk_bf16_f32 v83, v102, v103
    v_mfma_f32_32x32x16_bf16 v[144:159], v[76:79], v[92:95], v[144:159]
    v_exp_f32 v108, v108
    v_exp_f32 v109, v109
    v_exp_f32 v110, v110
    v_exp_f32 v111, v111
    v_cvt_pk_bf16_f32 v84, v104, v105
    v_cvt_pk_bf16_f32 v85, v106, v107
    v_cvt_pk_bf16_f32 v86, v108, v109
    v_cvt_pk_bf16_f32 v87, v110, v111
    s_waitcnt lgkmcnt(0)
    v_mfma_f32_32x32x16_bf16 v[96:111], v[56:59], v[32:35], 0
    ds_read_b128 v[48:51], v24 offset:35840
    v_exp_f32 v112, v112
    v_exp_f32 v113, v113
    v_exp_f32 v114, v114
    v_exp_f32 v115, v115
    v_mfma_f32_32x32x16_bf16 v[128:143], v[64:67], v[80:83], v[128:143]
    ds_read_b64 v[52:53], v25 offset:35840
    v_exp_f32 v116, v116
    v_exp_f32 v117, v117
    v_exp_f32 v118, v118
    v_exp_f32 v119, v119
    v_cvt_pk_bf16_f32 v88, v112, v113
    v_cvt_pk_bf16_f32 v89, v114, v115
    v_mfma_f32_32x32x8bf16_1k v[96:111], v[60:61], v[36:37], v[96:111]
    ds_read_b64_tr_b16 v[72:73], v26 offset:29184
    v_exp_f32 v120, v120
    v_exp_f32 v121, v121
    v_exp_f32 v122, v122
    v_exp_f32 v123, v123
    v_cvt_pk_bf16_f32 v90, v116, v117
    v_cvt_pk_bf16_f32 v91, v118, v119
    v_mfma_f32_32x32x16_bf16 v[128:143], v[68:71], v[84:87], v[128:143]
    ds_read_b64_tr_b16 v[74:75], v27 offset:29184
    v_exp_f32 v124, v124
    v_exp_f32 v125, v125
    v_exp_f32 v126, v126
    v_exp_f32 v127, v127
    v_cvt_pk_bf16_f32 v92, v120, v121
    v_cvt_pk_bf16_f32 v93, v122, v123
    v_cvt_pk_bf16_f32 v94, v124, v125
    v_cvt_pk_bf16_f32 v95, v126, v127
    v_mfma_f32_32x32x16_bf16 v[112:127], v[56:59], v[40:43], 0
    ds_read_b64_tr_b16 v[76:77], v26 offset:29440
    v_exp_f32 v96, v96
    v_exp_f32 v97, v97
    v_exp_f32 v98, v98
    v_exp_f32 v99, v99
    v_mfma_f32_32x32x16_bf16 v[144:159], v[64:67], v[88:91], v[144:159]
    ds_read_b64_tr_b16 v[78:79], v27 offset:29440
    v_exp_f32 v100, v100
    v_exp_f32 v101, v101
    v_exp_f32 v102, v102
    v_exp_f32 v103, v103
    v_cvt_pk_bf16_f32 v80, v96, v97
    v_cvt_pk_bf16_f32 v81, v98, v99
    v_mfma_f32_32x32x8bf16_1k v[112:127], v[60:61], v[44:45], v[112:127]
    v_exp_f32 v104, v104
    v_exp_f32 v105, v105
    v_exp_f32 v106, v106
    v_exp_f32 v107, v107
    v_cvt_pk_bf16_f32 v82, v100, v101
    v_cvt_pk_bf16_f32 v83, v102, v103
    v_mfma_f32_32x32x16_bf16 v[144:159], v[68:71], v[92:95], v[144:159]
    v_exp_f32 v108, v108
    v_exp_f32 v109, v109
    v_exp_f32 v110, v110
    v_exp_f32 v111, v111
    v_cvt_pk_bf16_f32 v84, v104, v105
    v_cvt_pk_bf16_f32 v85, v106, v107
    v_cvt_pk_bf16_f32 v86, v108, v109
    v_cvt_pk_bf16_f32 v87, v110, v111
    s_waitcnt lgkmcnt(0)
    v_mfma_f32_32x32x16_bf16 v[96:111], v[48:51], v[32:35], 0
    ds_read_b128 v[56:59], v24 offset:36352
    v_exp_f32 v112, v112
    v_exp_f32 v113, v113
    v_exp_f32 v114, v114
    v_exp_f32 v115, v115
    v_mfma_f32_32x32x16_bf16 v[128:143], v[72:75], v[80:83], v[128:143]
    ds_read_b64 v[60:61], v25 offset:36352
    v_exp_f32 v116, v116
    v_exp_f32 v117, v117
    v_exp_f32 v118, v118
    v_exp_f32 v119, v119
    v_cvt_pk_bf16_f32 v88, v112, v113
    v_cvt_pk_bf16_f32 v89, v114, v115
    v_mfma_f32_32x32x8bf16_1k v[96:111], v[52:53], v[36:37], v[96:111]
    ds_read_b64_tr_b16 v[64:65], v26 offset:35840
    v_exp_f32 v120, v120
    v_exp_f32 v121, v121
    v_exp_f32 v122, v122
    v_exp_f32 v123, v123
    v_cvt_pk_bf16_f32 v90, v116, v117
    v_cvt_pk_bf16_f32 v91, v118, v119
    v_mfma_f32_32x32x16_bf16 v[128:143], v[76:79], v[84:87], v[128:143]
    ds_read_b64_tr_b16 v[66:67], v27 offset:35840
    v_exp_f32 v124, v124
    v_exp_f32 v125, v125
    v_exp_f32 v126, v126
    v_exp_f32 v127, v127
    v_cvt_pk_bf16_f32 v92, v120, v121
    v_cvt_pk_bf16_f32 v93, v122, v123
    v_cvt_pk_bf16_f32 v94, v124, v125
    v_cvt_pk_bf16_f32 v95, v126, v127
    v_mfma_f32_32x32x16_bf16 v[112:127], v[48:51], v[40:43], 0
    ds_read_b64_tr_b16 v[68:69], v26 offset:36096
    v_exp_f32 v96, v96
    v_exp_f32 v97, v97
    v_exp_f32 v98, v98
    v_exp_f32 v99, v99
    v_mfma_f32_32x32x16_bf16 v[144:159], v[72:75], v[88:91], v[144:159]
    ds_read_b64_tr_b16 v[70:71], v27 offset:36096
    v_exp_f32 v100, v100
    v_exp_f32 v101, v101
    v_exp_f32 v102, v102
    v_exp_f32 v103, v103
    v_cvt_pk_bf16_f32 v80, v96, v97
    v_cvt_pk_bf16_f32 v81, v98, v99
    v_mfma_f32_32x32x8bf16_1k v[112:127], v[52:53], v[44:45], v[112:127]
    v_exp_f32 v104, v104
    v_exp_f32 v105, v105
    v_exp_f32 v106, v106
    v_exp_f32 v107, v107
    v_cvt_pk_bf16_f32 v82, v100, v101
    v_cvt_pk_bf16_f32 v83, v102, v103
    v_mfma_f32_32x32x16_bf16 v[144:159], v[76:79], v[92:95], v[144:159]
    v_exp_f32 v108, v108
    v_exp_f32 v109, v109
    v_exp_f32 v110, v110
    v_exp_f32 v111, v111
    v_cvt_pk_bf16_f32 v84, v104, v105
    v_cvt_pk_bf16_f32 v85, v106, v107
    v_cvt_pk_bf16_f32 v86, v108, v109
    v_cvt_pk_bf16_f32 v87, v110, v111
    s_waitcnt lgkmcnt(0)
    v_mfma_f32_32x32x16_bf16 v[96:111], v[56:59], v[32:35], 0
    ds_read_b128 v[48:51], v24 offset:43008
    v_exp_f32 v112, v112
    v_exp_f32 v113, v113
    v_exp_f32 v114, v114
    v_exp_f32 v115, v115
    v_mfma_f32_32x32x16_bf16 v[128:143], v[64:67], v[80:83], v[128:143]
    ds_read_b64 v[52:53], v25 offset:43008
    v_exp_f32 v116, v116
    v_exp_f32 v117, v117
    v_exp_f32 v118, v118
    v_exp_f32 v119, v119
    v_cvt_pk_bf16_f32 v88, v112, v113
    v_cvt_pk_bf16_f32 v89, v114, v115
    v_mfma_f32_32x32x8bf16_1k v[96:111], v[60:61], v[36:37], v[96:111]
    ds_read_b64_tr_b16 v[72:73], v26 offset:36352
    v_exp_f32 v120, v120
    v_exp_f32 v121, v121
    v_exp_f32 v122, v122
    v_exp_f32 v123, v123
    v_cvt_pk_bf16_f32 v90, v116, v117
    v_cvt_pk_bf16_f32 v91, v118, v119
    v_mfma_f32_32x32x16_bf16 v[128:143], v[68:71], v[84:87], v[128:143]
    ds_read_b64_tr_b16 v[74:75], v27 offset:36352
    v_exp_f32 v124, v124
    v_exp_f32 v125, v125
    v_exp_f32 v126, v126
    v_exp_f32 v127, v127
    v_cvt_pk_bf16_f32 v92, v120, v121
    v_cvt_pk_bf16_f32 v93, v122, v123
    v_cvt_pk_bf16_f32 v94, v124, v125
    v_cvt_pk_bf16_f32 v95, v126, v127
    v_mfma_f32_32x32x16_bf16 v[112:127], v[56:59], v[40:43], 0
    ds_read_b64_tr_b16 v[76:77], v26 offset:36608
    v_exp_f32 v96, v96
    v_exp_f32 v97, v97
    v_exp_f32 v98, v98
    v_exp_f32 v99, v99
    v_mfma_f32_32x32x16_bf16 v[144:159], v[64:67], v[88:91], v[144:159]
    ds_read_b64_tr_b16 v[78:79], v27 offset:36608
    v_exp_f32 v100, v100
    v_exp_f32 v101, v101
    v_exp_f32 v102, v102
    v_exp_f32 v103, v103
    v_cvt_pk_bf16_f32 v80, v96, v97
    v_cvt_pk_bf16_f32 v81, v98, v99
    v_mfma_f32_32x32x8bf16_1k v[112:127], v[60:61], v[44:45], v[112:127]
    v_exp_f32 v104, v104
    v_exp_f32 v105, v105
    v_exp_f32 v106, v106
    v_exp_f32 v107, v107
    v_cvt_pk_bf16_f32 v82, v100, v101
    v_cvt_pk_bf16_f32 v83, v102, v103
    v_mfma_f32_32x32x16_bf16 v[144:159], v[68:71], v[92:95], v[144:159]
    v_exp_f32 v108, v108
    v_exp_f32 v109, v109
    v_exp_f32 v110, v110
    v_exp_f32 v111, v111
    v_cvt_pk_bf16_f32 v84, v104, v105
    v_cvt_pk_bf16_f32 v85, v106, v107
    v_cvt_pk_bf16_f32 v86, v108, v109
    v_cvt_pk_bf16_f32 v87, v110, v111
    s_waitcnt lgkmcnt(0)
    v_mfma_f32_32x32x16_bf16 v[96:111], v[48:51], v[32:35], 0
    ds_read_b128 v[56:59], v24 offset:43520
    v_exp_f32 v112, v112
    v_exp_f32 v113, v113
    v_exp_f32 v114, v114
    v_exp_f32 v115, v115
    v_mfma_f32_32x32x16_bf16 v[128:143], v[72:75], v[80:83], v[128:143]
    ds_read_b64 v[60:61], v25 offset:43520
    v_exp_f32 v116, v116
    v_exp_f32 v117, v117
    v_exp_f32 v118, v118
    v_exp_f32 v119, v119
    v_cvt_pk_bf16_f32 v88, v112, v113
    v_cvt_pk_bf16_f32 v89, v114, v115
    v_mfma_f32_32x32x8bf16_1k v[96:111], v[52:53], v[36:37], v[96:111]
    ds_read_b64_tr_b16 v[64:65], v26 offset:43008
    v_exp_f32 v120, v120
    v_exp_f32 v121, v121
    v_exp_f32 v122, v122
    v_exp_f32 v123, v123
    v_cvt_pk_bf16_f32 v90, v116, v117
    v_cvt_pk_bf16_f32 v91, v118, v119
    v_mfma_f32_32x32x16_bf16 v[128:143], v[76:79], v[84:87], v[128:143]
    ds_read_b64_tr_b16 v[66:67], v27 offset:43008
    v_exp_f32 v124, v124
    v_exp_f32 v125, v125
    v_exp_f32 v126, v126
    v_exp_f32 v127, v127
    v_cvt_pk_bf16_f32 v92, v120, v121
    v_cvt_pk_bf16_f32 v93, v122, v123
    v_cvt_pk_bf16_f32 v94, v124, v125
    v_cvt_pk_bf16_f32 v95, v126, v127
    v_mfma_f32_32x32x16_bf16 v[112:127], v[48:51], v[40:43], 0
    ds_read_b64_tr_b16 v[68:69], v26 offset:43264
    v_exp_f32 v96, v96
    v_exp_f32 v97, v97
    v_exp_f32 v98, v98
    v_exp_f32 v99, v99
    v_mfma_f32_32x32x16_bf16 v[144:159], v[72:75], v[88:91], v[144:159]
    ds_read_b64_tr_b16 v[70:71], v27 offset:43264
    v_exp_f32 v100, v100
    v_exp_f32 v101, v101
    v_exp_f32 v102, v102
    v_exp_f32 v103, v103
    v_cvt_pk_bf16_f32 v80, v96, v97
    v_cvt_pk_bf16_f32 v81, v98, v99
    v_mfma_f32_32x32x8bf16_1k v[112:127], v[52:53], v[44:45], v[112:127]
    v_exp_f32 v104, v104
    v_exp_f32 v105, v105
    v_exp_f32 v106, v106
    v_exp_f32 v107, v107
    v_cvt_pk_bf16_f32 v82, v100, v101
    v_cvt_pk_bf16_f32 v83, v102, v103
    v_mfma_f32_32x32x16_bf16 v[144:159], v[76:79], v[92:95], v[144:159]
    v_exp_f32 v108, v108
    v_exp_f32 v109, v109
    v_exp_f32 v110, v110
    v_exp_f32 v111, v111
    v_cvt_pk_bf16_f32 v84, v104, v105
    v_cvt_pk_bf16_f32 v85, v106, v107
    v_cvt_pk_bf16_f32 v86, v108, v109
    v_cvt_pk_bf16_f32 v87, v110, v111
    s_waitcnt lgkmcnt(0)
    v_mfma_f32_32x32x16_bf16 v[96:111], v[56:59], v[32:35], 0
    ds_read_b128 v[48:51], v24 offset:50176
    v_exp_f32 v112, v112
    v_exp_f32 v113, v113
    v_exp_f32 v114, v114
    v_exp_f32 v115, v115
    v_mfma_f32_32x32x16_bf16 v[128:143], v[64:67], v[80:83], v[128:143]
    ds_read_b64 v[52:53], v25 offset:50176
    v_exp_f32 v116, v116
    v_exp_f32 v117, v117
    v_exp_f32 v118, v118
    v_exp_f32 v119, v119
    v_cvt_pk_bf16_f32 v88, v112, v113
    v_cvt_pk_bf16_f32 v89, v114, v115
    v_mfma_f32_32x32x8bf16_1k v[96:111], v[60:61], v[36:37], v[96:111]
    ds_read_b64_tr_b16 v[72:73], v26 offset:43520
    v_exp_f32 v120, v120
    v_exp_f32 v121, v121
    v_exp_f32 v122, v122
    v_exp_f32 v123, v123
    v_cvt_pk_bf16_f32 v90, v116, v117
    v_cvt_pk_bf16_f32 v91, v118, v119
    v_mfma_f32_32x32x16_bf16 v[128:143], v[68:71], v[84:87], v[128:143]
    ds_read_b64_tr_b16 v[74:75], v27 offset:43520
    v_exp_f32 v124, v124
    v_exp_f32 v125, v125
    v_exp_f32 v126, v126
    v_exp_f32 v127, v127
    v_cvt_pk_bf16_f32 v92, v120, v121
    v_cvt_pk_bf16_f32 v93, v122, v123
    v_cvt_pk_bf16_f32 v94, v124, v125
    v_cvt_pk_bf16_f32 v95, v126, v127
    v_mfma_f32_32x32x16_bf16 v[112:127], v[56:59], v[40:43], 0
    ds_read_b64_tr_b16 v[76:77], v26 offset:43776
    v_exp_f32 v96, v96
    v_exp_f32 v97, v97
    v_exp_f32 v98, v98
    v_exp_f32 v99, v99
    v_mfma_f32_32x32x16_bf16 v[144:159], v[64:67], v[88:91], v[144:159]
    ds_read_b64_tr_b16 v[78:79], v27 offset:43776
    v_exp_f32 v100, v100
    v_exp_f32 v101, v101
    v_exp_f32 v102, v102
    v_exp_f32 v103, v103
    v_cvt_pk_bf16_f32 v80, v96, v97
    v_cvt_pk_bf16_f32 v81, v98, v99
    v_mfma_f32_32x32x8bf16_1k v[112:127], v[60:61], v[44:45], v[112:127]
    v_exp_f32 v104, v104
    v_exp_f32 v105, v105
    v_exp_f32 v106, v106
    v_exp_f32 v107, v107
    v_cvt_pk_bf16_f32 v82, v100, v101
    v_cvt_pk_bf16_f32 v83, v102, v103
    v_mfma_f32_32x32x16_bf16 v[144:159], v[68:71], v[92:95], v[144:159]
    v_exp_f32 v108, v108
    v_exp_f32 v109, v109
    v_exp_f32 v110, v110
    v_exp_f32 v111, v111
    v_cvt_pk_bf16_f32 v84, v104, v105
    v_cvt_pk_bf16_f32 v85, v106, v107
    v_cvt_pk_bf16_f32 v86, v108, v109
    v_cvt_pk_bf16_f32 v87, v110, v111
    s_waitcnt lgkmcnt(0)
    v_mfma_f32_32x32x16_bf16 v[96:111], v[48:51], v[32:35], 0
    ds_read_b128 v[56:59], v24 offset:50688
    v_exp_f32 v112, v112
    v_exp_f32 v113, v113
    v_exp_f32 v114, v114
    v_exp_f32 v115, v115
    v_mfma_f32_32x32x16_bf16 v[128:143], v[72:75], v[80:83], v[128:143]
    ds_read_b64 v[60:61], v25 offset:50688
    v_exp_f32 v116, v116
    v_exp_f32 v117, v117
    v_exp_f32 v118, v118
    v_exp_f32 v119, v119
    v_cvt_pk_bf16_f32 v88, v112, v113
    v_cvt_pk_bf16_f32 v89, v114, v115
    v_mfma_f32_32x32x8bf16_1k v[96:111], v[52:53], v[36:37], v[96:111]
    ds_read_b64_tr_b16 v[64:65], v26 offset:50176
    v_exp_f32 v120, v120
    v_exp_f32 v121, v121
    v_exp_f32 v122, v122
    v_exp_f32 v123, v123
    v_cvt_pk_bf16_f32 v90, v116, v117
    v_cvt_pk_bf16_f32 v91, v118, v119
    v_mfma_f32_32x32x16_bf16 v[128:143], v[76:79], v[84:87], v[128:143]
    ds_read_b64_tr_b16 v[66:67], v27 offset:50176
    v_exp_f32 v124, v124
    v_exp_f32 v125, v125
    v_exp_f32 v126, v126
    v_exp_f32 v127, v127
    v_cvt_pk_bf16_f32 v92, v120, v121
    v_cvt_pk_bf16_f32 v93, v122, v123
    v_cvt_pk_bf16_f32 v94, v124, v125
    v_cvt_pk_bf16_f32 v95, v126, v127
    v_mfma_f32_32x32x16_bf16 v[112:127], v[48:51], v[40:43], 0
    ds_read_b64_tr_b16 v[68:69], v26 offset:50432
    v_exp_f32 v96, v96
    v_exp_f32 v97, v97
    v_exp_f32 v98, v98
    v_exp_f32 v99, v99
    v_mfma_f32_32x32x16_bf16 v[144:159], v[72:75], v[88:91], v[144:159]
    ds_read_b64_tr_b16 v[70:71], v27 offset:50432
    v_exp_f32 v100, v100
    v_exp_f32 v101, v101
    v_exp_f32 v102, v102
    v_exp_f32 v103, v103
    v_cvt_pk_bf16_f32 v80, v96, v97
    v_cvt_pk_bf16_f32 v81, v98, v99
    v_mfma_f32_32x32x8bf16_1k v[112:127], v[52:53], v[44:45], v[112:127]
    v_exp_f32 v104, v104
    v_exp_f32 v105, v105
    v_exp_f32 v106, v106
    v_exp_f32 v107, v107
    v_cvt_pk_bf16_f32 v82, v100, v101
    v_cvt_pk_bf16_f32 v83, v102, v103
    v_mfma_f32_32x32x16_bf16 v[144:159], v[76:79], v[92:95], v[144:159]
    v_exp_f32 v108, v108
    v_exp_f32 v109, v109
    v_exp_f32 v110, v110
    v_exp_f32 v111, v111
    v_cvt_pk_bf16_f32 v84, v104, v105
    v_cvt_pk_bf16_f32 v85, v106, v107
    v_cvt_pk_bf16_f32 v86, v108, v109
    v_cvt_pk_bf16_f32 v87, v110, v111
    s_waitcnt lgkmcnt(0)
    v_mfma_f32_32x32x16_bf16 v[96:111], v[56:59], v[32:35], 0
    ds_read_b64_tr_b16 v[72:73], v26 offset:50688
    v_exp_f32 v112, v112
    v_exp_f32 v113, v113
    v_exp_f32 v114, v114
    v_exp_f32 v115, v115
    v_mfma_f32_32x32x16_bf16 v[128:143], v[64:67], v[80:83], v[128:143]
    ds_read_b64_tr_b16 v[74:75], v27 offset:50688
    v_exp_f32 v116, v116
    v_exp_f32 v117, v117
    v_exp_f32 v118, v118
    v_exp_f32 v119, v119
    v_cvt_pk_bf16_f32 v88, v112, v113
    v_cvt_pk_bf16_f32 v89, v114, v115
    v_mfma_f32_32x32x8bf16_1k v[96:111], v[60:61], v[36:37], v[96:111]
    ds_read_b64_tr_b16 v[76:77], v26 offset:50944
    v_exp_f32 v120, v120
    v_exp_f32 v121, v121
    v_exp_f32 v122, v122
    v_exp_f32 v123, v123
    v_cvt_pk_bf16_f32 v90, v116, v117
    v_cvt_pk_bf16_f32 v91, v118, v119
    v_mfma_f32_32x32x16_bf16 v[128:143], v[68:71], v[84:87], v[128:143]
    ds_read_b64_tr_b16 v[78:79], v27 offset:50944
    v_exp_f32 v124, v124
    v_exp_f32 v125, v125
    v_exp_f32 v126, v126
    v_exp_f32 v127, v127
    v_cvt_pk_bf16_f32 v92, v120, v121
    v_cvt_pk_bf16_f32 v93, v122, v123
    v_cvt_pk_bf16_f32 v94, v124, v125
    v_cvt_pk_bf16_f32 v95, v126, v127
    v_mfma_f32_32x32x16_bf16 v[112:127], v[56:59], v[40:43], 0
    v_exp_f32 v96, v96
    v_exp_f32 v97, v97
    v_exp_f32 v98, v98
    v_exp_f32 v99, v99
    v_mfma_f32_32x32x16_bf16 v[144:159], v[64:67], v[88:91], v[144:159]
    v_exp_f32 v100, v100
    v_exp_f32 v101, v101
    v_exp_f32 v102, v102
    v_exp_f32 v103, v103
    v_cvt_pk_bf16_f32 v80, v96, v97
    v_cvt_pk_bf16_f32 v81, v98, v99
    v_mfma_f32_32x32x8bf16_1k v[112:127], v[60:61], v[44:45], v[112:127]
    v_exp_f32 v104, v104
    v_exp_f32 v105, v105
    v_exp_f32 v106, v106
    v_exp_f32 v107, v107
    v_cvt_pk_bf16_f32 v82, v100, v101
    v_cvt_pk_bf16_f32 v83, v102, v103
    v_mfma_f32_32x32x16_bf16 v[144:159], v[68:71], v[92:95], v[144:159]
    v_exp_f32 v108, v108
    v_exp_f32 v109, v109
    v_exp_f32 v110, v110
    v_exp_f32 v111, v111
    v_cvt_pk_bf16_f32 v84, v104, v105
    v_cvt_pk_bf16_f32 v85, v106, v107
    v_cvt_pk_bf16_f32 v86, v108, v109
    v_cvt_pk_bf16_f32 v87, v110, v111
    s_waitcnt lgkmcnt(0)
    v_mfma_f32_32x32x16_bf16 v[128:143], v[72:75], v[80:83], v[128:143]
    v_exp_f32 v112, v112
    v_exp_f32 v113, v113
    v_exp_f32 v114, v114
    v_exp_f32 v115, v115
    v_mfma_f32_32x32x16_bf16 v[128:143], v[76:79], v[84:87], v[128:143]
    v_exp_f32 v116, v116
    v_exp_f32 v117, v117
    v_exp_f32 v118, v118
    v_exp_f32 v119, v119
    v_cvt_pk_bf16_f32 v88, v112, v113
    v_cvt_pk_bf16_f32 v89, v114, v115
    v_exp_f32 v120, v120
    v_exp_f32 v121, v121
    v_exp_f32 v122, v122
    v_exp_f32 v123, v123
    v_cvt_pk_bf16_f32 v90, v116, v117
    v_cvt_pk_bf16_f32 v91, v118, v119
    v_exp_f32 v124, v124
    v_exp_f32 v125, v125
    v_exp_f32 v126, v126
    v_exp_f32 v127, v127
    v_cvt_pk_bf16_f32 v92, v120, v121
    v_cvt_pk_bf16_f32 v93, v122, v123
    v_cvt_pk_bf16_f32 v94, v124, v125
    v_cvt_pk_bf16_f32 v95, v126, v127
    v_mfma_f32_32x32x16_bf16 v[144:159], v[72:75], v[88:91], v[144:159]
    s_nop 0
    v_mfma_f32_32x32x16_bf16 v[144:159], v[76:79], v[92:95], v[144:159]
L_slow_back:
    s_mov_b32 s66, 0x71800000
    s_mov_b32 s67, 0x30800000
    v_rcp_f32 v2, v140
    v_cmp_nge_f32 s[62:63], v140, s67
    v_pk_mul_f32 v[128:129], v[128:129], v[2:3] op_sel:[0,0] op_sel_hi:[1,0]
    v_pk_mul_f32 v[130:131], v[130:131], v[2:3] op_sel:[0,0] op_sel_hi:[1,0]
    v_pk_mul_f32 v[132:133], v[132:133], v[2:3] op_sel:[0,0] op_sel_hi:[1,0]
    v_pk_mul_f32 v[134:135], v[134:135], v[2:3] op_sel:[0,0] op_sel_hi:[1,0]
    v_pk_mul_f32 v[136:137], v[136:137], v[2:3] op_sel:[0,0] op_sel_hi:[1,0]
    v_pk_mul_f32 v[138:139], v[138:139], v[2:3] op_sel:[0,0] op_sel_hi:[1,0]
    v_cvt_pk_bf16_f32 v96, v128, v129
    v_cvt_pk_bf16_f32 v97, v130, v131
    v_cvt_pk_bf16_f32 v98, v132, v133
    v_cvt_pk_bf16_f32 v99, v134, v135
    v_cvt_pk_bf16_f32 v100, v136, v137
    v_cvt_pk_bf16_f32 v101, v138, v139
    v_pk_add_f32 v[128:129], v[128:129], v[130:131]
    v_pk_add_f32 v[132:133], v[132:133], v[134:135]
    v_pk_add_f32 v[136:137], v[136:137], v[138:139]
    v_permlane32_swap_b32 v96, v98
    v_permlane32_swap_b32 v97, v99
    v_pk_add_f32 v[128:129], v[128:129], v[132:133]
    v_pk_add_f32 v[128:129], v[128:129], v[136:137]
    v_add_f32 v128, v128, v129
    v_fma_f32 v128, v128, 0, v140
    v_cmp_nle_f32 vcc, v128, s66
    s_nop 0
    s_or_b64 s[62:63], s[62:63], vcc
    v_rcp_f32 v4, v156
    v_cmp_nge_f32 s[64:65], v156, s67
    v_pk_mul_f32 v[144:145], v[144:145], v[4:5] op_sel:[0,0] op_sel_hi:[1,0]
    v_pk_mul_f32 v[146:147], v[146:147], v[4:5] op_sel:[0,0] op_sel_hi:[1,0]
    v_pk_mul_f32 v[148:149], v[148:149], v[4:5] op_sel:[0,0] op_sel_hi:[1,0]
    v_pk_mul_f32 v[150:151], v[150:151], v[4:5] op_sel:[0,0] op_sel_hi:[1,0]
    v_pk_mul_f32 v[152:153], v[152:153], v[4:5] op_sel:[0,0] op_sel_hi:[1,0]
    v_pk_mul_f32 v[154:155], v[154:155], v[4:5] op_sel:[0,0] op_sel_hi:[1,0]
    v_cvt_pk_bf16_f32 v104, v144, v145
    v_cvt_pk_bf16_f32 v105, v146, v147
    v_cvt_pk_bf16_f32 v106, v148, v149
    v_cvt_pk_bf16_f32 v107, v150, v151
    v_cvt_pk_bf16_f32 v108, v152, v153
    v_cvt_pk_bf16_f32 v109, v154, v155
    v_pk_add_f32 v[144:145], v[144:145], v[146:147]
    v_pk_add_f32 v[148:149], v[148:149], v[150:151]
    v_pk_add_f32 v[152:153], v[152:153], v[154:155]
    v_permlane32_swap_b32 v104, v106
    v_permlane32_swap_b32 v105, v107
    v_pk_add_f32 v[144:145], v[144:145], v[148:149]
    v_pk_add_f32 v[144:145], v[144:145], v[152:153]
    v_add_f32 v144, v144, v145
    v_fma_f32 v144, v144, 0, v156
    v_cmp_nle_f32 vcc, v144, s66
    s_or_b64 s[62:63], s[62:63], s[64:65]
    v_permlane32_swap_b32 v100, v108
    v_permlane32_swap_b32 v101, v109
    s_or_b64 vcc, vcc, s[62:63]
    s_cbranch_scc1 L_slow
L_slow_done:
    buffer_store_dwordx4 v[96:99], v28, s[32:35], s88 offen sc1
    buffer_store_dwordx4 v[104:107], v28, s[32:35], s88 offen offset:512 sc1
    buffer_store_dwordx2 v[100:101], v16, s[32:35], s89 offen sc1
    s_xor_b32 s67, s42, s95
    s_waitcnt vmcnt(3)
    v_cmp_ne_u32 vcc, s67, v15
    s_nop 0
    s_cmp_lg_u64 vcc, 0
    s_cselect_b32 s94, 1, 0
    v_lshlrev_b32 v32, 16, v160
    v_and_b32 v33, 0xffff0000, v160
    v_lshlrev_b32 v34, 16, v161
    v_and_b32 v35, 0xffff0000, v161
    v_lshlrev_b32 v36, 16, v162
    v_and_b32 v37, 0xffff0000, v162
    v_lshlrev_b32 v38, 16, v163
    v_and_b32 v39, 0xffff0000, v163
    v_lshlrev_b32 v40, 16, v164
    v_and_b32 v41, 0xffff0000, v164
    v_lshlrev_b32 v42, 16, v165
    v_and_b32 v43, 0xffff0000, v165
    v_lshlrev_b32 v44, 16, v166
    v_and_b32 v45, 0xffff0000, v166
    v_lshlrev_b32 v46, 16, v167
    v_and_b32 v47, 0xffff0000, v167
    v_lshlrev_b32 v48, 16, v168
    v_and_b32 v49, 0xffff0000, v168
    v_lshlrev_b32 v50, 16, v169
    v_and_b32 v51, 0xffff0000, v169
    v_lshrrev_b32 v2, 4, v1
    v_and_b32 v3, 15, v1
    v_lshlrev_b32 v3, 4, v3
    v_lshl_add_u32 v3, v2, 10, v3
    s_add_u32 s66, s6, 1
    s_and_b32 s66, s66, 3
    s_lshl_b32 s67, s66, 8
    v_add_u32 v12, s67, v3
    s_mul_i32 s66, s66, 5120
    s_add_u32 s66, s66, 143360
    v_add_u32 v8, s66, v16
    s_add_u32 s66, s6, 2
    s_and_b32 s66, s66, 3
    s_lshl_b32 s67, s66, 8
    v_add_u32 v13, s67, v3
    s_mul_i32 s66, s66, 5120
    s_add_u32 s66, s66, 143360
    v_add_u32 v9, s66, v16
    s_add_u32 s66, s6, 3
    s_and_b32 s66, s66, 3
    s_lshl_b32 s67, s66, 8
    v_add_u32 v14, s67, v3
    s_mul_i32 s66, s66, 5120
    s_add_u32 s66, s66, 143360
    v_add_u32 v10, s66, v16
    s_add_u32 s66, s6, 4
    s_and_b32 s66, s66, 3
    s_lshl_b32 s67, s66, 8
    v_add_u32 v15, s67, v3
    s_mul_i32 s66, s66, 5120
    s_add_u32 s66, s66, 143360
    v_add_u32 v11, s66, v16
    v_and_b32 v2, 7, v1
    s_lshl_b32 s66, s3, 3
    v_add_u32 v2, s66, v2
    v_lshl_add_u32 v2, v2, 5, s52
    v_lshlrev_b32 v2, 7, v2
    v_add_u32 v30, 21364736, v2
    s_mul_i32 s62, s52, 80
    s_mul_i32 s66, s3, 20
    s_add_u32 s62, s62, s66
    s_lshl_b32 s62, s62, 10
    s_add_u32 s62, s62, 8388608
    s_add_u32 s63, s62, 4096
    s_add_u32 s64, s62, 8192
    s_add_u32 s65, s62, 12288
    s_add_u32 s58, s62, 16384
    s_lshl_b32 s66, s52, 2
    s_add_u32 s66, s66, s6
    s_lshl_b32 s66, s66, 4
    v_and_b32 v5, 15, v1
    v_add_u32 v24, s66, v5
    v_lshlrev_b32 v24, 6, v24
    v_bfe_u32 v2, v1, 4, 1
    v_lshrrev_b32 v3, 5, v1
    v_lshl_add_u32 v4, v2, 1, v3
    v_lshlrev_b32 v5, 4, v5
    v_lshl_add_u32 v25, v4, 10, v5
    v_lshl_add_u32 v5, v3, 10, v5
    v_lshl_add_u32 v26, v2, 3, v5
    s_mul_i32 s66, s52, 80
    s_mul_i32 s67, s51, 10
    s_add_u32 s66, s66, s67
    s_lshl_b32 s66, s66, 10
    s_lshl_b32 s67, s6, 8
    s_add_u32 s66, s66, s67
    s_add_u32 s54, s66, 11010048
    s_add_u32 s55, s54, 4096
    s_add_u32 s56, s54, 8192
    s_lshl_b32 s59, s51, 3
    s_add_u32 s59, s59, 20709376
    v_mov_b32 v19, 0x3f803f80
    s_waitcnt lgkmcnt(0)
    s_waitcnt vmcnt(0)
    v_mov_b32 v4, s42
    v_lshlrev_b32 v5, 2, v1
    s_mov_b32 exec_hi, 0
    buffer_store_dword v4, v5, s[32:35], s4 offen sc1
    s_mov_b32 exec_hi, -1
    s_barrier
    ds_read_b128 v[52:55], v21 offset:0
    ds_read_b128 v[56:59], v21 offset:1024
    ds_read_b128 v[60:63], v21 offset:2048
    ds_read_b128 v[64:67], v21 offset:3072
    ds_read_b128 v[68:71], v21 offset:4096
    s_mov_b32 s44, 0
    s_nop 1
L_pl_30:
    buffer_load_dword v2, v30, s[32:35], 0 offen sc1
L_chain2:
    s_cbranch_execz L_pad2_1
    s_waitcnt vmcnt(0)
    v_cmp_ne_u32 vcc, s42, v2
    s_add_u32 s44, s44, 1
    s_cmp_gt_u32 s44, 1000000
    s_cbranch_scc1 L_pld_31
    s_cbranch_vccnz L_pl_30
L_pld_31:
    buffer_load_dwordx4 v[72:75], v12, s[32:35], s62 offen sc1
    buffer_load_dwordx4 v[76:79], v12, s[32:35], s63 offen sc1
    buffer_load_dwordx4 v[80:83], v12, s[32:35], s64 offen sc1
    buffer_load_dwordx4 v[84:87], v12, s[32:35], s65 offen sc1
    buffer_load_dwordx4 v[88:91], v12, s[32:35], s58 offen sc1
    buffer_load_dwordx4 v[92:95], v13, s[32:35], s62 offen sc1
    buffer_load_dwordx4 v[96:99], v13, s[32:35], s63 offen sc1
    buffer_load_dwordx4 v[100:103], v13, s[32:35], s64 offen sc1
    s_lshl_b32 s4, s52, 3
    s_add_u32 s4, s4, s51
    s_lshl_b32 s4, s4, 2
    s_add_u32 s4, s4, s6
    s_lshl_b32 s4, s4, 7
    s_add_u32 s4, s4, 21495808
    s_waitcnt vmcnt(7)
    v_mfma_f32_16x16x32_bf16 v[32:35], v[176:179], v[72:75], v[32:35]
    buffer_load_dwordx4 v[104:107], v13, s[32:35], s65 offen sc1
    v_mfma_f32_16x16x32_bf16 v[36:39], v[180:183], v[72:75], v[36:39]
    v_mfma_f32_16x16x32_bf16 v[40:43], v[184:187], v[72:75], v[40:43]
    v_mfma_f32_16x16x32_bf16 v[44:47], v[188:191], v[72:75], v[44:47]
    v_mfma_f32_16x16x32_bf16 v[48:51], v[192:195], v[72:75], v[48:51]
    s_waitcnt vmcnt(7)
    v_mfma_f32_16x16x32_bf16 v[32:35], v[196:199], v[76:79], v[32:35]
    buffer_load_dwordx4 v[108:111], v13, s[32:35], s58 offen sc1
    v_mfma_f32_16x16x32_bf16 v[36:39], v[200:203], v[76:79], v[36:39]
    v_mfma_f32_16x16x32_bf16 v[40:43], v[204:207], v[76:79], v[40:43]
    v_mfma_f32_16x16x32_bf16 v[44:47], v[208:211], v[76:79], v[44:47]
    v_mfma_f32_16x16x32_bf16 v[48:51], v[212:215], v[76:79], v[48:51]
    s_waitcnt vmcnt(7)
    v_mfma_f32_16x16x32_bf16 v[32:35], v[216:219], v[80:83], v[32:35]
    buffer_load_dwordx4 v[112:115], v14, s[32:35], s62 offen sc1
    v_mfma_f32_16x16x32_bf16 v[36:39], v[220:223], v[80:83], v[36:39]
    v_mfma_f32_16x16x32_bf16 v[40:43], v[224:227], v[80:83], v[40:43]
    v_mfma_f32_16x16x32_bf16 v[44:47], v[228:231], v[80:83], v[44:47]
    v_mfma_f32_16x16x32_bf16 v[48:51], v[232:235], v[80:83], v[48:51]
    s_waitcnt vmcnt(7)
    v_mfma_f32_16x16x32_bf16 v[32:35], v[236:239], v[84:87], v[32:35]
    buffer_load_dwordx4 v[116:119], v14, s[32:35], s63 offen sc1
    v_mfma_f32_16x16x32_bf16 v[36:39], v[240:243], v[84:87], v[36:39]
    v_mfma_f32_16x16x32_bf16 v[40:43], v[244:247], v[84:87], v[40:43]
    v_mfma_f32_16x16x32_bf16 v[44:47], v[248:251], v[84:87], v[44:47]
    v_mfma_f32_16x16x32_bf16 v[48:51], v[252:255], v[84:87], v[48:51]
    s_waitcnt vmcnt(7) lgkmcnt(4)
    v_mfma_f32_16x16x32_bf16 v[32:35], v[52:55], v[88:91], v[32:35]
    buffer_load_dwordx4 v[120:123], v14, s[32:35], s64 offen sc1
    s_waitcnt lgkmcnt(3)
    v_mfma_f32_16x16x32_bf16 v[36:39], v[56:59], v[88:91], v[36:39]
    s_waitcnt lgkmcnt(2)
    v_mfma_f32_16x16x32_bf16 v[40:43], v[60:63], v[88:91], v[40:43]
    s_waitcnt lgkmcnt(1)
    v_mfma_f32_16x16x32_bf16 v[44:47], v[64:67], v[88:91], v[44:47]
    s_waitcnt lgkmcnt(0)
    v_mfma_f32_16x16x32_bf16 v[48:51], v[68:71], v[88:91], v[48:51]
    s_waitcnt vmcnt(7)
    v_mfma_f32_16x16x32_bf16 v[72:75], v[176:179], v[92:95], 0
    buffer_load_dwordx4 v[124:127], v14, s[32:35], s65 offen sc1
    v_mfma_f32_16x16x32_bf16 v[76:79], v[180:183], v[92:95], 0
    v_mfma_f32_16x16x32_bf16 v[80:83], v[184:187], v[92:95], 0
    v_mfma_f32_16x16x32_bf16 v[84:87], v[188:191], v[92:95], 0
    ds_write_b128 v8, v[32:35] offset:0
    v_mfma_f32_16x16x32_bf16 v[88:91], v[192:195], v[92:95], 0
    ds_write_b128 v8, v[36:39] offset:1024
    s_waitcnt vmcnt(7)
    v_mfma_f32_16x16x32_bf16 v[72:75], v[196:199], v[96:99], v[72:75]
    buffer_load_dwordx4 v[128:131], v14, s[32:35], s58 offen sc1
    v_mfma_f32_16x16x32_bf16 v[76:79], v[200:203], v[96:99], v[76:79]
    ds_write_b128 v8, v[40:43] offset:2048
    v_mfma_f32_16x16x32_bf16 v[80:83], v[204:207], v[96:99], v[80:83]
    ds_write_b128 v8, v[44:47] offset:3072
    v_mfma_f32_16x16x32_bf16 v[84:87], v[208:211], v[96:99], v[84:87]
    ds_write_b128 v8, v[48:51] offset:4096
    v_mfma_f32_16x16x32_bf16 v[88:91], v[212:215], v[96:99], v[88:91]
    s_waitcnt lgkmcnt(0)
    s_barrier
    s_waitcnt vmcnt(7)
    v_mfma_f32_16x16x32_bf16 v[72:75], v[216:219], v[100:103], v[72:75]
    buffer_load_dwordx4 v[132:135], v15, s[32:35], s62 offen sc1
    v_mfma_f32_16x16x32_bf16 v[76:79], v[220:223], v[100:103], v[76:79]
    ds_read_b128 v[152:155], v9 offset:0
    ds_read_b128 v[156:159], v9 offset:1024
    ds_read_b128 v[160:163], v9 offset:2048
    v_mfma_f32_16x16x32_bf16 v[80:83], v[224:227], v[100:103], v[80:83]
    ds_read_b128 v[164:167], v9 offset:3072
    ds_read_b128 v[168:171], v9 offset:4096
    v_mfma_f32_16x16x32_bf16 v[84:87], v[228:231], v[100:103], v[84:87]
    v_mfma_f32_16x16x32_bf16 v[88:91], v[232:235], v[100:103], v[88:91]
    s_waitcnt vmcnt(7)
    v_mfma_f32_16x16x32_bf16 v[72:75], v[236:239], v[104:107], v[72:75]
    buffer_load_dwordx4 v[136:139], v15, s[32:35], s63 offen sc1
    v_mfma_f32_16x16x32_bf16 v[76:79], v[240:243], v[104:107], v[76:79]
    v_mfma_f32_16x16x32_bf16 v[80:83], v[244:247], v[104:107], v[80:83]
    v_mfma_f32_16x16x32_bf16 v[84:87], v[248:251], v[104:107], v[84:87]
    v_mfma_f32_16x16x32_bf16 v[88:91], v[252:255], v[104:107], v[88:91]
    s_waitcnt vmcnt(7)
    v_mfma_f32_16x16x32_bf16 v[72:75], v[52:55], v[108:111], v[72:75]
    buffer_load_dwordx4 v[140:143], v15, s[32:35], s64 offen sc1
    v_mfma_f32_16x16x32_bf16 v[76:79], v[56:59], v[108:111], v[76:79]
    v_mfma_f32_16x16x32_bf16 v[80:83], v[60:63], v[108:111], v[80:83]
    v_mfma_f32_16x16x32_bf16 v[84:87], v[64:67], v[108:111], v[84:87]
    v_mfma_f32_16x16x32_bf16 v[88:91], v[68:71], v[108:111], v[88:91]
    s_waitcnt vmcnt(7)
    v_mfma_f32_16x16x32_bf16 v[92:95], v[176:179], v[112:115], 0
    buffer_load_dwordx4 v[144:147], v15, s[32:35], s65 offen sc1
    v_mfma_f32_16x16x32_bf16 v[96:99], v[180:183], v[112:115], 0
    v_mfma_f32_16x16x32_bf16 v[100:103], v[184:187], v[112:115], 0
    s_waitcnt lgkmcnt(4)
    v_add_f32 v72, v72, v152
    v_add_f32 v73, v73, v153
    v_add_f32 v74, v74, v154
    v_add_f32 v75, v75, v155
    v_mfma_f32_16x16x32_bf16 v[104:107], v[188:191], v[112:115], 0
    ds_write_b128 v9, v[72:75] offset:0
    v_mfma_f32_16x16x32_bf16 v[108:111], v[192:195], v[112:115], 0
    s_waitcnt lgkmcnt(4)
    v_add_f32 v76, v76, v156
    v_add_f32 v77, v77, v157
    v_add_f32 v78, v78, v158
    v_add_f32 v79, v79, v159
    s_waitcnt vmcnt(7)
    v_mfma_f32_16x16x32_bf16 v[92:95], v[196:199], v[116:119], v[92:95]
    buffer_load_dwordx4 v[148:151], v15, s[32:35], s58 offen sc1
    v_mfma_f32_16x16x32_bf16 v[96:99], v[200:203], v[116:119], v[96:99]
    ds_write_b128 v9, v[76:79] offset:1024
    v_mfma_f32_16x16x32_bf16 v[100:103], v[204:207], v[116:119], v[100:103]
    s_waitcnt lgkmcnt(4)
    v_add_f32 v80, v80, v160
    v_add_f32 v81, v81, v161
    v_add_f32 v82, v82, v162
    v_add_f32 v83, v83, v163
    v_mfma_f32_16x16x32_bf16 v[104:107], v[208:211], v[116:119], v[104:107]
    ds_write_b128 v9, v[80:83] offset:2048
    v_mfma_f32_16x16x32_bf16 v[108:111], v[212:215], v[116:119], v[108:111]
    s_waitcnt lgkmcnt(4)
    v_add_f32 v84, v84, v164
    v_add_f32 v85, v85, v165
    v_add_f32 v86, v86, v166
    v_add_f32 v87, v87, v167
    s_waitcnt vmcnt(7)
    v_mfma_f32_16x16x32_bf16 v[92:95], v[216:219], v[120:123], v[92:95]
    ds_write_b128 v9, v[84:87] offset:3072
    v_mfma_f32_16x16x32_bf16 v[96:99], v[220:223], v[120:123], v[96:99]
    s_waitcnt lgkmcnt(4)
    v_add_f32 v88, v88, v168
    v_add_f32 v89, v89, v169
    v_add_f32 v90, v90, v170
    v_add_f32 v91, v91, v171
    v_mfma_f32_16x16x32_bf16 v[100:103], v[224:227], v[120:123], v[100:103]
    ds_write_b128 v9, v[88:91] offset:4096
    v_mfma_f32_16x16x32_bf16 v[104:107], v[228:231], v[120:123], v[104:107]
    v_mfma_f32_16x16x32_bf16 v[108:111], v[232:235], v[120:123], v[108:111]
    s_waitcnt lgkmcnt(0)
    s_barrier
    s_waitcnt vmcnt(6)
    v_mfma_f32_16x16x32_bf16 v[92:95], v[236:239], v[124:127], v[92:95]
    ds_read_b128 v[152:155], v10 offset:0
    ds_read_b128 v[156:159], v10 offset:1024
    ds_read_b128 v[160:163], v10 offset:2048
    v_mfma_f32_16x16x32_bf16 v[96:99], v[240:243], v[124:127], v[96:99]
    ds_read_b128 v[164:167], v10 offset:3072
    ds_read_b128 v[168:171], v10 offset:4096
    v_mfma_f32_16x16x32_bf16 v[100:103], v[244:247], v[124:127], v[100:103]
    v_mfma_f32_16x16x32_bf16 v[104:107], v[248:251], v[124:127], v[104:107]
    v_mfma_f32_16x16x32_bf16 v[108:111], v[252:255], v[124:127], v[108:111]
    s_waitcnt vmcnt(5)
    v_mfma_f32_16x16x32_bf16 v[92:95], v[52:55], v[128:131], v[92:95]
    v_mfma_f32_16x16x32_bf16 v[96:99], v[56:59], v[128:131], v[96:99]
    v_mfma_f32_16x16x32_bf16 v[100:103], v[60:63], v[128:131], v[100:103]
    v_mfma_f32_16x16x32_bf16 v[104:107], v[64:67], v[128:131], v[104:107]
    v_mfma_f32_16x16x32_bf16 v[108:111], v[68:71], v[128:131], v[108:111]
    s_waitcnt vmcnt(4)
    v_mfma_f32_16x16x32_bf16 v[32:35], v[176:179], v[132:135], 0
    v_mfma_f32_16x16x32_bf16 v[36:39], v[180:183], v[132:135], 0
    v_mfma_f32_16x16x32_bf16 v[40:43], v[184:187], v[132:135], 0
    s_waitcnt lgkmcnt(4)
    v_add_f32 v92, v92, v152
    v_add_f32 v93, v93, v153
    v_add_f32 v94, v94, v154
    v_add_f32 v95, v95, v155
    v_mfma_f32_16x16x32_bf16 v[44:47], v[188:191], v[132:135], 0
    ds_write_b128 v10, v[92:95] offset:0
    v_mfma_f32_16x16x32_bf16 v[48:51], v[192:195], v[132:135], 0
    s_waitcnt lgkmcnt(4)
    v_add_f32 v96, v96, v156
    v_add_f32 v97, v97, v157
    v_add_f32 v98, v98, v158
    v_add_f32 v99, v99, v159
    s_waitcnt vmcnt(3)
    v_mfma_f32_16x16x32_bf16 v[32:35], v[196:199], v[136:139], v[32:35]
    ds_write_b128 v10, v[96:99] offset:1024
    v_mfma_f32_16x16x32_bf16 v[36:39], v[200:203], v[136:139], v[36:39]
    s_waitcnt lgkmcnt(4)
    v_add_f32 v100, v100, v160
    v_add_f32 v101, v101, v161
    v_add_f32 v102, v102, v162
    v_add_f32 v103, v103, v163
    v_mfma_f32_16x16x32_bf16 v[40:43], v[204:207], v[136:139], v[40:43]
    ds_write_b128 v10, v[100:103] offset:2048
    v_mfma_f32_16x16x32_bf16 v[44:47], v[208:211], v[136:139], v[44:47]
    s_waitcnt lgkmcnt(4)
    v_add_f32 v104, v104, v164
    v_add_f32 v105, v105, v165
    v_add_f32 v106, v106, v166
    v_add_f32 v107, v107, v167
    v_mfma_f32_16x16x32_bf16 v[48:51], v[212:215], v[136:139], v[48:51]
    ds_write_b128 v10, v[104:107] offset:3072
    s_waitcnt vmcnt(2)
    v_mfma_f32_16x16x32_bf16 v[32:35], v[216:219], v[140:143], v[32:35]
    s_waitcnt lgkmcnt(4)
    v_add_f32 v108, v108, v168
    v_add_f32 v109, v109, v169
    v_add_f32 v110, v110, v170
    v_add_f32 v111, v111, v171
    v_mfma_f32_16x16x32_bf16 v[36:39], v[220:223], v[140:143], v[36:39]
    ds_write_b128 v10, v[108:111] offset:4096
    v_mfma_f32_16x16x32_bf16 v[40:43], v[224:227], v[140:143], v[40:43]
    v_mfma_f32_16x16x32_bf16 v[44:47], v[228:231], v[140:143], v[44:47]
    v_mfma_f32_16x16x32_bf16 v[48:51], v[232:235], v[140:143], v[48:51]
    s_waitcnt lgkmcnt(0)
    s_barrier
    s_waitcnt vmcnt(1)
    v_mfma_f32_16x16x32_bf16 v[32:35], v[236:239], v[144:147], v[32:35]
    ds_read_b128 v[152:155], v11 offset:0
    ds_read_b128 v[156:159], v11 offset:1024
    ds_read_b128 v[160:163], v11 offset:2048
    v_mfma_f32_16x16x32_bf16 v[36:39], v[240:243], v[144:147], v[36:39]
    ds_read_b128 v[164:167], v11 offset:3072
    ds_read_b128 v[168:171], v11 offset:4096
    v_mfma_f32_16x16x32_bf16 v[40:43], v[244:247], v[144:147], v[40:43]
    v_mfma_f32_16x16x32_bf16 v[44:47], v[248:251], v[144:147], v[44:47]
    v_mfma_f32_16x16x32_bf16 v[48:51], v[252:255], v[144:147], v[48:51]
    s_waitcnt vmcnt(0)
    v_mfma_f32_16x16x32_bf16 v[32:35], v[52:55], v[148:151], v[32:35]
    v_mfma_f32_16x16x32_bf16 v[36:39], v[56:59], v[148:151], v[36:39]
    v_mfma_f32_16x16x32_bf16 v[40:43], v[60:63], v[148:151], v[40:43]
    v_mfma_f32_16x16x32_bf16 v[44:47], v[64:67], v[148:151], v[44:47]
    v_mfma_f32_16x16x32_bf16 v[48:51], v[68:71], v[148:151], v[48:51]
    s_waitcnt lgkmcnt(4)
    s_nop 2
    v_pk_add_f32 v[32:33], v[32:33], v[152:153]
    v_pk_add_f32 v[34:35], v[34:35], v[154:155]
    s_waitcnt lgkmcnt(3)
    v_pk_add_f32 v[36:37], v[36:37], v[156:157]
    v_pk_add_f32 v[38:39], v[38:39], v[158:159]
    s_waitcnt lgkmcnt(2)
    v_pk_add_f32 v[40:41], v[40:41], v[160:161]
    v_pk_add_f32 v[42:43], v[42:43], v[162:163]
    s_waitcnt lgkmcnt(1)
    v_pk_add_f32 v[44:45], v[44:45], v[164:165]
    v_pk_add_f32 v[46:47], v[46:47], v[166:167]
    s_waitcnt lgkmcnt(0)
    v_pk_add_f32 v[48:49], v[48:49], v[168:169]
    v_pk_add_f32 v[50:51], v[50:51], v[170:171]
    v_cvt_pk_bf16_f32 v152, v32, v33
    v_cvt_pk_bf16_f32 v153, v34, v35
    v_cvt_pk_bf16_f32 v154, v36, v37
    v_cvt_pk_bf16_f32 v155, v38, v39
    v_cvt_pk_bf16_f32 v156, v40, v41
    v_cvt_pk_bf16_f32 v157, v42, v43
    v_cvt_pk_bf16_f32 v158, v44, v45
    v_cvt_pk_bf16_f32 v159, v46, v47
    v_cvt_pk_bf16_f32 v230, v48, v49
    v_cvt_pk_bf16_f32 v231, v50, v51
    v_permlane16_swap_b32 v152, v154
    v_permlane16_swap_b32 v153, v155
    v_permlane16_swap_b32 v156, v158
    v_permlane16_swap_b32 v157, v159
    s_cmp_lg_u32 s94, 0
    s_cbranch_scc1 L_gm_32
    buffer_store_dwordx4 v[152:155], v25, s[32:35], s54 offen nt
    buffer_store_dwordx4 v[156:159], v25, s[32:35], s55 offen nt
    buffer_store_dwordx2 v[230:231], v26, s[32:35], s56 offen nt
    v_dot2_f32_bf16 v6, v152, v19, 0
    v_dot2_f32_bf16 v7, v152, v152, 0
    v_dot2_f32_bf16 v6, v153, v19, v6
    v_dot2_f32_bf16 v7, v153, v153, v7
    v_dot2_f32_bf16 v6, v154, v19, v6
    v_dot2_f32_bf16 v7, v154, v154, v7
    v_dot2_f32_bf16 v6, v155, v19, v6
    v_dot2_f32_bf16 v7, v155, v155, v7
    v_dot2_f32_bf16 v6, v156, v19, v6
    v_dot2_f32_bf16 v7, v156, v156, v7
    v_dot2_f32_bf16 v6, v157, v19, v6
    v_dot2_f32_bf16 v7, v157, v157, v7
    v_dot2_f32_bf16 v6, v158, v19, v6
    v_dot2_f32_bf16 v7, v158, v158, v7
    v_dot2_f32_bf16 v6, v159, v19, v6
    v_dot2_f32_bf16 v7, v159, v159, v7
    v_dot2_f32_bf16 v6, v230, v19, v6
    v_dot2_f32_bf16 v7, v230, v230, v7
    v_dot2_f32_bf16 v6, v231, v19, v6
    v_dot2_f32_bf16 v7, v231, v231, v7
    s_nop 1
    v_mov_b32 v2, v6
    v_mov_b32 v3, v7
    s_nop 0
    v_permlane16_swap_b32 v6, v2
    v_permlane16_swap_b32 v7, v3
    v_add_f32 v6, v6, v2
    v_add_f32 v7, v7, v3
    v_mov_b32 v2, v6
    v_mov_b32 v3, v7
    s_nop 0
    v_permlane32_swap_b32 v6, v2
    v_permlane32_swap_b32 v7, v3
    v_add_f32 v6, v6, v2
    v_add_f32 v7, v7, v3
    s_mov_b64 exec, 0xffff
    buffer_store_dwordx2 v[6:7], v24, s[32:35], s59 offen nt
    s_mov_b64 exec, -1
L_gmb_33:
    v_cvt_pk_bf16_f32 v222, v32, v33
    v_cvt_pk_bf16_f32 v223, v34, v35
    v_cvt_pk_bf16_f32 v224, v36, v37
    v_cvt_pk_bf16_f32 v225, v38, v39
    v_cvt_pk_bf16_f32 v226, v40, v41
    v_cvt_pk_bf16_f32 v227, v42, v43
    v_cvt_pk_bf16_f32 v228, v44, v45
    v_cvt_pk_bf16_f32 v229, v46, v47
    s_lshr_b32 s66, s41, 4
    s_lshl_b32 s62, s40, 1
    s_add_u32 s62, s62, s66
    s_lshl_b32 s63, s62, 1
    s_lshr_b32 s66, s3, 1
    s_add_u32 s63, s63, s66
    s_and_b32 s64, s3, 1
    v_and_b32 v2, 7, v1
    s_lshl_b32 s66, s63, 3
    v_add_u32 v2, s66, v2
    v_bfe_u32 v3, v1, 3, 1
    v_lshl_add_u32 v2, v2, 2, v3
    s_lshl_b32 s66, s64, 1
    v_add_u32 v2, s66, v2
    v_lshlrev_b32 v2, 7, v2
    v_add_u32 v30, 21495808, v2
    v_lshrrev_b32 v2, 4, v1
    v_and_b32 v3, 15, v1
    v_lshlrev_b32 v4, 4, v3
    v_lshl_add_u32 v27, v2, 10, v4
    v_lshlrev_b32 v28, 4, v2
    v_lshl_add_u32 v29, v3, 6, v28
    v_add_u32 v28, 143360, v28
    s_mul_i32 s65, s63, 80
    s_lshl_b32 s65, s65, 10
    s_lshl_b32 s66, s64, 9
    s_add_u32 s65, s65, s66
    s_add_u32 s70, s65, 11010048
    s_add_u32 s71, s70, 4096
    s_add_u32 s72, s70, 8192
    s_add_u32 s73, s70, 12288
    s_lshl_b32 s58, s63, 6
    s_lshl_b32 s67, s64, 5
    s_add_u32 s58, s58, s67
    s_lshl_b32 s58, s58, 6
    s_add_u32 s58, s58, 20709376
    s_waitcnt vmcnt(0)
    s_cmp_lg_u32 s94, 0
    s_cbranch_scc1 L_gm_34
    v_mov_b32 v4, s42
    v_lshlrev_b32 v5, 2, v1
    s_mov_b32 exec_hi, 0
    buffer_store_dword v4, v5, s[32:35], s4 offen
    s_mov_b32 exec_hi, -1
L_gmb_35:
    v_add_u32 v25, 57344, v16
    v_add_u32 v26, 114688, v16
    v_mov_b32 v24, v16
    ds_read_b128 v[88:91], v24 offset:0
    ds_read_b128 v[92:95], v24 offset:1024
    ds_read_b128 v[96:99], v24 offset:2048
    ds_read_b128 v[100:103], v24 offset:3072
    ds_read_b128 v[104:107], v24 offset:4096
    ds_read_b128 v[108:111], v24 offset:5120
    ds_read_b128 v[112:115], v24 offset:6144
    s_mov_b32 s44, 0
    s_nop 1
L_pl_36:
    buffer_load_dword v2, v30, s[32:35], 0 offen sc1
    s_waitcnt vmcnt(0)
    v_cmp_ne_u32 vcc, s42, v2
    s_add_u32 s44, s44, 1
    s_cmp_gt_u32 s44, 1000000
    s_cbranch_scc1 L_pld_37
    s_cbranch_vccnz L_pl_36
L_pld_37:
    buffer_load_dwordx4 v[144:147], v27, s[32:35], s70 offen offset:0 sc1
    buffer_load_dwordx4 v[148:151], v27, s[32:35], s70 offen offset:256 sc1
    buffer_load_dwordx4 v[152:155], v27, s[32:35], s71 offen offset:0 sc1
    buffer_load_dwordx4 v[156:159], v27, s[32:35], s71 offen offset:256 sc1
    buffer_load_dwordx4 v[160:163], v27, s[32:35], s72 offen offset:0 sc1
    buffer_load_dwordx4 v[164:167], v27, s[32:35], s72 offen offset:256 sc1
    buffer_load_dwordx4 v[168:171], v27, s[32:35], s73 offen offset:0 sc1
    buffer_load_dwordx4 v[172:175], v27, s[32:35], s73 offen offset:256 sc1
    buffer_load_dwordx4 v[8:11], v29, s[32:35], s58 offen offset:0 sc1
    buffer_load_dwordx4 v[12:15], v29, s[32:35], s58 offen offset:1024 sc1
    s_add_u32 s74, s70, 16384
    s_add_u32 s75, s70, 20480
    s_add_u32 s76, s70, 24576
    s_add_u32 s77, s70, 28672
    s_add_u32 s78, s70, 32768
    s_add_u32 s79, s70, 36864
    s_add_u32 s80, s70, 40960
    s_add_u32 s81, s70, 45056
    s_add_u32 s82, s70, 49152
    s_add_u32 s83, s70, 53248
    s_add_u32 s84, s70, 57344
    s_add_u32 s85, s70, 61440
    s_add_u32 s86, s70, 65536
    s_add_u32 s87, s70, 69632
    s_add_u32 s88, s70, 73728
    s_add_u32 s89, s70, 77824
    v_and_b32 v31, 31, v1
    v_lshlrev_b32 v31, 4, v31
    v_lshrrev_b32 v4, 5, v1
    v_lshl_add_u32 v31, v4, 10, v31
    s_mul_i32 s54, s63, 216
    s_mul_i32 s66, s5, 14
    s_add_u32 s54, s54, s66
    s_lshl_b32 s54, s54, 10
    s_lshl_b32 s66, s64, 9
    s_add_u32 s54, s54, s66
    s_add_u32 s54, s54, 13631488
    s_lshl_b32 s4, s62, 4
    s_add_u32 s4, s4, s5
    s_lshl_b32 s4, s4, 2
    s_add_u32 s4, s4, s3
    s_lshl_b32 s4, s4, 7
    s_add_u32 s4, s4, 21626880
    s_waitcnt lgkmcnt(0)
    s_waitcnt vmcnt(9)
    v_mfma_f32_16x16x32_bf16 v[32:35], v[88:91], v[144:147], 0
    s_waitcnt vmcnt(8)
    v_mfma_f32_16x16x32_bf16 v[36:39], v[88:91], v[148:151], 0
    buffer_load_dwordx4 v[176:179], v27, s[32:35], s74 offen offset:0 sc1
    v_mfma_f32_16x16x32_bf16 v[40:43], v[92:95], v[144:147], 0
    ds_read_b128 v[116:119], v24 offset:7168
    v_mfma_f32_16x16x32_bf16 v[44:47], v[92:95], v[148:151], 0
    ds_read_b128 v[120:123], v24 offset:8192
    v_mfma_f32_16x16x32_bf16 v[48:51], v[96:99], v[144:147], 0
    ds_read_b128 v[124:127], v24 offset:9216
    v_mfma_f32_16x16x32_bf16 v[52:55], v[96:99], v[148:151], 0
    ds_read_b128 v[128:131], v24 offset:10240
    v_mfma_f32_16x16x32_bf16 v[56:59], v[100:103], v[144:147], 0
    ds_read_b128 v[132:135], v24 offset:11264
    v_mfma_f32_16x16x32_bf16 v[60:63], v[100:103], v[148:151], 0
    ds_read_b128 v[136:139], v24 offset:12288
    v_mfma_f32_16x16x32_bf16 v[64:67], v[104:107], v[144:147], 0
    buffer_load_dwordx4 v[180:183], v27, s[32:35], s74 offen offset:256 sc1
    v_mfma_f32_16x16x32_bf16 v[68:71], v[104:107], v[148:151], 0
    ds_read_b128 v[140:143], v24 offset:13312
    v_mfma_f32_16x16x32_bf16 v[72:75], v[108:111], v[144:147], 0
    v_mfma_f32_16x16x32_bf16 v[76:79], v[108:111], v[148:151], 0
    v_mfma_f32_16x16x32_bf16 v[80:83], v[112:115], v[144:147], 0
    v_mfma_f32_16x16x32_bf16 v[84:87], v[112:115], v[148:151], 0
    s_waitcnt lgkmcnt(0)
    s_waitcnt vmcnt(9)
    v_mfma_f32_16x16x32_bf16 v[32:35], v[116:119], v[152:155], v[32:35]
    s_waitcnt vmcnt(8)
    v_mfma_f32_16x16x32_bf16 v[36:39], v[116:119], v[156:159], v[36:39]
    buffer_load_dwordx4 v[184:187], v27, s[32:35], s75 offen offset:0 sc1
    v_mfma_f32_16x16x32_bf16 v[40:43], v[120:123], v[152:155], v[40:43]
    ds_read_b128 v[88:91], v24 offset:14336
    v_mfma_f32_16x16x32_bf16 v[44:47], v[120:123], v[156:159], v[44:47]
    ds_read_b128 v[92:95], v24 offset:15360
    v_mfma_f32_16x16x32_bf16 v[48:51], v[124:127], v[152:155], v[48:51]
    ds_read_b128 v[96:99], v24 offset:16384
    v_mfma_f32_16x16x32_bf16 v[52:55], v[124:127], v[156:159], v[52:55]
    ds_read_b128 v[100:103], v24 offset:17408
    v_mfma_f32_16x16x32_bf16 v[56:59], v[128:131], v[152:155], v[56:59]
    ds_read_b128 v[104:107], v24 offset:18432
    v_mfma_f32_16x16x32_bf16 v[60:63], v[128:131], v[156:159], v[60:63]
    ds_read_b128 v[108:111], v24 offset:19456
    v_mfma_f32_16x16x32_bf16 v[64:67], v[132:135], v[152:155], v[64:67]
    buffer_load_dwordx4 v[188:191], v27, s[32:35], s75 offen offset:256 sc1
    v_mfma_f32_16x16x32_bf16 v[68:71], v[132:135], v[156:159], v[68:71]
    ds_read_b128 v[112:115], v24 offset:20480
    v_mfma_f32_16x16x32_bf16 v[72:75], v[136:139], v[152:155], v[72:75]
    s_mul_i32 s66, s3, 5120
    v_add_u32 v17, s66, v16
    v_mfma_f32_16x16x32_bf16 v[76:79], v[136:139], v[156:159], v[76:79]
    v_add_u32 v18, 61440, v17
    v_lshrrev_b32 v2, 4, v1
    v_mfma_f32_16x16x32_bf16 v[80:83], v[140:143], v[152:155], v[80:83]
    v_and_b32 v3, 15, v1
    v_lshlrev_b32 v3, 4, v3
    v_mfma_f32_16x16x32_bf16 v[84:87], v[140:143], v[156:159], v[84:87]
    s_waitcnt lgkmcnt(0)
    s_waitcnt vmcnt(9)
    v_mfma_f32_16x16x32_bf16 v[32:35], v[88:91], v[160:163], v[32:35]
    s_waitcnt vmcnt(8)
    v_mfma_f32_16x16x32_bf16 v[36:39], v[88:91], v[164:167], v[36:39]
    buffer_load_dwordx4 v[192:195], v27, s[32:35], s76 offen offset:0 sc1
    v_mfma_f32_16x16x32_bf16 v[40:43], v[92:95], v[160:163], v[40:43]
    ds_read_b128 v[116:119], v24 offset:21504
    v_mfma_f32_16x16x32_bf16 v[44:47], v[92:95], v[164:167], v[44:47]
    ds_read_b128 v[120:123], v24 offset:22528
    v_mfma_f32_16x16x32_bf16 v[48:51], v[96:99], v[160:163], v[48:51]
    ds_read_b128 v[124:127], v24 offset:23552
    v_mfma_f32_16x16x32_bf16 v[52:55], v[96:99], v[164:167], v[52:55]
    ds_read_b128 v[128:131], v24 offset:24576
    v_mfma_f32_16x16x32_bf16 v[56:59], v[100:103], v[160:163], v[56:59]
    ds_read_b128 v[132:135], v24 offset:25600
    v_mfma_f32_16x16x32_bf16 v[60:63], v[100:103], v[164:167], v[60:63]
    ds_read_b128 v[136:139], v24 offset:26624
    v_mfma_f32_16x16x32_bf16 v[64:67], v[104:107], v[160:163], v[64:67]
    buffer_load_dwordx4 v[196:199], v27, s[32:35], s76 offen offset:256 sc1
    v_mfma_f32_16x16x32_bf16 v[68:71], v[104:107], v[164:167], v[68:71]
    ds_read_b128 v[140:143], v24 offset:27648
    v_mfma_f32_16x16x32_bf16 v[72:75], v[108:111], v[160:163], v[72:75]
    v_lshl_add_u32 v3, v2, 10, v3
    s_mul_i32 s62, s52, 216
    v_mfma_f32_16x16x32_bf16 v[76:79], v[108:111], v[164:167], v[76:79]
    s_mul_i32 s66, s3, 56
    s_add_u32 s63, s62, 212
    v_mfma_f32_16x16x32_bf16 v[80:83], v[112:115], v[160:163], v[80:83]
    s_add_u32 s62, s62, s66
    s_lshl_b32 s62, s62, 10
    v_mfma_f32_16x16x32_bf16 v[84:87], v[112:115], v[164:167], v[84:87]
    s_waitcnt lgkmcnt(0)
    s_waitcnt vmcnt(9)
    v_mfma_f32_16x16x32_bf16 v[32:35], v[116:119], v[168:171], v[32:35]
    s_waitcnt vmcnt(8)
    v_mfma_f32_16x16x32_bf16 v[36:39], v[116:119], v[172:175], v[36:39]
    buffer_load_dwordx4 v[200:203], v27, s[32:35], s77 offen offset:0 sc1
    v_mfma_f32_16x16x32_bf16 v[40:43], v[120:123], v[168:171], v[40:43]
    ds_read_b128 v[88:91], v24 offset:28672
    v_mfma_f32_16x16x32_bf16 v[44:47], v[120:123], v[172:175], v[44:47]
    ds_read_b128 v[92:95], v24 offset:29696
    v_mfma_f32_16x16x32_bf16 v[48:51], v[124:127], v[168:171], v[48:51]
    ds_read_b128 v[96:99], v24 offset:30720
    v_mfma_f32_16x16x32_bf16 v[52:55], v[124:127], v[172:175], v[52:55]
    ds_read_b128 v[100:103], v24 offset:31744
    v_mfma_f32_16x16x32_bf16 v[56:59], v[128:131], v[168:171], v[56:59]
    ds_read_b128 v[104:107], v24 offset:32768
    v_mfma_f32_16x16x32_bf16 v[60:63], v[128:131], v[172:175], v[60:63]
    ds_read_b128 v[108:111], v24 offset:33792
    v_mfma_f32_16x16x32_bf16 v[64:67], v[132:135], v[168:171], v[64:67]
    buffer_load_dwordx4 v[204:207], v27, s[32:35], s77 offen offset:256 sc1
    v_mfma_f32_16x16x32_bf16 v[68:71], v[132:135], v[172:175], v[68:71]
    ds_read_b128 v[112:115], v24 offset:34816
    v_mfma_f32_16x16x32_bf16 v[72:75], v[136:139], v[168:171], v[72:75]
    s_waitcnt vmcnt(9)
    v_add_f32 v8, v8, v10
    s_add_u32 s62, s62, 13631488
    v_mfma_f32_16x16x32_bf16 v[76:79], v[136:139], v[172:175], v[76:79]
    v_mov_b32 v9, v8
    s_lshl_b32 s63, s63, 10
    v_mfma_f32_16x16x32_bf16 v[80:83], v[140:143], v[168:171], v[80:83]
    v_permlane16_swap_b32 v8, v9
    s_add_u32 s63, s63, 13631488
    v_mfma_f32_16x16x32_bf16 v[84:87], v[140:143], v[172:175], v[84:87]
    s_waitcnt lgkmcnt(0)
    s_waitcnt vmcnt(7)
    v_mfma_f32_16x16x32_bf16 v[32:35], v[88:91], v[176:179], v[32:35]
    s_waitcnt vmcnt(6)
    v_mfma_f32_16x16x32_bf16 v[36:39], v[88:91], v[180:183], v[36:39]
    buffer_load_dwordx4 v[208:211], v27, s[32:35], s78 offen offset:0 sc1
    v_mfma_f32_16x16x32_bf16 v[40:43], v[92:95], v[176:179], v[40:43]
    ds_read_b128 v[116:119], v24 offset:35840
    v_mfma_f32_16x16x32_bf16 v[44:47], v[92:95], v[180:183], v[44:47]
    ds_read_b128 v[120:123], v24 offset:36864
    v_mfma_f32_16x16x32_bf16 v[48:51], v[96:99], v[176:179], v[48:51]
    ds_read_b128 v[124:127], v24 offset:37888
    v_mfma_f32_16x16x32_bf16 v[52:55], v[96:99], v[180:183], v[52:55]
    ds_read_b128 v[128:131], v24 offset:38912
    v_mfma_f32_16x16x32_bf16 v[56:59], v[100:103], v[176:179], v[56:59]
    ds_read_b128 v[132:135], v24 offset:39936
    v_mfma_f32_16x16x32_bf16 v[60:63], v[100:103], v[180:183], v[60:63]
    ds_read_b128 v[136:139], v24 offset:40960
    v_mfma_f32_16x16x32_bf16 v[64:67], v[104:107], v[176:179], v[64:67]
    buffer_load_dwordx4 v[212:215], v27, s[32:35], s78 offen offset:256 sc1
    v_mfma_f32_16x16x32_bf16 v[68:71], v[104:107], v[180:183], v[68:71]
    ds_read_b128 v[140:143], v24 offset:41984
    v_mfma_f32_16x16x32_bf16 v[72:75], v[108:111], v[176:179], v[72:75]
    v_add_f32 v8, v8, v9
    s_add_u32 s66, s6, 1
    v_mfma_f32_16x16x32_bf16 v[76:79], v[108:111], v[180:183], v[76:79]
    v_mov_b32 v9, v8
    s_and_b32 s66, s66, 3
    v_mfma_f32_16x16x32_bf16 v[80:83], v[112:115], v[176:179], v[80:83]
    v_permlane32_swap_b32 v8, v9
    s_lshl_b32 s67, s66, 8
    v_mfma_f32_16x16x32_bf16 v[84:87], v[112:115], v[180:183], v[84:87]
    s_waitcnt lgkmcnt(0)
    s_waitcnt vmcnt(7)
    v_mfma_f32_16x16x32_bf16 v[32:35], v[116:119], v[184:187], v[32:35]
    s_waitcnt vmcnt(6)
    v_mfma_f32_16x16x32_bf16 v[36:39], v[116:119], v[188:191], v[36:39]
    buffer_load_dwordx4 v[144:147], v27, s[32:35], s79 offen offset:0 sc1
    v_mfma_f32_16x16x32_bf16 v[40:43], v[120:123], v[184:187], v[40:43]
    ds_read_b128 v[88:91], v24 offset:43008
    v_mfma_f32_16x16x32_bf16 v[44:47], v[120:123], v[188:191], v[44:47]
    ds_read_b128 v[92:95], v24 offset:44032
    v_mfma_f32_16x16x32_bf16 v[48:51], v[124:127], v[184:187], v[48:51]
    ds_read_b128 v[96:99], v24 offset:45056
    v_mfma_f32_16x16x32_bf16 v[52:55], v[124:127], v[188:191], v[52:55]
    ds_read_b128 v[100:103], v24 offset:46080
    v_mfma_f32_16x16x32_bf16 v[56:59], v[128:131], v[184:187], v[56:59]
    ds_read_b128 v[104:107], v24 offset:47104
    v_mfma_f32_16x16x32_bf16 v[60:63], v[128:131], v[188:191], v[60:63]
    ds_read_b128 v[108:111], v24 offset:48128
    v_mfma_f32_16x16x32_bf16 v[64:67], v[132:135], v[184:187], v[64:67]
    buffer_load_dwordx4 v[148:151], v27, s[32:35], s79 offen offset:256 sc1
    v_mfma_f32_16x16x32_bf16 v[68:71], v[132:135], v[188:191], v[68:71]
    ds_read_b128 v[112:115], v24 offset:49152
    v_mfma_f32_16x16x32_bf16 v[72:75], v[136:139], v[184:187], v[72:75]
    v_add_f32 v8, v8, v9
    v_add_u32 v252, s67, v3
    v_mfma_f32_16x16x32_bf16 v[76:79], v[136:139], v[188:191], v[76:79]
    v_mul_f32 v8, 0xbacccccd, v8
    s_mul_i32 s66, s66, 35840
    v_mfma_f32_16x16x32_bf16 v[80:83], v[140:143], v[184:187], v[80:83]
    v_cvt_pk_bf16_f32 v8, v8, v8
    s_add_u32 s66, s66, 0
    v_mfma_f32_16x16x32_bf16 v[84:87], v[140:143], v[188:191], v[84:87]
L_pad2_1:
    s_cbranch_execz L_pad2_2
    s_waitcnt lgkmcnt(0)
    s_waitcnt vmcnt(7)
    v_mfma_f32_16x16x32_bf16 v[32:35], v[88:91], v[192:195], v[32:35]
    s_waitcnt vmcnt(6)
    v_mfma_f32_16x16x32_bf16 v[36:39], v[88:91], v[196:199], v[36:39]
    buffer_load_dwordx4 v[152:155], v27, s[32:35], s80 offen offset:0 sc1
    v_mfma_f32_16x16x32_bf16 v[40:43], v[92:95], v[192:195], v[40:43]
    ds_read_b128 v[116:119], v24 offset:50176
    v_mfma_f32_16x16x32_bf16 v[44:47], v[92:95], v[196:199], v[44:47]
    ds_read_b128 v[120:123], v24 offset:51200
    v_mfma_f32_16x16x32_bf16 v[48:51], v[96:99], v[192:195], v[48:51]
    ds_read_b128 v[124:127], v24 offset:52224
    v_mfma_f32_16x16x32_bf16 v[52:55], v[96:99], v[196:199], v[52:55]
    ds_read_b128 v[128:131], v24 offset:53248
    v_mfma_f32_16x16x32_bf16 v[56:59], v[100:103], v[192:195], v[56:59]
    ds_read_b128 v[132:135], v24 offset:54272
    v_mfma_f32_16x16x32_bf16 v[60:63], v[100:103], v[196:199], v[60:63]
    ds_read_b128 v[136:139], v24 offset:55296
    v_mfma_f32_16x16x32_bf16 v[64:67], v[104:107], v[192:195], v[64:67]
    buffer_load_dwordx4 v[156:159], v27, s[32:35], s80 offen offset:256 sc1
    v_mfma_f32_16x16x32_bf16 v[68:71], v[104:107], v[196:199], v[68:71]
    ds_read_b128 v[140:143], v24 offset:56320
    v_mfma_f32_16x16x32_bf16 v[72:75], v[108:111], v[192:195], v[72:75]
    v_and_b32 v8, 0xffff0000, v8
    v_add_u32 v216, s66, v16
    v_mfma_f32_16x16x32_bf16 v[76:79], v[108:111], v[196:199], v[76:79]
    v_add_f32 v12, v12, v14
    s_add_u32 s66, s6, 2
    v_mfma_f32_16x16x32_bf16 v[80:83], v[112:115], v[192:195], v[80:83]
    v_mov_b32 v13, v12
    s_and_b32 s66, s66, 3
    v_mfma_f32_16x16x32_bf16 v[84:87], v[112:115], v[196:199], v[84:87]
    s_waitcnt lgkmcnt(0)
    s_waitcnt vmcnt(7)
    v_mfma_f32_16x16x32_bf16 v[32:35], v[116:119], v[200:203], v[32:35]
    s_waitcnt vmcnt(6)
    v_mfma_f32_16x16x32_bf16 v[36:39], v[116:119], v[204:207], v[36:39]
    buffer_load_dwordx4 v[160:163], v27, s[32:35], s81 offen offset:0 sc1
    v_mfma_f32_16x16x32_bf16 v[40:43], v[120:123], v[200:203], v[40:43]
    ds_read_b128 v[88:91], v25 offset:0
    v_mfma_f32_16x16x32_bf16 v[44:47], v[120:123], v[204:207], v[44:47]
    ds_read_b128 v[92:95], v25 offset:1024
    v_mfma_f32_16x16x32_bf16 v[48:51], v[124:127], v[200:203], v[48:51]
    ds_read_b128 v[96:99], v25 offset:2048
    v_mfma_f32_16x16x32_bf16 v[52:55], v[124:127], v[204:207], v[52:55]
    ds_read_b128 v[100:103], v25 offset:3072
    v_mfma_f32_16x16x32_bf16 v[56:59], v[128:131], v[200:203], v[56:59]
    ds_read_b128 v[104:107], v25 offset:4096
    v_mfma_f32_16x16x32_bf16 v[60:63], v[128:131], v[204:207], v[60:63]
    ds_read_b128 v[108:111], v25 offset:5120
    v_mfma_f32_16x16x32_bf16 v[64:67], v[132:135], v[200:203], v[64:67]
    buffer_load_dwordx4 v[164:167], v27, s[32:35], s81 offen offset:256 sc1
    v_mfma_f32_16x16x32_bf16 v[68:71], v[132:135], v[204:207], v[68:71]
    ds_read_b128 v[112:115], v25 offset:6144
    v_mfma_f32_16x16x32_bf16 v[72:75], v[136:139], v[200:203], v[72:75]
    v_permlane16_swap_b32 v12, v13
    s_lshl_b32 s67, s66, 8
    v_mfma_f32_16x16x32_bf16 v[76:79], v[136:139], v[204:207], v[76:79]
    v_add_f32 v12, v12, v13
    v_add_u32 v253, s67, v3
    v_mfma_f32_16x16x32_bf16 v[80:83], v[140:143], v[200:203], v[80:83]
    v_mov_b32 v13, v12
    s_mul_i32 s66, s66, 35840
    v_mfma_f32_16x16x32_bf16 v[84:87], v[140:143], v[204:207], v[84:87]
    s_waitcnt lgkmcnt(0)
    s_waitcnt vmcnt(7)
    v_mfma_f32_16x16x32_bf16 v[32:35], v[88:91], v[208:211], v[32:35]
    s_waitcnt vmcnt(6)
    v_mfma_f32_16x16x32_bf16 v[36:39], v[88:91], v[212:215], v[36:39]
    buffer_load_dwordx4 v[168:171], v27, s[32:35], s82 offen offset:0 sc1
    v_mfma_f32_16x16x32_bf16 v[40:43], v[92:95], v[208:211], v[40:43]
    ds_read_b128 v[116:119], v25 offset:7168
    v_mfma_f32_16x16x32_bf16 v[44:47], v[92:95], v[212:215], v[44:47]
    ds_read_b128 v[120:123], v25 offset:8192
    v_mfma_f32_16x16x32_bf16 v[48:51], v[96:99], v[208:211], v[48:51]
    ds_read_b128 v[124:127], v25 offset:9216
    v_mfma_f32_16x16x32_bf16 v[52:55], v[96:99], v[212:215], v[52:55]
    ds_read_b128 v[128:131], v25 offset:10240
    v_mfma_f32_16x16x32_bf16 v[56:59], v[100:103], v[208:211], v[56:59]
    ds_read_b128 v[132:135], v25 offset:11264
    v_mfma_f32_16x16x32_bf16 v[60:63], v[100:103], v[212:215], v[60:63]
    ds_read_b128 v[136:139], v25 offset:12288
    v_mfma_f32_16x16x32_bf16 v[64:67], v[104:107], v[208:211], v[64:67]
    buffer_load_dwordx4 v[172:175], v27, s[32:35], s82 offen offset:256 sc1
    v_mfma_f32_16x16x32_bf16 v[68:71], v[104:107], v[212:215], v[68:71]
    ds_read_b128 v[140:143], v25 offset:13312
    v_mfma_f32_16x16x32_bf16 v[72:75], v[108:111], v[208:211], v[72:75]
    v_permlane32_swap_b32 v12, v13
    s_add_u32 s66, s66, 5120
    v_mfma_f32_16x16x32_bf16 v[76:79], v[108:111], v[212:215], v[76:79]
    v_add_f32 v12, v12, v13
    v_add_u32 v217, s66, v16
    v_mfma_f32_16x16x32_bf16 v[80:83], v[112:115], v[208:211], v[80:83]
    v_mul_f32 v12, 0xbacccccd, v12
    s_add_u32 s66, s6, 3
    v_mfma_f32_16x16x32_bf16 v[84:87], v[112:115], v[212:215], v[84:87]
    s_waitcnt lgkmcnt(0)
    s_waitcnt vmcnt(7)
    v_mfma_f32_16x16x32_bf16 v[32:35], v[116:119], v[144:147], v[32:35]
    s_waitcnt vmcnt(6)
    v_mfma_f32_16x16x32_bf16 v[36:39], v[116:119], v[148:151], v[36:39]
    buffer_load_dwordx4 v[176:179], v27, s[32:35], s83 offen offset:0 sc1
    v_mfma_f32_16x16x32_bf16 v[40:43], v[120:123], v[144:147], v[40:43]
    ds_read_b128 v[88:91], v25 offset:14336
    v_mfma_f32_16x16x32_bf16 v[44:47], v[120:123], v[148:151], v[44:47]
    ds_read_b128 v[92:95], v25 offset:15360
    v_mfma_f32_16x16x32_bf16 v[48:51], v[124:127], v[144:147], v[48:51]
    ds_read_b128 v[96:99], v25 offset:16384
    v_mfma_f32_16x16x32_bf16 v[52:55], v[124:127], v[148:151], v[52:55]
    ds_read_b128 v[100:103], v25 offset:17408
    v_mfma_f32_16x16x32_bf16 v[56:59], v[128:131], v[144:147], v[56:59]
    ds_read_b128 v[104:107], v25 offset:18432
    v_mfma_f32_16x16x32_bf16 v[60:63], v[128:131], v[148:151], v[60:63]
    ds_read_b128 v[108:111], v25 offset:19456
    v_mfma_f32_16x16x32_bf16 v[64:67], v[132:135], v[144:147], v[64:67]
    buffer_load_dwordx4 v[180:183], v27, s[32:35], s83 offen offset:256 sc1
    v_mfma_f32_16x16x32_bf16 v[68:71], v[132:135], v[148:151], v[68:71]
    ds_read_b128 v[112:115], v25 offset:20480
    v_mfma_f32_16x16x32_bf16 v[72:75], v[136:139], v[144:147], v[72:75]
    v_cvt_pk_bf16_f32 v12, v12, v12
    s_and_b32 s66, s66, 3
    v_mfma_f32_16x16x32_bf16 v[76:79], v[136:139], v[148:151], v[76:79]
    v_and_b32 v12, 0xffff0000, v12
    s_lshl_b32 s67, s66, 8
    v_mfma_f32_16x16x32_bf16 v[80:83], v[140:143], v[144:147], v[80:83]
    v_add_u32 v254, s67, v3
    s_mul_i32 s66, s66, 35840
    v_mfma_f32_16x16x32_bf16 v[84:87], v[140:143], v[148:151], v[84:87]
    s_waitcnt lgkmcnt(0)
    s_waitcnt vmcnt(7)
    v_mfma_f32_16x16x32_bf16 v[32:35], v[88:91], v[152:155], v[32:35]
    s_barrier
    s_waitcnt vmcnt(6)
    v_mfma_f32_16x16x32_bf16 v[36:39], v[88:91], v[156:159], v[36:39]
    buffer_load_dwordx4 v[184:187], v27, s[32:35], s84 offen offset:0 sc1
    v_mfma_f32_16x16x32_bf16 v[40:43], v[92:95], v[152:155], v[40:43]
    ds_read_b128 v[116:119], v25 offset:21504
    v_mfma_f32_16x16x32_bf16 v[44:47], v[92:95], v[156:159], v[44:47]
    ds_read_b128 v[120:123], v25 offset:22528
    v_mfma_f32_16x16x32_bf16 v[48:51], v[96:99], v[152:155], v[48:51]
    ds_read_b128 v[124:127], v25 offset:23552
    v_mfma_f32_16x16x32_bf16 v[52:55], v[96:99], v[156:159], v[52:55]
    ds_read_b128 v[128:131], v25 offset:24576
    v_mfma_f32_16x16x32_bf16 v[56:59], v[100:103], v[152:155], v[56:59]
    ds_read_b128 v[132:135], v25 offset:25600
    v_mfma_f32_16x16x32_bf16 v[60:63], v[100:103], v[156:159], v[60:63]
    ds_read_b128 v[136:139], v25 offset:26624
    v_mfma_f32_16x16x32_bf16 v[64:67], v[104:107], v[152:155], v[64:67]
    buffer_load_dwordx4 v[188:191], v27, s[32:35], s84 offen offset:256 sc1
    v_mfma_f32_16x16x32_bf16 v[68:71], v[104:107], v[156:159], v[68:71]
    ds_read_b128 v[140:143], v25 offset:27648
    v_mfma_f32_16x16x32_bf16 v[72:75], v[108:111], v[152:155], v[72:75]
    s_add_u32 s66, s66, 10240
    v_add_u32 v218, s66, v16
    v_mfma_f32_16x16x32_bf16 v[76:79], v[108:111], v[156:159], v[76:79]
    s_add_u32 s66, s6, 4
    s_and_b32 s66, s66, 3
    v_mfma_f32_16x16x32_bf16 v[80:83], v[112:115], v[152:155], v[80:83]
    s_lshl_b32 s67, s66, 8
    v_add_u32 v255, s67, v3
    v_mfma_f32_16x16x32_bf16 v[84:87], v[112:115], v[156:159], v[84:87]
    s_waitcnt lgkmcnt(0)
    s_waitcnt vmcnt(7)
    v_mfma_f32_16x16x32_bf16 v[32:35], v[116:119], v[160:163], v[32:35]
    s_waitcnt vmcnt(6)
    v_mfma_f32_16x16x32_bf16 v[36:39], v[116:119], v[164:167], v[36:39]
    buffer_load_dwordx4 v[192:195], v27, s[32:35], s85 offen offset:0 sc1
    v_mfma_f32_16x16x32_bf16 v[40:43], v[120:123], v[160:163], v[40:43]
    ds_read_b128 v[88:91], v25 offset:28672
    v_mfma_f32_16x16x32_bf16 v[44:47], v[120:123], v[164:167], v[44:47]
    ds_read_b128 v[92:95], v25 offset:29696
    v_mfma_f32_16x16x32_bf16 v[48:51], v[124:127], v[160:163], v[48:51]
    ds_read_b128 v[96:99], v25 offset:30720
    v_mfma_f32_16x16x32_bf16 v[52:55], v[124:127], v[164:167], v[52:55]
    ds_read_b128 v[100:103], v25 offset:31744
    v_mfma_f32_16x16x32_bf16 v[56:59], v[128:131], v[160:163], v[56:59]
    ds_read_b128 v[104:107], v25 offset:32768
    v_mfma_f32_16x16x32_bf16 v[60:63], v[128:131], v[164:167], v[60:63]
    ds_read_b128 v[108:111], v25 offset:33792
    v_mfma_f32_16x16x32_bf16 v[64:67], v[132:135], v[160:163], v[64:67]
    buffer_load_dwordx4 v[196:199], v27, s[32:35], s85 offen offset:256 sc1
    v_mfma_f32_16x16x32_bf16 v[68:71], v[132:135], v[164:167], v[68:71]
    ds_read_b128 v[112:115], v25 offset:34816
    v_mfma_f32_16x16x32_bf16 v[72:75], v[136:139], v[160:163], v[72:75]
    s_mul_i32 s66, s66, 35840
    s_add_u32 s66, s66, 0
    v_mfma_f32_16x16x32_bf16 v[76:79], v[136:139], v[164:167], v[76:79]
    v_add_u32 v219, s66, v16
    s_add_u32 s96, s62, 45056
    v_mfma_f32_16x16x32_bf16 v[80:83], v[140:143], v[160:163], v[80:83]
    s_add_u32 s97, s62, 49152
    s_cmp_eq_u32 s3, 3
    s_cselect_b32 s97, 0x7f000000, s97
    v_mfma_f32_16x16x32_bf16 v[84:87], v[140:143], v[164:167], v[84:87]
    s_waitcnt lgkmcnt(0)
    s_waitcnt vmcnt(7)
    v_mfma_f32_16x16x32_bf16 v[32:35], v[88:91], v[168:171], v[32:35]
    s_waitcnt vmcnt(6)
    v_mfma_f32_16x16x32_bf16 v[36:39], v[88:91], v[172:175], v[36:39]
    buffer_load_dwordx4 v[200:203], v27, s[32:35], s86 offen offset:0 sc1
    v_mfma_f32_16x16x32_bf16 v[40:43], v[92:95], v[168:171], v[40:43]
    ds_read_b128 v[116:119], v25 offset:35840
    v_mfma_f32_16x16x32_bf16 v[44:47], v[92:95], v[172:175], v[44:47]
    ds_read_b128 v[120:123], v25 offset:36864
    v_mfma_f32_16x16x32_bf16 v[48:51], v[96:99], v[168:171], v[48:51]
    ds_read_b128 v[124:127], v25 offset:37888
    v_mfma_f32_16x16x32_bf16 v[52:55], v[96:99], v[172:175], v[52:55]
    ds_read_b128 v[128:131], v25 offset:38912
    v_mfma_f32_16x16x32_bf16 v[56:59], v[100:103], v[168:171], v[56:59]
    ds_read_b128 v[132:135], v25 offset:39936
    v_mfma_f32_16x16x32_bf16 v[60:63], v[100:103], v[172:175], v[60:63]
    ds_read_b128 v[136:139], v25 offset:40960
    v_mfma_f32_16x16x32_bf16 v[64:67], v[104:107], v[168:171], v[64:67]
    buffer_load_dwordx4 v[204:207], v27, s[32:35], s86 offen offset:256 sc1
    v_mfma_f32_16x16x32_bf16 v[68:71], v[104:107], v[172:175], v[68:71]
    ds_read_b128 v[140:143], v25 offset:41984
    v_mfma_f32_16x16x32_bf16 v[72:75], v[108:111], v[168:171], v[72:75]
    s_add_u32 s98, s62, 53248
    s_cmp_eq_u32 s3, 3
    s_cselect_b32 s98, 0x7f000000, s98
    v_mfma_f32_16x16x32_bf16 v[76:79], v[108:111], v[172:175], v[76:79]
    s_add_u32 s99, s62, 36864
    s_add_u32 s100, s62, 40960
    v_mfma_f32_16x16x32_bf16 v[80:83], v[112:115], v[168:171], v[80:83]
    s_lshl_b32 s66, s52, 2
    s_add_u32 s66, s66, s6
    v_mfma_f32_16x16x32_bf16 v[84:87], v[112:115], v[172:175], v[84:87]
    s_waitcnt lgkmcnt(0)
    s_waitcnt vmcnt(7)
    v_mfma_f32_16x16x32_bf16 v[32:35], v[116:119], v[176:179], v[32:35]
    s_waitcnt vmcnt(6)
    v_mfma_f32_16x16x32_bf16 v[36:39], v[116:119], v[180:183], v[36:39]
    buffer_load_dwordx4 v[208:211], v27, s[32:35], s87 offen offset:0 sc1
    v_mfma_f32_16x16x32_bf16 v[40:43], v[120:123], v[176:179], v[40:43]
    ds_read_b128 v[88:91], v25 offset:43008
    v_mfma_f32_16x16x32_bf16 v[44:47], v[120:123], v[180:183], v[44:47]
    ds_read_b128 v[92:95], v25 offset:44032
    v_mfma_f32_16x16x32_bf16 v[48:51], v[124:127], v[176:179], v[48:51]
    ds_read_b128 v[96:99], v25 offset:45056
    v_mfma_f32_16x16x32_bf16 v[52:55], v[124:127], v[180:183], v[52:55]
    ds_read_b128 v[100:103], v25 offset:46080
    v_mfma_f32_16x16x32_bf16 v[56:59], v[128:131], v[176:179], v[56:59]
    ds_read_b128 v[104:107], v25 offset:47104
    v_mfma_f32_16x16x32_bf16 v[60:63], v[128:131], v[180:183], v[60:63]
    ds_read_b128 v[108:111], v25 offset:48128
    v_mfma_f32_16x16x32_bf16 v[64:67], v[132:135], v[176:179], v[64:67]
    buffer_load_dwordx4 v[212:215], v27, s[32:35], s87 offen offset:256 sc1
    v_mfma_f32_16x16x32_bf16 v[68:71], v[132:135], v[180:183], v[68:71]
    ds_read_b128 v[112:115], v25 offset:49152
    v_mfma_f32_16x16x32_bf16 v[72:75], v[136:139], v[176:179], v[72:75]
    s_lshl_b32 s66, s66, 4
    v_and_b32 v2, 15, v1
    v_mfma_f32_16x16x32_bf16 v[76:79], v[136:139], v[180:183], v[76:79]
    v_add_u32 v5, s66, v2
    v_lshrrev_b32 v3, 4, v1
    v_mfma_f32_16x16x32_bf16 v[80:83], v[140:143], v[176:179], v[80:83]
    v_lshlrev_b32 v4, 6, v5
    v_lshl_add_u32 v19, v3, 4, v4
    v_mfma_f32_16x16x32_bf16 v[84:87], v[140:143], v[180:183], v[84:87]
    s_waitcnt lgkmcnt(0)
    s_waitcnt vmcnt(7)
    v_mfma_f32_16x16x32_bf16 v[32:35], v[88:91], v[184:187], v[32:35]
    s_waitcnt vmcnt(6)
    v_mfma_f32_16x16x32_bf16 v[36:39], v[88:91], v[188:191], v[36:39]
    buffer_load_dwordx4 v[144:147], v27, s[32:35], s88 offen offset:0 sc1
    v_mfma_f32_16x16x32_bf16 v[40:43], v[92:95], v[184:187], v[40:43]
    ds_read_b128 v[116:119], v25 offset:50176
    v_mfma_f32_16x16x32_bf16 v[44:47], v[92:95], v[188:191], v[44:47]
    ds_read_b128 v[120:123], v25 offset:51200
    v_mfma_f32_16x16x32_bf16 v[48:51], v[96:99], v[184:187], v[48:51]
    ds_read_b128 v[124:127], v25 offset:52224
    v_mfma_f32_16x16x32_bf16 v[52:55], v[96:99], v[188:191], v[52:55]
    ds_read_b128 v[128:131], v25 offset:53248
    v_mfma_f32_16x16x32_bf16 v[56:59], v[100:103], v[184:187], v[56:59]
    ds_read_b128 v[132:135], v25 offset:54272
    v_mfma_f32_16x16x32_bf16 v[60:63], v[100:103], v[188:191], v[60:63]
    ds_read_b128 v[136:139], v25 offset:55296
    v_mfma_f32_16x16x32_bf16 v[64:67], v[104:107], v[184:187], v[64:67]
    buffer_load_dwordx4 v[148:151], v27, s[32:35], s88 offen offset:256 sc1
    v_mfma_f32_16x16x32_bf16 v[68:71], v[104:107], v[188:191], v[68:71]
    ds_read_b128 v[140:143], v25 offset:56320
    v_mfma_f32_16x16x32_bf16 v[72:75], v[108:111], v[184:187], v[72:75]
    v_mul_u32_u24 v4, 1280, v5
    v_bfe_u32 v2, v1, 4, 1
    v_mfma_f32_16x16x32_bf16 v[76:79], v[108:111], v[188:191], v[76:79]
    v_lshrrev_b32 v3, 5, v1
    v_lshl_add_u32 v6, v2, 1, v3
    v_mfma_f32_16x16x32_bf16 v[80:83], v[112:115], v[184:187], v[80:83]
    v_lshl_add_u32 v20, v6, 4, v4
    v_lshrrev_b32 v6, 4, v1
    v_mfma_f32_16x16x32_bf16 v[84:87], v[112:115], v[188:191], v[84:87]
    s_waitcnt lgkmcnt(0)
    s_waitcnt vmcnt(7)
    v_mfma_f32_16x16x32_bf16 v[32:35], v[116:119], v[192:195], v[32:35]
    s_barrier
    s_waitcnt vmcnt(6)
    v_mfma_f32_16x16x32_bf16 v[36:39], v[116:119], v[196:199], v[36:39]
    buffer_load_dwordx4 v[152:155], v27, s[32:35], s89 offen offset:0 sc1
    v_mfma_f32_16x16x32_bf16 v[40:43], v[120:123], v[192:195], v[40:43]
    ds_read_b128 v[88:91], v26 offset:0
    v_mfma_f32_16x16x32_bf16 v[44:47], v[120:123], v[196:199], v[44:47]
    ds_read_b128 v[92:95], v26 offset:1024
    v_mfma_f32_16x16x32_bf16 v[48:51], v[124:127], v[192:195], v[48:51]
    ds_read_b128 v[96:99], v26 offset:2048
    v_mfma_f32_16x16x32_bf16 v[52:55], v[124:127], v[196:199], v[52:55]
    ds_read_b128 v[100:103], v26 offset:3072
    v_mfma_f32_16x16x32_bf16 v[56:59], v[128:131], v[192:195], v[56:59]
    ds_read_b128 v[104:107], v26 offset:4096
    v_mfma_f32_16x16x32_bf16 v[60:63], v[128:131], v[196:199], v[60:63]
    ds_read_b128 v[108:111], v26 offset:5120
    v_mfma_f32_16x16x32_bf16 v[64:67], v[132:135], v[192:195], v[64:67]
    buffer_load_dwordx4 v[156:159], v27, s[32:35], s89 offen offset:256 sc1
    v_mfma_f32_16x16x32_bf16 v[68:71], v[132:135], v[196:199], v[68:71]
    ds_read_b128 v[112:115], v26 offset:6144
    v_mfma_f32_16x16x32_bf16 v[72:75], v[136:139], v[192:195], v[72:75]
    v_lshl_add_u32 v21, v6, 3, v4
    s_mul_i32 s59, s51, 160
    v_mfma_f32_16x16x32_bf16 v[76:79], v[136:139], v[196:199], v[76:79]
    v_mfma_f32_16x16x32_bf16 v[80:83], v[140:143], v[192:195], v[80:83]
    v_mfma_f32_16x16x32_bf16 v[84:87], v[140:143], v[196:199], v[84:87]
    s_waitcnt lgkmcnt(0)
    s_waitcnt vmcnt(7)
    v_mfma_f32_16x16x32_bf16 v[32:35], v[88:91], v[200:203], v[32:35]
    s_waitcnt vmcnt(6)
    v_mfma_f32_16x16x32_bf16 v[36:39], v[88:91], v[204:207], v[36:39]
    v_mfma_f32_16x16x32_bf16 v[40:43], v[92:95], v[200:203], v[40:43]
    ds_read_b128 v[116:119], v26 offset:7168
    v_mfma_f32_16x16x32_bf16 v[44:47], v[92:95], v[204:207], v[44:47]
    ds_read_b128 v[120:123], v26 offset:8192
    v_mfma_f32_16x16x32_bf16 v[48:51], v[96:99], v[200:203], v[48:51]
    ds_read_b128 v[124:127], v26 offset:9216
    v_mfma_f32_16x16x32_bf16 v[52:55], v[96:99], v[204:207], v[52:55]
    ds_read_b128 v[128:131], v26 offset:10240
    v_mfma_f32_16x16x32_bf16 v[56:59], v[100:103], v[200:203], v[56:59]
    ds_read_b128 v[132:135], v26 offset:11264
    v_mfma_f32_16x16x32_bf16 v[60:63], v[100:103], v[204:207], v[60:63]
    ds_read_b128 v[136:139], v26 offset:12288
    v_mfma_f32_16x16x32_bf16 v[64:67], v[104:107], v[200:203], v[64:67]
    ds_read_b128 v[140:143], v26 offset:13312
    v_mfma_f32_16x16x32_bf16 v[68:71], v[104:107], v[204:207], v[68:71]
    v_mfma_f32_16x16x32_bf16 v[72:75], v[108:111], v[200:203], v[72:75]
    ds_read_b128 v[160:163], v28 offset:0
    v_mfma_f32_16x16x32_bf16 v[76:79], v[108:111], v[204:207], v[76:79]
    ds_read_b128 v[164:167], v28 offset:64
    v_mfma_f32_16x16x32_bf16 v[80:83], v[112:115], v[200:203], v[80:83]
    ds_read_b128 v[168:171], v28 offset:128
    v_mfma_f32_16x16x32_bf16 v[84:87], v[112:115], v[204:207], v[84:87]
    ds_read_b128 v[172:175], v28 offset:192
    s_waitcnt lgkmcnt(4)
    s_waitcnt vmcnt(5)
    v_mfma_f32_16x16x32_bf16 v[32:35], v[116:119], v[208:211], v[32:35]
    s_waitcnt vmcnt(4)
    v_mfma_f32_16x16x32_bf16 v[36:39], v[116:119], v[212:215], v[36:39]
    v_mfma_f32_16x16x32_bf16 v[40:43], v[120:123], v[208:211], v[40:43]
    ds_read_b128 v[88:91], v26 offset:14336
    v_mfma_f32_16x16x32_bf16 v[44:47], v[120:123], v[212:215], v[44:47]
    ds_read_b128 v[92:95], v26 offset:15360
    v_mfma_f32_16x16x32_bf16 v[48:51], v[124:127], v[208:211], v[48:51]
    ds_read_b128 v[96:99], v26 offset:16384
    v_mfma_f32_16x16x32_bf16 v[52:55], v[124:127], v[212:215], v[52:55]
    ds_read_b128 v[100:103], v26 offset:17408
    v_mfma_f32_16x16x32_bf16 v[56:59], v[128:131], v[208:211], v[56:59]
    ds_read_b128 v[104:107], v26 offset:18432
    v_mfma_f32_16x16x32_bf16 v[60:63], v[128:131], v[212:215], v[60:63]
    ds_read_b128 v[108:111], v26 offset:19456
    v_mfma_f32_16x16x32_bf16 v[64:67], v[132:135], v[208:211], v[64:67]
    ds_read_b128 v[112:115], v26 offset:20480
    v_mfma_f32_16x16x32_bf16 v[68:71], v[132:135], v[212:215], v[68:71]
    v_mfma_f32_16x16x32_bf16 v[72:75], v[136:139], v[208:211], v[72:75]
    ds_read_b128 v[176:179], v28 offset:256
    v_mfma_f32_16x16x32_bf16 v[76:79], v[136:139], v[212:215], v[76:79]
    ds_read_b128 v[180:183], v28 offset:320
    v_mfma_f32_16x16x32_bf16 v[80:83], v[140:143], v[208:211], v[80:83]
    ds_read_b128 v[184:187], v28 offset:384
    v_mfma_f32_16x16x32_bf16 v[84:87], v[140:143], v[212:215], v[84:87]
    s_add_u32 s55, s54, 4096
    s_add_u32 s56, s54, 6144
    s_cmp_eq_u32 s5, 15
    s_cselect_b32 s56, 0x7f000000, s56
    s_add_u32 s57, s56, 4096
    s_cmp_lg_u32 s94, 0
    s_cbranch_scc1 L_gm_38
    s_waitcnt lgkmcnt(3)
    s_waitcnt vmcnt(3)
    v_mfma_f32_16x16x32_bf16 v[32:35], v[88:91], v[144:147], v[32:35]
    ds_read_b128 v[116:119], v26 offset:21504
    ds_read_b128 v[120:123], v26 offset:22528
    s_waitcnt vmcnt(2)
    v_mfma_f32_16x16x32_bf16 v[36:39], v[88:91], v[148:151], v[36:39]
    ds_read_b128 v[124:127], v26 offset:23552
    ds_read_b128 v[128:131], v26 offset:24576
    v_mfma_f32_16x16x32_bf16 v[40:43], v[92:95], v[144:147], v[40:43]
    ds_read_b128 v[132:135], v26 offset:25600
    ds_read_b128 v[136:139], v26 offset:26624
    v_mfma_f32_16x16x32_bf16 v[44:47], v[92:95], v[148:151], v[44:47]
    ds_read_b128 v[140:143], v26 offset:27648
    s_waitcnt vmcnt(1) lgkmcnt(6)
    v_mfma_f32_16x16x32_bf16 v[32:35], v[116:119], v[152:155], v[32:35]
    s_waitcnt vmcnt(0)
    v_mfma_f32_16x16x32_bf16 v[36:39], v[116:119], v[156:159], v[36:39]
    v_mfma_f32_16x16x32_bf16 v[48:51], v[96:99], v[144:147], v[48:51]
    v_mfma_f32_16x16x32_bf16 v[52:55], v[96:99], v[148:151], v[52:55]
    s_waitcnt lgkmcnt(5)
    v_mfma_f32_16x16x32_bf16 v[40:43], v[120:123], v[152:155], v[40:43]
    s_nop 1
    v_fmac_f32 v32, v8, v160
    v_fmac_f32 v33, v8, v161
    v_mfma_f32_16x16x32_bf16 v[44:47], v[120:123], v[156:159], v[44:47]
    v_fmac_f32 v34, v8, v162
    v_fmac_f32 v35, v8, v163
    v_mfma_f32_16x16x32_bf16 v[56:59], v[100:103], v[144:147], v[56:59]
    v_fmac_f32 v36, v12, v160
    v_fmac_f32 v37, v12, v161
    v_mfma_f32_16x16x32_bf16 v[60:63], v[100:103], v[148:151], v[60:63]
    v_fmac_f32 v38, v12, v162
    v_fmac_f32 v39, v12, v163
    s_waitcnt lgkmcnt(4)
    v_mfma_f32_16x16x32_bf16 v[48:51], v[124:127], v[152:155], v[48:51]
    v_cvt_pk_bf16_f32 v32, v32, v33
    v_cvt_pk_bf16_f32 v33, v34, v35
    v_mfma_f32_16x16x32_bf16 v[52:55], v[124:127], v[156:159], v[52:55]
    v_cvt_pk_bf16_f32 v34, v36, v37
    v_cvt_pk_bf16_f32 v35, v38, v39
    v_mfma_f32_16x16x32_bf16 v[64:67], v[104:107], v[144:147], v[64:67]
    v_pk_max_i16 v32, v32, 0
    v_pk_max_i16 v34, v34, 0
    v_mfma_f32_16x16x32_bf16 v[68:71], v[104:107], v[148:151], v[68:71]
    v_pk_max_i16 v33, v33, 0
    v_pk_max_i16 v35, v35, 0
    s_waitcnt lgkmcnt(3)
    v_mfma_f32_16x16x32_bf16 v[56:59], v[128:131], v[152:155], v[56:59]
    v_permlane16_swap_b32 v32, v34
    v_permlane16_swap_b32 v33, v35
    v_mfma_f32_16x16x32_bf16 v[60:63], v[128:131], v[156:159], v[60:63]
    buffer_store_dwordx4 v[32:35], v31, s[32:35], s54 offen offset:0 nt
    v_fmac_f32 v40, v8, v164
    v_mfma_f32_16x16x32_bf16 v[72:75], v[108:111], v[144:147], v[72:75]
    v_fmac_f32 v41, v8, v165
    v_fmac_f32 v42, v8, v166
    v_mfma_f32_16x16x32_bf16 v[76:79], v[108:111], v[148:151], v[76:79]
    v_fmac_f32 v43, v8, v167
    v_fmac_f32 v44, v12, v164
    s_waitcnt lgkmcnt(2)
    v_mfma_f32_16x16x32_bf16 v[64:67], v[132:135], v[152:155], v[64:67]
    v_fmac_f32 v45, v12, v165
    v_fmac_f32 v46, v12, v166
    v_mfma_f32_16x16x32_bf16 v[68:71], v[132:135], v[156:159], v[68:71]
    v_fmac_f32 v47, v12, v167
    v_cvt_pk_bf16_f32 v40, v40, v41
    v_mfma_f32_16x16x32_bf16 v[80:83], v[112:115], v[144:147], v[80:83]
    v_cvt_pk_bf16_f32 v41, v42, v43
    v_cvt_pk_bf16_f32 v42, v44, v45
    v_mfma_f32_16x16x32_bf16 v[84:87], v[112:115], v[148:151], v[84:87]
    v_cvt_pk_bf16_f32 v43, v46, v47
    v_pk_max_i16 v40, v40, 0
    s_waitcnt lgkmcnt(1)
    v_mfma_f32_16x16x32_bf16 v[72:75], v[136:139], v[152:155], v[72:75]
    v_pk_max_i16 v42, v42, 0
    v_pk_max_i16 v41, v41, 0
    v_mfma_f32_16x16x32_bf16 v[76:79], v[136:139], v[156:159], v[76:79]
    v_pk_max_i16 v43, v43, 0
    v_permlane16_swap_b32 v40, v42
    s_waitcnt lgkmcnt(0)
    v_mfma_f32_16x16x32_bf16 v[80:83], v[140:143], v[152:155], v[80:83]
    v_permlane16_swap_b32 v41, v43
    buffer_store_dwordx4 v[40:43], v31, s[32:35], s54 offen offset:2048 nt
    v_mfma_f32_16x16x32_bf16 v[84:87], v[140:143], v[156:159], v[84:87]
    v_pk_fma_f32 v[48:49], v[168:169], v[8:9], v[48:49] op_sel:[0,0,0] op_sel_hi:[1,0,1]
    v_pk_fma_f32 v[50:51], v[170:171], v[8:9], v[50:51] op_sel:[0,0,0] op_sel_hi:[1,0,1]
    v_pk_fma_f32 v[52:53], v[168:169], v[12:13], v[52:53] op_sel:[0,0,0] op_sel_hi:[1,0,1]
    v_pk_fma_f32 v[54:55], v[170:171], v[12:13], v[54:55] op_sel:[0,0,0] op_sel_hi:[1,0,1]
    v_cvt_pk_bf16_f32 v48, v48, v49
    v_cvt_pk_bf16_f32 v49, v50, v51
    v_cvt_pk_bf16_f32 v50, v52, v53
    v_cvt_pk_bf16_f32 v51, v54, v55
    v_pk_max_i16 v48, v48, 0
    v_pk_max_i16 v50, v50, 0
    v_pk_max_i16 v49, v49, 0
    v_pk_max_i16 v51, v51, 0
    v_permlane16_swap_b32 v48, v50
    s_nop 0
    v_permlane16_swap_b32 v49, v51
    buffer_store_dwordx4 v[48:51], v31, s[32:35], s55 offen offset:0 nt
    v_pk_fma_f32 v[56:57], v[172:173], v[8:9], v[56:57] op_sel:[0,0,0] op_sel_hi:[1,0,1]
    v_pk_fma_f32 v[58:59], v[174:175], v[8:9], v[58:59] op_sel:[0,0,0] op_sel_hi:[1,0,1]
    v_pk_fma_f32 v[60:61], v[172:173], v[12:13], v[60:61] op_sel:[0,0,0] op_sel_hi:[1,0,1]
    v_pk_fma_f32 v[62:63], v[174:175], v[12:13], v[62:63] op_sel:[0,0,0] op_sel_hi:[1,0,1]
    v_cvt_pk_bf16_f32 v56, v56, v57
    v_cvt_pk_bf16_f32 v57, v58, v59
    v_cvt_pk_bf16_f32 v58, v60, v61
    v_cvt_pk_bf16_f32 v59, v62, v63
    v_pk_max_i16 v56, v56, 0
    v_pk_max_i16 v58, v58, 0
    v_pk_max_i16 v57, v57, 0
    v_pk_max_i16 v59, v59, 0
    v_permlane16_swap_b32 v56, v58
    s_nop 0
    v_permlane16_swap_b32 v57, v59
    buffer_store_dwordx4 v[56:59], v31, s[32:35], s56 offen offset:0 nt
    v_pk_fma_f32 v[64:65], v[176:177], v[8:9], v[64:65] op_sel:[0,0,0] op_sel_hi:[1,0,1]
    v_pk_fma_f32 v[66:67], v[178:179], v[8:9], v[66:67] op_sel:[0,0,0] op_sel_hi:[1,0,1]
    v_pk_fma_f32 v[68:69], v[176:177], v[12:13], v[68:69] op_sel:[0,0,0] op_sel_hi:[1,0,1]
    v_pk_fma_f32 v[70:71], v[178:179], v[12:13], v[70:71] op_sel:[0,0,0] op_sel_hi:[1,0,1]
    v_cvt_pk_bf16_f32 v64, v64, v65
    v_cvt_pk_bf16_f32 v65, v66, v67
    v_cvt_pk_bf16_f32 v66, v68, v69
    v_cvt_pk_bf16_f32 v67, v70, v71
    v_pk_max_i16 v64, v64, 0
    v_pk_max_i16 v66, v66, 0
    v_pk_max_i16 v65, v65, 0
    v_pk_max_i16 v67, v67, 0
    v_permlane16_swap_b32 v64, v66
    s_nop 0
    v_permlane16_swap_b32 v65, v67
    buffer_store_dwordx4 v[64:67], v31, s[32:35], s56 offen offset:2048 nt
    v_pk_fma_f32 v[72:73], v[180:181], v[8:9], v[72:73] op_sel:[0,0,0] op_sel_hi:[1,0,1]
    v_pk_fma_f32 v[74:75], v[182:183], v[8:9], v[74:75] op_sel:[0,0,0] op_sel_hi:[1,0,1]
    v_pk_fma_f32 v[76:77], v[180:181], v[12:13], v[76:77] op_sel:[0,0,0] op_sel_hi:[1,0,1]
    v_pk_fma_f32 v[78:79], v[182:183], v[12:13], v[78:79] op_sel:[0,0,0] op_sel_hi:[1,0,1]
    v_cvt_pk_bf16_f32 v72, v72, v73
    v_cvt_pk_bf16_f32 v73, v74, v75
    v_cvt_pk_bf16_f32 v74, v76, v77
    v_cvt_pk_bf16_f32 v75, v78, v79
    v_pk_max_i16 v72, v72, 0
    v_pk_max_i16 v74, v74, 0
    v_pk_max_i16 v73, v73, 0
    v_pk_max_i16 v75, v75, 0
    v_permlane16_swap_b32 v72, v74
    s_nop 0
    v_permlane16_swap_b32 v73, v75
    buffer_store_dwordx4 v[72:75], v31, s[32:35], s57 offen offset:0 nt
    v_pk_fma_f32 v[80:81], v[184:185], v[8:9], v[80:81] op_sel:[0,0,0] op_sel_hi:[1,0,1]
    v_pk_fma_f32 v[82:83], v[186:187], v[8:9], v[82:83] op_sel:[0,0,0] op_sel_hi:[1,0,1]
    v_pk_fma_f32 v[84:85], v[184:185], v[12:13], v[84:85] op_sel:[0,0,0] op_sel_hi:[1,0,1]
    v_pk_fma_f32 v[86:87], v[186:187], v[12:13], v[86:87] op_sel:[0,0,0] op_sel_hi:[1,0,1]
    v_cvt_pk_bf16_f32 v80, v80, v81
    v_cvt_pk_bf16_f32 v81, v82, v83
    v_cvt_pk_bf16_f32 v82, v84, v85
    v_cvt_pk_bf16_f32 v83, v86, v87
    v_pk_max_i16 v80, v80, 0
    v_pk_max_i16 v82, v82, 0
    v_pk_max_i16 v81, v81, 0
    v_pk_max_i16 v83, v83, 0
    v_permlane16_swap_b32 v80, v82
    s_nop 0
    v_permlane16_swap_b32 v81, v83
    buffer_store_dwordx4 v[80:83], v31, s[32:35], s57 offen offset:2048 nt
L_gmb_39:
    s_barrier
    ds_read_b128 v[100:103], v17 offset:0
    ds_read_b128 v[104:107], v17 offset:1024
    ds_read_b128 v[108:111], v17 offset:2048
    ds_read_b128 v[112:115], v17 offset:3072
    ds_read_b128 v[116:119], v17 offset:4096
    ds_read_b128 v[120:123], v17 offset:20480
    ds_read_b128 v[124:127], v17 offset:21504
    ds_read_b128 v[128:131], v17 offset:22528
    ds_read_b128 v[132:135], v17 offset:23552
    ds_read_b128 v[136:139], v17 offset:24576
    ds_read_b128 v[140:143], v17 offset:40960
    ds_read_b128 v[144:147], v17 offset:41984
    ds_read_b128 v[148:151], v17 offset:43008
    ds_read_b128 v[152:155], v17 offset:44032
    ds_read_b128 v[156:159], v17 offset:45056
    ds_read_b128 v[160:163], v18 offset:0
    ds_read_b128 v[164:167], v18 offset:1024
    ds_read_b128 v[168:171], v18 offset:2048
    ds_read_b128 v[172:175], v18 offset:3072
    ds_read_b128 v[176:179], v18 offset:4096
    ds_read_b128 v[180:183], v18 offset:20480
    ds_read_b128 v[184:187], v18 offset:21504
    ds_read_b128 v[188:191], v18 offset:22528
    ds_read_b128 v[192:195], v18 offset:23552
    ds_read_b128 v[196:199], v18 offset:24576
    s_waitcnt vmcnt(0)
L_pad2_2:
    s_cbranch_execz L_pad2_3
    s_cmp_lg_u32 s94, 0
    s_cbranch_scc1 L_gm_40
    v_mov_b32 v4, s42
    v_lshlrev_b32 v5, 2, v1
    s_mov_b32 exec_hi, 0
    buffer_store_dword v4, v5, s[32:35], s4 offen
    s_mov_b32 exec_hi, -1
L_gmb_41:
    s_mov_b32 s58, 20709376
    v_mov_b32 v25, v19
    v_mov_b32 v27, v20
    v_mov_b32 v28, v21
    v_lshlrev_b32 v232, 16, v222
    v_and_b32 v233, 0xffff0000, v222
    v_lshlrev_b32 v234, 16, v223
    v_and_b32 v235, 0xffff0000, v223
    v_lshlrev_b32 v236, 16, v224
    v_and_b32 v237, 0xffff0000, v224
    v_lshlrev_b32 v238, 16, v225
    v_and_b32 v239, 0xffff0000, v225
    v_lshlrev_b32 v240, 16, v226
    v_and_b32 v241, 0xffff0000, v226
    v_lshlrev_b32 v242, 16, v227
    v_and_b32 v243, 0xffff0000, v227
    v_lshlrev_b32 v244, 16, v228
    v_and_b32 v245, 0xffff0000, v228
    v_lshlrev_b32 v246, 16, v229
    v_and_b32 v247, 0xffff0000, v229
    v_lshlrev_b32 v248, 16, v230
    v_and_b32 v249, 0xffff0000, v230
    v_lshlrev_b32 v250, 16, v231
    v_and_b32 v251, 0xffff0000, v231
    s_waitcnt lgkmcnt(0)
    s_barrier
    buffer_load_dwordx4 v[32:35], v252, s[32:35], s96 offen sc1
    buffer_load_dwordx4 v[36:39], v252, s[32:35], s97 offen sc1
    buffer_load_dwordx4 v[40:43], v252, s[32:35], s98 offen sc1
    buffer_load_dwordx4 v[44:47], v252, s[32:35], s99 offen sc1
    buffer_load_dwordx4 v[48:51], v252, s[32:35], s100 offen sc1
    buffer_load_dwordx4 v[52:55], v253, s[32:35], s96 offen sc1
    buffer_load_dwordx4 v[20:23], v25, s[32:35], s58 offen sc1
    s_waitcnt vmcnt(6)
    v_mfma_f32_16x16x32_bf16 v[60:63], v[100:103], v[32:35], 0
    buffer_load_dwordx4 v[56:59], v253, s[32:35], s97 offen sc1
    v_mfma_f32_16x16x32_bf16 v[64:67], v[104:107], v[32:35], 0
    v_mfma_f32_16x16x32_bf16 v[68:71], v[108:111], v[32:35], 0
    v_mfma_f32_16x16x32_bf16 v[72:75], v[112:115], v[32:35], 0
    v_mfma_f32_16x16x32_bf16 v[76:79], v[116:119], v[32:35], 0
    s_waitcnt vmcnt(6)
    v_mfma_f32_16x16x32_bf16 v[60:63], v[120:123], v[36:39], v[60:63]
    buffer_load_dwordx4 v[32:35], v253, s[32:35], s98 offen sc1
    v_mfma_f32_16x16x32_bf16 v[64:67], v[124:127], v[36:39], v[64:67]
    v_mfma_f32_16x16x32_bf16 v[68:71], v[128:131], v[36:39], v[68:71]
    v_mfma_f32_16x16x32_bf16 v[72:75], v[132:135], v[36:39], v[72:75]
    v_mfma_f32_16x16x32_bf16 v[76:79], v[136:139], v[36:39], v[76:79]
    s_waitcnt vmcnt(6)
    v_mfma_f32_16x16x32_bf16 v[60:63], v[140:143], v[40:43], v[60:63]
    buffer_load_dwordx4 v[36:39], v253, s[32:35], s99 offen sc1
    v_mfma_f32_16x16x32_bf16 v[64:67], v[144:147], v[40:43], v[64:67]
    v_mfma_f32_16x16x32_bf16 v[68:71], v[148:151], v[40:43], v[68:71]
    v_mfma_f32_16x16x32_bf16 v[72:75], v[152:155], v[40:43], v[72:75]
    v_mfma_f32_16x16x32_bf16 v[76:79], v[156:159], v[40:43], v[76:79]
    s_waitcnt vmcnt(6)
    v_mfma_f32_16x16x32_bf16 v[60:63], v[160:163], v[44:47], v[60:63]
    buffer_load_dwordx4 v[40:43], v253, s[32:35], s100 offen sc1
    v_mfma_f32_16x16x32_bf16 v[64:67], v[164:167], v[44:47], v[64:67]
    v_mfma_f32_16x16x32_bf16 v[68:71], v[168:171], v[44:47], v[68:71]
    v_mfma_f32_16x16x32_bf16 v[72:75], v[172:175], v[44:47], v[72:75]
    v_mfma_f32_16x16x32_bf16 v[76:79], v[176:179], v[44:47], v[76:79]
    s_waitcnt vmcnt(6)
    v_mfma_f32_16x16x32_bf16 v[60:63], v[180:183], v[48:51], v[60:63]
    buffer_load_dwordx4 v[44:47], v254, s[32:35], s96 offen sc1
    v_mfma_f32_16x16x32_bf16 v[64:67], v[184:187], v[48:51], v[64:67]
    v_mfma_f32_16x16x32_bf16 v[68:71], v[188:191], v[48:51], v[68:71]
    v_mfma_f32_16x16x32_bf16 v[72:75], v[192:195], v[48:51], v[72:75]
    v_mfma_f32_16x16x32_bf16 v[76:79], v[196:199], v[48:51], v[76:79]
    s_waitcnt vmcnt(6)
    v_mfma_f32_16x16x32_bf16 v[80:83], v[100:103], v[52:55], 0
    buffer_load_dwordx4 v[48:51], v254, s[32:35], s97 offen sc1
    v_mfma_f32_16x16x32_bf16 v[84:87], v[104:107], v[52:55], 0
    v_mfma_f32_16x16x32_bf16 v[88:91], v[108:111], v[52:55], 0
    v_mfma_f32_16x16x32_bf16 v[92:95], v[112:115], v[52:55], 0
    ds_write_b128 v216, v[60:63] offset:0
    v_mfma_f32_16x16x32_bf16 v[96:99], v[116:119], v[52:55], 0
    ds_write_b128 v216, v[64:67] offset:1024
    s_waitcnt vmcnt(5)
    v_mfma_f32_16x16x32_bf16 v[80:83], v[120:123], v[56:59], v[80:83]
    buffer_load_dwordx4 v[52:55], v254, s[32:35], s98 offen sc1
    v_mfma_f32_16x16x32_bf16 v[84:87], v[124:127], v[56:59], v[84:87]
    ds_write_b128 v216, v[68:71] offset:2048
    v_mfma_f32_16x16x32_bf16 v[88:91], v[128:131], v[56:59], v[88:91]
    ds_write_b128 v216, v[72:75] offset:3072
    v_mfma_f32_16x16x32_bf16 v[92:95], v[132:135], v[56:59], v[92:95]
    ds_write_b128 v216, v[76:79] offset:4096
    v_mfma_f32_16x16x32_bf16 v[96:99], v[136:139], v[56:59], v[96:99]
    s_waitcnt vmcnt(5)
    v_mfma_f32_16x16x32_bf16 v[80:83], v[140:143], v[32:35], v[80:83]
    buffer_load_dwordx4 v[56:59], v254, s[32:35], s99 offen sc1
    v_mfma_f32_16x16x32_bf16 v[84:87], v[144:147], v[32:35], v[84:87]
    v_mfma_f32_16x16x32_bf16 v[88:91], v[148:151], v[32:35], v[88:91]
    v_mfma_f32_16x16x32_bf16 v[92:95], v[152:155], v[32:35], v[92:95]
    v_mfma_f32_16x16x32_bf16 v[96:99], v[156:159], v[32:35], v[96:99]
    s_waitcnt vmcnt(5)
    v_mfma_f32_16x16x32_bf16 v[80:83], v[160:163], v[36:39], v[80:83]
    buffer_load_dwordx4 v[32:35], v254, s[32:35], s100 offen sc1
    v_mfma_f32_16x16x32_bf16 v[84:87], v[164:167], v[36:39], v[84:87]
    v_mfma_f32_16x16x32_bf16 v[88:91], v[168:171], v[36:39], v[88:91]
    v_mfma_f32_16x16x32_bf16 v[92:95], v[172:175], v[36:39], v[92:95]
    v_mfma_f32_16x16x32_bf16 v[96:99], v[176:179], v[36:39], v[96:99]
    s_waitcnt vmcnt(5)
    v_mfma_f32_16x16x32_bf16 v[80:83], v[180:183], v[40:43], v[80:83]
    buffer_load_dwordx4 v[36:39], v255, s[32:35], s96 offen sc1
    v_mfma_f32_16x16x32_bf16 v[84:87], v[184:187], v[40:43], v[84:87]
    v_mfma_f32_16x16x32_bf16 v[88:91], v[188:191], v[40:43], v[88:91]
    v_mfma_f32_16x16x32_bf16 v[92:95], v[192:195], v[40:43], v[92:95]
    v_mfma_f32_16x16x32_bf16 v[96:99], v[196:199], v[40:43], v[96:99]
    s_waitcnt vmcnt(5)
    v_mfma_f32_16x16x32_bf16 v[60:63], v[100:103], v[44:47], 0
    buffer_load_dwordx4 v[40:43], v255, s[32:35], s97 offen sc1
    v_mfma_f32_16x16x32_bf16 v[64:67], v[104:107], v[44:47], 0
    v_mfma_f32_16x16x32_bf16 v[68:71], v[108:111], v[44:47], 0
    v_mfma_f32_16x16x32_bf16 v[72:75], v[112:115], v[44:47], 0
    ds_write_b128 v217, v[80:83] offset:0
    v_mfma_f32_16x16x32_bf16 v[76:79], v[116:119], v[44:47], 0
    ds_write_b128 v217, v[84:87] offset:1024
    s_waitcnt vmcnt(5)
    v_mfma_f32_16x16x32_bf16 v[60:63], v[120:123], v[48:51], v[60:63]
    buffer_load_dwordx4 v[44:47], v255, s[32:35], s98 offen sc1
    v_mfma_f32_16x16x32_bf16 v[64:67], v[124:127], v[48:51], v[64:67]
    ds_write_b128 v217, v[88:91] offset:2048
    v_mfma_f32_16x16x32_bf16 v[68:71], v[128:131], v[48:51], v[68:71]
    ds_write_b128 v217, v[92:95] offset:3072
    v_mfma_f32_16x16x32_bf16 v[72:75], v[132:135], v[48:51], v[72:75]
    ds_write_b128 v217, v[96:99] offset:4096
    v_mfma_f32_16x16x32_bf16 v[76:79], v[136:139], v[48:51], v[76:79]
    s_waitcnt vmcnt(5)
    v_mfma_f32_16x16x32_bf16 v[60:63], v[140:143], v[52:55], v[60:63]
    buffer_load_dwordx4 v[48:51], v255, s[32:35], s99 offen sc1
    v_mfma_f32_16x16x32_bf16 v[64:67], v[144:147], v[52:55], v[64:67]
    v_mfma_f32_16x16x32_bf16 v[68:71], v[148:151], v[52:55], v[68:71]
    v_mfma_f32_16x16x32_bf16 v[72:75], v[152:155], v[52:55], v[72:75]
    v_mfma_f32_16x16x32_bf16 v[76:79], v[156:159], v[52:55], v[76:79]
    s_waitcnt vmcnt(5)
    v_mfma_f32_16x16x32_bf16 v[60:63], v[160:163], v[56:59], v[60:63]
    buffer_load_dwordx4 v[52:55], v255, s[32:35], s100 offen sc1
    v_mfma_f32_16x16x32_bf16 v[64:67], v[164:167], v[56:59], v[64:67]
    v_mfma_f32_16x16x32_bf16 v[68:71], v[168:171], v[56:59], v[68:71]
    v_mfma_f32_16x16x32_bf16 v[72:75], v[172:175], v[56:59], v[72:75]
    v_mfma_f32_16x16x32_bf16 v[76:79], v[176:179], v[56:59], v[76:79]
    s_waitcnt vmcnt(5)
    v_mfma_f32_16x16x32_bf16 v[60:63], v[180:183], v[32:35], v[60:63]
    v_mfma_f32_16x16x32_bf16 v[64:67], v[184:187], v[32:35], v[64:67]
    v_mfma_f32_16x16x32_bf16 v[68:71], v[188:191], v[32:35], v[68:71]
    v_mfma_f32_16x16x32_bf16 v[72:75], v[192:195], v[32:35], v[72:75]
    v_mfma_f32_16x16x32_bf16 v[76:79], v[196:199], v[32:35], v[76:79]
    s_waitcnt vmcnt(4)
    v_mfma_f32_16x16x32_bf16 v[80:83], v[100:103], v[36:39], 0
    v_mfma_f32_16x16x32_bf16 v[84:87], v[104:107], v[36:39], 0
    v_mfma_f32_16x16x32_bf16 v[88:91], v[108:111], v[36:39], 0
    v_mfma_f32_16x16x32_bf16 v[92:95], v[112:115], v[36:39], 0
    ds_write_b128 v218, v[60:63] offset:0
    v_mfma_f32_16x16x32_bf16 v[96:99], v[116:119], v[36:39], 0
    ds_write_b128 v218, v[64:67] offset:1024
    s_waitcnt vmcnt(3)
    v_mfma_f32_16x16x32_bf16 v[80:83], v[120:123], v[40:43], v[80:83]
    ds_write_b128 v218, v[68:71] offset:2048
    v_mfma_f32_16x16x32_bf16 v[84:87], v[124:127], v[40:43], v[84:87]
    ds_write_b128 v218, v[72:75] offset:3072
    v_mfma_f32_16x16x32_bf16 v[88:91], v[128:131], v[40:43], v[88:91]
    ds_write_b128 v218, v[76:79] offset:4096
    v_mfma_f32_16x16x32_bf16 v[92:95], v[132:135], v[40:43], v[92:95]
    v_mfma_f32_16x16x32_bf16 v[96:99], v[136:139], v[40:43], v[96:99]
    s_waitcnt vmcnt(2)
    v_mfma_f32_16x16x32_bf16 v[80:83], v[140:143], v[44:47], v[80:83]
    v_mfma_f32_16x16x32_bf16 v[84:87], v[144:147], v[44:47], v[84:87]
    v_mfma_f32_16x16x32_bf16 v[88:91], v[148:151], v[44:47], v[88:91]
    v_mfma_f32_16x16x32_bf16 v[92:95], v[152:155], v[44:47], v[92:95]
    v_mfma_f32_16x16x32_bf16 v[96:99], v[156:159], v[44:47], v[96:99]
    s_waitcnt vmcnt(1)
    v_mfma_f32_16x16x32_bf16 v[80:83], v[160:163], v[48:51], v[80:83]
    v_mfma_f32_16x16x32_bf16 v[84:87], v[164:167], v[48:51], v[84:87]
    v_mfma_f32_16x16x32_bf16 v[88:91], v[168:171], v[48:51], v[88:91]
    v_mfma_f32_16x16x32_bf16 v[92:95], v[172:175], v[48:51], v[92:95]
    v_mfma_f32_16x16x32_bf16 v[96:99], v[176:179], v[48:51], v[96:99]
    s_waitcnt vmcnt(0)
    v_mfma_f32_16x16x32_bf16 v[80:83], v[180:183], v[52:55], v[80:83]
    v_mfma_f32_16x16x32_bf16 v[84:87], v[184:187], v[52:55], v[84:87]
    v_mfma_f32_16x16x32_bf16 v[88:91], v[188:191], v[52:55], v[88:91]
    v_mfma_f32_16x16x32_bf16 v[92:95], v[192:195], v[52:55], v[92:95]
    v_mfma_f32_16x16x32_bf16 v[96:99], v[196:199], v[52:55], v[96:99]
    v_add_f32 v20, v20, v22
    v_add_f32 v21, v21, v23
    v_mov_b32 v22, v20
    v_mov_b32 v23, v21
    s_nop 0
    v_permlane16_swap_b32 v20, v22
    v_permlane16_swap_b32 v21, v23
    v_add_f32 v20, v20, v22
    v_add_f32 v21, v21, v23
    v_mov_b32 v22, v20
    v_mov_b32 v23, v21
    s_nop 0
    v_permlane32_swap_b32 v20, v22
    v_permlane32_swap_b32 v21, v23
    v_add_f32 v20, v20, v22
    v_add_f32 v21, v21, v23
    v_mul_f32 v23, 0x3acccccd, v20
    v_mul_f32 v2, 0x3acccccd, v21
    v_fma_f32 v2, -v23, v23, v2
    v_max_f32 v2, 0, v2
    v_cvt_pk_bf16_f32 v2, v2, v2
    v_and_b32 v2, 0xffff0000, v2
    v_add_f32 v2, 0x3727c5ac, v2
    v_cvt_pk_bf16_f32 v2, v2, v2
    v_and_b32 v2, 0xffff0000, v2
    v_sqrt_f32 v2, v2
    s_nop 0
    v_cvt_pk_bf16_f32 v2, v2, v2
    v_and_b32 v2, 0xffff0000, v2
    v_rcp_f32 v22, v2
    v_cvt_pk_bf16_f32 v23, v23, v23
    v_and_b32 v23, 0xffff0000, v23
    s_waitcnt lgkmcnt(0)
    s_barrier
    ds_read_b128 v[116:119], v219 offset:0
    ds_read_b128 v[120:123], v219 offset:1024
    ds_read_b128 v[124:127], v219 offset:2048
    ds_read_b128 v[128:131], v219 offset:3072
    ds_read_b128 v[132:135], v219 offset:4096
    ds_read_b128 v[136:139], v219 offset:5120
    ds_read_b128 v[140:143], v219 offset:6144
    ds_read_b128 v[144:147], v219 offset:7168
    ds_read_b128 v[148:151], v219 offset:8192
    ds_read_b128 v[152:155], v219 offset:9216
    ds_read_b128 v[156:159], v219 offset:10240
    ds_read_b128 v[160:163], v219 offset:11264
    ds_read_b128 v[164:167], v219 offset:12288
    ds_read_b128 v[168:171], v219 offset:13312
    ds_read_b128 v[172:175], v219 offset:14336
    ds_read_b128 v[176:179], v219 offset:15360
    ds_read_b128 v[180:183], v219 offset:16384
    ds_read_b128 v[184:187], v219 offset:17408
    ds_read_b128 v[188:191], v219 offset:18432
    ds_read_b128 v[192:195], v219 offset:19456
    ds_read_b128 v[196:199], v219 offset:20480
    ds_read_b128 v[200:203], v219 offset:21504
    ds_read_b128 v[204:207], v219 offset:22528
    ds_read_b128 v[208:211], v219 offset:23552
    ds_read_b128 v[212:215], v219 offset:24576
    s_waitcnt lgkmcnt(15)
    v_add_f32 v80, v80, v116
    v_add_f32 v81, v81, v117
    v_add_f32 v82, v82, v118
    v_add_f32 v83, v83, v119
    v_add_f32 v84, v84, v120
    v_add_f32 v85, v85, v121
    v_add_f32 v86, v86, v122
    v_add_f32 v87, v87, v123
    v_add_f32 v88, v88, v124
    v_add_f32 v89, v89, v125
    v_add_f32 v90, v90, v126
    v_add_f32 v91, v91, v127
    v_add_f32 v92, v92, v128
    v_add_f32 v93, v93, v129
    v_add_f32 v94, v94, v130
    v_add_f32 v95, v95, v131
    v_add_f32 v96, v96, v132
    v_add_f32 v97, v97, v133
    v_add_f32 v98, v98, v134
    v_add_f32 v99, v99, v135
    v_add_f32 v80, v80, v136
    v_add_f32 v81, v81, v137
    v_add_f32 v82, v82, v138
    v_add_f32 v83, v83, v139
    v_add_f32 v84, v84, v140
    v_add_f32 v85, v85, v141
    v_add_f32 v86, v86, v142
    v_add_f32 v87, v87, v143
    v_add_f32 v88, v88, v144
    v_add_f32 v89, v89, v145
    v_add_f32 v90, v90, v146
    v_add_f32 v91, v91, v147
    v_add_f32 v92, v92, v148
    v_add_f32 v93, v93, v149
    v_add_f32 v94, v94, v150
    v_add_f32 v95, v95, v151
    v_add_f32 v96, v96, v152
    v_add_f32 v97, v97, v153
    v_add_f32 v98, v98, v154
    v_add_f32 v99, v99, v155
    s_waitcnt lgkmcnt(14)
    v_add_f32 v80, v80, v156
    v_add_f32 v81, v81, v157
    v_add_f32 v82, v82, v158
    v_add_f32 v83, v83, v159
    s_waitcnt lgkmcnt(13)
    v_add_f32 v84, v84, v160
    v_add_f32 v85, v85, v161
    v_add_f32 v86, v86, v162
    v_add_f32 v87, v87, v163
    s_waitcnt lgkmcnt(12)
    v_add_f32 v88, v88, v164
    v_add_f32 v89, v89, v165
    v_add_f32 v90, v90, v166
    v_add_f32 v91, v91, v167
    s_waitcnt lgkmcnt(11)
    v_add_f32 v92, v92, v168
    v_add_f32 v93, v93, v169
    v_add_f32 v94, v94, v170
    v_add_f32 v95, v95, v171
    s_waitcnt lgkmcnt(10)
    v_add_f32 v96, v96, v172
    v_add_f32 v97, v97, v173
    v_add_f32 v98, v98, v174
    v_add_f32 v99, v99, v175
    s_waitcnt lgkmcnt(9)
    v_add_f32 v80, v80, v176
    v_add_f32 v81, v81, v177
    v_add_f32 v82, v82, v178
    v_add_f32 v83, v83, v179
    s_waitcnt lgkmcnt(8)
    v_add_f32 v84, v84, v180
    v_add_f32 v85, v85, v181
    v_add_f32 v86, v86, v182
    v_add_f32 v87, v87, v183
    s_waitcnt lgkmcnt(7)
    v_add_f32 v88, v88, v184
    v_add_f32 v89, v89, v185
    v_add_f32 v90, v90, v186
    v_add_f32 v91, v91, v187
    s_waitcnt lgkmcnt(6)
    v_add_f32 v92, v92, v188
    v_add_f32 v93, v93, v189
    v_add_f32 v94, v94, v190
    v_add_f32 v95, v95, v191
    s_waitcnt lgkmcnt(5)
    v_add_f32 v96, v96, v192
    v_add_f32 v97, v97, v193
    v_add_f32 v98, v98, v194
    v_add_f32 v99, v99, v195
    s_waitcnt lgkmcnt(4)
    v_add_f32 v80, v80, v196
    v_add_f32 v81, v81, v197
    v_add_f32 v82, v82, v198
    v_add_f32 v83, v83, v199
    s_waitcnt lgkmcnt(3)
    v_add_f32 v84, v84, v200
    v_add_f32 v85, v85, v201
    v_add_f32 v86, v86, v202
    v_add_f32 v87, v87, v203
    s_waitcnt lgkmcnt(2)
    v_add_f32 v88, v88, v204
    v_add_f32 v89, v89, v205
    v_add_f32 v90, v90, v206
    v_add_f32 v91, v91, v207
    s_waitcnt lgkmcnt(1)
    v_add_f32 v92, v92, v208
    v_add_f32 v93, v93, v209
    v_add_f32 v94, v94, v210
    v_add_f32 v95, v95, v211
    s_waitcnt lgkmcnt(0)
    v_add_f32 v96, v96, v212
    v_add_f32 v97, v97, v213
    v_add_f32 v98, v98, v214
    v_add_f32 v99, v99, v215
    s_barrier
    ds_read_b128 v[116:119], v219 offset:25600
    ds_read_b128 v[120:123], v219 offset:26624
    ds_read_b128 v[124:127], v219 offset:27648
    ds_read_b128 v[128:131], v219 offset:28672
    ds_read_b128 v[132:135], v219 offset:29696
    s_waitcnt lgkmcnt(4)
    v_add_f32 v80, v80, v116
    v_add_f32 v81, v81, v117
    v_add_f32 v82, v82, v118
    v_add_f32 v83, v83, v119
    s_waitcnt lgkmcnt(3)
    v_add_f32 v84, v84, v120
    v_add_f32 v85, v85, v121
    v_add_f32 v86, v86, v122
    v_add_f32 v87, v87, v123
    s_waitcnt lgkmcnt(2)
    v_add_f32 v88, v88, v124
    v_add_f32 v89, v89, v125
    v_add_f32 v90, v90, v126
    v_add_f32 v91, v91, v127
    s_waitcnt lgkmcnt(1)
    v_add_f32 v92, v92, v128
    v_add_f32 v93, v93, v129
    v_add_f32 v94, v94, v130
    v_add_f32 v95, v95, v131
    s_waitcnt lgkmcnt(0)
    v_add_f32 v96, v96, v132
    v_add_f32 v97, v97, v133
    v_add_f32 v98, v98, v134
    v_add_f32 v99, v99, v135
    v_fmac_f32 v232, v22, v80
    v_fmac_f32 v233, v22, v81
    v_fmac_f32 v234, v22, v82
    v_fmac_f32 v235, v22, v83
    v_fmac_f32 v236, v22, v84
    v_fmac_f32 v237, v22, v85
    v_fmac_f32 v238, v22, v86
    v_fmac_f32 v239, v22, v87
    v_fmac_f32 v240, v22, v88
    v_fmac_f32 v241, v22, v89
    v_fmac_f32 v242, v22, v90
    v_fmac_f32 v243, v22, v91
    v_fmac_f32 v244, v22, v92
    v_fmac_f32 v245, v22, v93
    v_fmac_f32 v246, v22, v94
    v_fmac_f32 v247, v22, v95
    v_fmac_f32 v248, v22, v96
    v_fmac_f32 v249, v22, v97
    v_fmac_f32 v250, v22, v98
    v_fmac_f32 v251, v22, v99
    s_barrier
    ds_read_b128 v[116:119], v219 offset:30720
    ds_read_b128 v[120:123], v219 offset:31744
    ds_read_b128 v[124:127], v219 offset:32768
    ds_read_b128 v[128:131], v219 offset:33792
    ds_read_b128 v[132:135], v219 offset:34816
    s_waitcnt lgkmcnt(4)
    v_pk_fma_f32 v[232:233], v[116:117], v[22:23], v[232:233] op_sel:[0,0,0] op_sel_hi:[1,0,1]
    v_pk_fma_f32 v[234:235], v[118:119], v[22:23], v[234:235] op_sel:[0,0,0] op_sel_hi:[1,0,1]
    s_waitcnt lgkmcnt(3)
    v_pk_fma_f32 v[236:237], v[120:121], v[22:23], v[236:237] op_sel:[0,0,0] op_sel_hi:[1,0,1]
    v_pk_fma_f32 v[238:239], v[122:123], v[22:23], v[238:239] op_sel:[0,0,0] op_sel_hi:[1,0,1]
    s_waitcnt lgkmcnt(2)
    v_pk_fma_f32 v[240:241], v[124:125], v[22:23], v[240:241] op_sel:[0,0,0] op_sel_hi:[1,0,1]
    v_pk_fma_f32 v[242:243], v[126:127], v[22:23], v[242:243] op_sel:[0,0,0] op_sel_hi:[1,0,1]
    s_waitcnt lgkmcnt(1)
    v_pk_fma_f32 v[244:245], v[128:129], v[22:23], v[244:245] op_sel:[0,0,0] op_sel_hi:[1,0,1]
    v_pk_fma_f32 v[246:247], v[130:131], v[22:23], v[246:247] op_sel:[0,0,0] op_sel_hi:[1,0,1]
    s_waitcnt lgkmcnt(0)
    v_pk_fma_f32 v[248:249], v[132:133], v[22:23], v[248:249] op_sel:[0,0,0] op_sel_hi:[1,0,1]
    v_pk_fma_f32 v[250:251], v[134:135], v[22:23], v[250:251] op_sel:[0,0,0] op_sel_hi:[1,0,1]
    v_cvt_pk_bf16_f32 v136, v232, v233
    v_cvt_pk_bf16_f32 v137, v234, v235
    v_cvt_pk_bf16_f32 v138, v236, v237
    v_cvt_pk_bf16_f32 v139, v238, v239
    v_cvt_pk_bf16_f32 v140, v240, v241
    v_cvt_pk_bf16_f32 v141, v242, v243
    v_cvt_pk_bf16_f32 v142, v244, v245
    v_cvt_pk_bf16_f32 v143, v246, v247
    v_cvt_pk_bf16_f32 v144, v248, v249
    v_cvt_pk_bf16_f32 v145, v250, v251
    v_permlane16_swap_b32 v136, v138
    v_permlane16_swap_b32 v137, v139
    v_permlane16_swap_b32 v140, v142
    v_permlane16_swap_b32 v141, v143
    buffer_store_dwordx4 v[136:139], v27, s[28:31], s59 offen nt
    buffer_store_dwordx4 v[140:143], v27, s[28:31], s59 offen offset:64 nt
    buffer_store_dwordx2 v[144:145], v28, s[28:31], s59 offen offset:128 nt
L_end:
    s_endpgm
L_slow:
    s_cmp_lg_u32 s61, 0
    s_cbranch_scc1 L_slow_done
    s_waitcnt vmcnt(0) lgkmcnt(0)
    s_mov_b32 s61, 1
    s_mov_b32 s62, 0
    s_mov_b32 s63, -1
    s_add_u32 s64, s49, 80
    s_lshl_b32 s64, s64, 10
    v_mov_b32 v6, 0x3f803f80
    v_mov_b32 v2, 0xff800000
    v_mov_b32 v3, 0xff800000
    v_cndmask_b32 v36, v36, 0, s[62:63]
    v_cndmask_b32 v37, v37, 0, s[62:63]
    v_cndmask_b32 v44, v44, 0, s[62:63]
    v_cndmask_b32 v45, v45, 0, s[62:63]
    s_mov_b32 s66, 0
    s_nop 3
L_slow1:
    s_mul_i32 s65, s66, 262144
    s_add_u32 s65, s65, s64
    buffer_load_dwordx4 v[48:51], v28, s[32:35], s65 offen offset:0 sc1
    buffer_load_dwordx2 v[52:53], v31, s[32:35], s65 offen offset:0 sc1
    s_waitcnt vmcnt(0)
    v_cndmask_b32 v52, v52, v6, s[62:63]
    v_cndmask_b32 v53, v53, v6, s[62:63]
    v_mfma_f32_32x32x16_bf16 v[96:111], v[48:51], v[32:35], 0
    s_nop 9
    v_mfma_f32_32x32x8bf16_1k v[96:111], v[52:53], v[36:37], v[96:111]
    v_mfma_f32_32x32x16_bf16 v[112:127], v[48:51], v[40:43], 0
    s_nop 9
    v_mfma_f32_32x32x8bf16_1k v[112:127], v[52:53], v[44:45], v[112:127]
    v_max3_f32 v2, v2, v96, v97
    v_max3_f32 v2, v2, v98, v99
    v_max3_f32 v2, v2, v100, v101
    v_max3_f32 v2, v2, v102, v103
    v_max3_f32 v2, v2, v104, v105
    v_max3_f32 v2, v2, v106, v107
    v_max3_f32 v2, v2, v108, v109
    v_max3_f32 v2, v2, v110, v111
    s_nop 3
    v_max3_f32 v3, v3, v112, v113
    v_max3_f32 v3, v3, v114, v115
    v_max3_f32 v3, v3, v116, v117
    v_max3_f32 v3, v3, v118, v119
    v_max3_f32 v3, v3, v120, v121
    v_max3_f32 v3, v3, v122, v123
    v_max3_f32 v3, v3, v124, v125
    v_max3_f32 v3, v3, v126, v127
    buffer_load_dwordx4 v[48:51], v28, s[32:35], s65 offen offset:512 sc1
    buffer_load_dwordx2 v[52:53], v31, s[32:35], s65 offen offset:512 sc1
    s_waitcnt vmcnt(0)
    v_cndmask_b32 v52, v52, v6, s[62:63]
    v_cndmask_b32 v53, v53, v6, s[62:63]
    v_mfma_f32_32x32x16_bf16 v[96:111], v[48:51], v[32:35], 0
    s_nop 9
    v_mfma_f32_32x32x8bf16_1k v[96:111], v[52:53], v[36:37], v[96:111]
    v_mfma_f32_32x32x16_bf16 v[112:127], v[48:51], v[40:43], 0
    s_nop 9
    v_mfma_f32_32x32x8bf16_1k v[112:127], v[52:53], v[44:45], v[112:127]
    v_max3_f32 v2, v2, v96, v97
    v_max3_f32 v2, v2, v98, v99
    v_max3_f32 v2, v2, v100, v101
    v_max3_f32 v2, v2, v102, v103
    v_max3_f32 v2, v2, v104, v105
    v_max3_f32 v2, v2, v106, v107
    v_max3_f32 v2, v2, v108, v109
    v_max3_f32 v2, v2, v110, v111
    s_nop 3
    v_max3_f32 v3, v3, v112, v113
    v_max3_f32 v3, v3, v114, v115
    v_max3_f32 v3, v3, v116, v117
    v_max3_f32 v3, v3, v118, v119
    v_max3_f32 v3, v3, v120, v121
    v_max3_f32 v3, v3, v122, v123
    v_max3_f32 v3, v3, v124, v125
    v_max3_f32 v3, v3, v126, v127
    s_add_u32 s66, s66, 1
    s_cmp_lt_u32 s66, 32
    s_nop 2
    s_cbranch_scc1 L_slow1
    v_mov_b32 v4, v2
    s_nop 1
    v_permlane32_swap_b32 v2, v4
    v_max_f32 v2, v2, v4
    v_and_b32 v4, 0xffff0000, v2
    v_sub_f32 v5, v2, v4
    v_and_b32 v7, 0xffff0000, v5
    v_sub_f32 v5, v5, v7
    v_cvt_pk_bf16_f32 v4, -v4, -v7
    v_cvt_pk_bf16_f32 v5, -v5, 0
    v_cndmask_b32 v36, v36, v4, s[62:63]
    v_cndmask_b32 v37, v37, v5, s[62:63]
    v_mov_b32 v4, v3
    s_nop 1
    v_permlane32_swap_b32 v3, v4
    v_max_f32 v3, v3, v4
    v_and_b32 v4, 0xffff0000, v3
    v_sub_f32 v5, v3, v4
    v_and_b32 v7, 0xffff0000, v5
    v_sub_f32 v5, v5, v7
    v_cvt_pk_bf16_f32 v4, -v4, -v7
    v_cvt_pk_bf16_f32 v5, -v5, 0
    v_cndmask_b32 v44, v44, v4, s[62:63]
    v_cndmask_b32 v45, v45, v5, s[62:63]
    s_mul_i32 s67, s3, 3072
    s_add_u32 s67, s67, 149504
    s_mov_b32 s65, 158720
    v_lshl_add_u32 v8, v1, 4, s65
    v_mov_b32 v80, 0x3f80
    v_mov_b32 v81, 0
    v_mov_b32 v82, 0
    v_mov_b32 v83, 0
    ds_write_b128 v8, v[80:83] offset:3072
    v_lshlrev_b32 v9, 4, v1
    v_xor_b32 v10, 64, v9
    v_xor_b32 v11, 128, v9
    s_sub_u32 s66, s67, 95232
    v_add_u32 v12, s66, v26
    v_add_u32 v13, s66, v27
    s_mov_b32 m0, s67
    s_sub_u32 s66, s65, 95232
    v_add_u32 v4, s66, v26
    v_add_u32 v5, s66, v27
    v_cmp_le_u32 vcc, 98304, v26
    s_nop 1
    v_cndmask_b32 v12, v12, v4, vcc
    v_cndmask_b32 v13, v13, v5, vcc
    v_mov_b32 v128, 0
    v_mov_b32 v129, 0
    v_mov_b32 v130, 0
    v_mov_b32 v131, 0
    v_mov_b32 v132, 0
    v_mov_b32 v133, 0
    v_mov_b32 v134, 0
    v_mov_b32 v135, 0
    v_mov_b32 v136, 0
    v_mov_b32 v137, 0
    v_mov_b32 v138, 0
    v_mov_b32 v139, 0
    v_mov_b32 v140, 0
    v_mov_b32 v141, 0
    v_mov_b32 v142, 0
    v_mov_b32 v143, 0
    v_mov_b32 v144, 0
    v_mov_b32 v145, 0
    v_mov_b32 v146, 0
    v_mov_b32 v147, 0
    v_mov_b32 v148, 0
    v_mov_b32 v149, 0
    v_mov_b32 v150, 0
    v_mov_b32 v151, 0
    v_mov_b32 v152, 0
    v_mov_b32 v153, 0
    v_mov_b32 v154, 0
    v_mov_b32 v155, 0
    v_mov_b32 v156, 0
    v_mov_b32 v157, 0
    v_mov_b32 v158, 0
    v_mov_b32 v159, 0
    s_mov_b32 s66, 0
    s_waitcnt vmcnt(0) lgkmcnt(0)
    s_nop 2
L_slow2:
    s_mul_i32 s65, s66, 262144
    s_add_u32 s65, s65, s64
    s_add_u32 s67, s65, 81920
    buffer_load_dwordx4 v9, s[32:35], s67 offen offset:0 sc1 lds
    buffer_load_dwordx4 v10, s[32:35], s67 offen offset:1024 sc1 lds
    buffer_load_dwordx4 v11, s[32:35], s67 offen offset:2048 sc1 lds
    buffer_load_dwordx4 v[48:51], v28, s[32:35], s65 offen offset:0 sc1
    buffer_load_dwordx2 v[52:53], v31, s[32:35], s65 offen offset:0 sc1
    s_waitcnt vmcnt(0)
    v_cndmask_b32 v52, v52, v6, s[62:63]
    v_cndmask_b32 v53, v53, v6, s[62:63]
    v_mfma_f32_32x32x16_bf16 v[96:111], v[48:51], v[32:35], 0
    s_nop 9
    v_mfma_f32_32x32x8bf16_1k v[96:111], v[52:53], v[36:37], v[96:111]
    v_mfma_f32_32x32x16_bf16 v[112:127], v[48:51], v[40:43], 0
    s_nop 9
    v_mfma_f32_32x32x8bf16_1k v[112:127], v[52:53], v[44:45], v[112:127]
    s_waitcnt vmcnt(0)
    ds_read_b64_tr_b16 v[64:65], v12 offset:0
    ds_read_b64_tr_b16 v[66:67], v13 offset:0
    ds_read_b64_tr_b16 v[68:69], v12 offset:256
    ds_read_b64_tr_b16 v[70:71], v13 offset:256
    v_exp_f32 v96, v96
    v_exp_f32 v97, v97
    v_exp_f32 v98, v98
    v_exp_f32 v99, v99
    v_exp_f32 v100, v100
    v_exp_f32 v101, v101
    v_exp_f32 v102, v102
    v_exp_f32 v103, v103
    v_exp_f32 v104, v104
    v_exp_f32 v105, v105
    v_exp_f32 v106, v106
    v_exp_f32 v107, v107
    v_exp_f32 v108, v108
    v_exp_f32 v109, v109
    v_exp_f32 v110, v110
    v_exp_f32 v111, v111
    v_cvt_pk_bf16_f32 v80, v96, v97
    v_cvt_pk_bf16_f32 v81, v98, v99
    v_cvt_pk_bf16_f32 v82, v100, v101
    v_cvt_pk_bf16_f32 v83, v102, v103
    v_cvt_pk_bf16_f32 v84, v104, v105
    v_cvt_pk_bf16_f32 v85, v106, v107
    v_cvt_pk_bf16_f32 v86, v108, v109
    v_cvt_pk_bf16_f32 v87, v110, v111
    s_waitcnt lgkmcnt(2)
    v_mfma_f32_32x32x16_bf16 v[128:143], v[64:67], v[80:83], v[128:143]
    s_waitcnt lgkmcnt(0)
    v_mfma_f32_32x32x16_bf16 v[128:143], v[68:71], v[84:87], v[128:143]
    v_exp_f32 v112, v112
    v_exp_f32 v113, v113
    v_exp_f32 v114, v114
    v_exp_f32 v115, v115
    v_exp_f32 v116, v116
    v_exp_f32 v117, v117
    v_exp_f32 v118, v118
    v_exp_f32 v119, v119
    v_exp_f32 v120, v120
    v_exp_f32 v121, v121
    v_exp_f32 v122, v122
    v_exp_f32 v123, v123
    v_exp_f32 v124, v124
    v_exp_f32 v125, v125
    v_exp_f32 v126, v126
    v_exp_f32 v127, v127
    v_cvt_pk_bf16_f32 v88, v112, v113
    v_cvt_pk_bf16_f32 v89, v114, v115
    v_cvt_pk_bf16_f32 v90, v116, v117
    v_cvt_pk_bf16_f32 v91, v118, v119
    v_cvt_pk_bf16_f32 v92, v120, v121
    v_cvt_pk_bf16_f32 v93, v122, v123
    v_cvt_pk_bf16_f32 v94, v124, v125
    v_cvt_pk_bf16_f32 v95, v126, v127
    v_mfma_f32_32x32x16_bf16 v[144:159], v[64:67], v[88:91], v[144:159]
    s_nop 0
    v_mfma_f32_32x32x16_bf16 v[144:159], v[68:71], v[92:95], v[144:159]
    buffer_load_dwordx4 v[48:51], v28, s[32:35], s65 offen offset:512 sc1
    buffer_load_dwordx2 v[52:53], v31, s[32:35], s65 offen offset:512 sc1
    s_waitcnt vmcnt(0)
    v_cndmask_b32 v52, v52, v6, s[62:63]
    v_cndmask_b32 v53, v53, v6, s[62:63]
    v_mfma_f32_32x32x16_bf16 v[96:111], v[48:51], v[32:35], 0
    s_nop 9
    v_mfma_f32_32x32x8bf16_1k v[96:111], v[52:53], v[36:37], v[96:111]
    v_mfma_f32_32x32x16_bf16 v[112:127], v[48:51], v[40:43], 0
    s_nop 9
    v_mfma_f32_32x32x8bf16_1k v[112:127], v[52:53], v[44:45], v[112:127]
    s_waitcnt vmcnt(0)
    ds_read_b64_tr_b16 v[64:65], v12 offset:512
    ds_read_b64_tr_b16 v[66:67], v13 offset:512
    ds_read_b64_tr_b16 v[68:69], v12 offset:768
    ds_read_b64_tr_b16 v[70:71], v13 offset:768
    v_exp_f32 v96, v96
    v_exp_f32 v97, v97
    v_exp_f32 v98, v98
    v_exp_f32 v99, v99
    v_exp_f32 v100, v100
    v_exp_f32 v101, v101
    v_exp_f32 v102, v102
    v_exp_f32 v103, v103
    v_exp_f32 v104, v104
    v_exp_f32 v105, v105
    v_exp_f32 v106, v106
    v_exp_f32 v107, v107
    v_exp_f32 v108, v108
    v_exp_f32 v109, v109
    v_exp_f32 v110, v110
    v_exp_f32 v111, v111
    v_cvt_pk_bf16_f32 v80, v96, v97
    v_cvt_pk_bf16_f32 v81, v98, v99
    v_cvt_pk_bf16_f32 v82, v100, v101
    v_cvt_pk_bf16_f32 v83, v102, v103
    v_cvt_pk_bf16_f32 v84, v104, v105
    v_cvt_pk_bf16_f32 v85, v106, v107
    v_cvt_pk_bf16_f32 v86, v108, v109
    v_cvt_pk_bf16_f32 v87, v110, v111
    s_waitcnt lgkmcnt(2)
    v_mfma_f32_32x32x16_bf16 v[128:143], v[64:67], v[80:83], v[128:143]
    s_waitcnt lgkmcnt(0)
    v_mfma_f32_32x32x16_bf16 v[128:143], v[68:71], v[84:87], v[128:143]
    v_exp_f32 v112, v112
    v_exp_f32 v113, v113
    v_exp_f32 v114, v114
    v_exp_f32 v115, v115
    v_exp_f32 v116, v116
    v_exp_f32 v117, v117
    v_exp_f32 v118, v118
    v_exp_f32 v119, v119
    v_exp_f32 v120, v120
    v_exp_f32 v121, v121
    v_exp_f32 v122, v122
    v_exp_f32 v123, v123
    v_exp_f32 v124, v124
    v_exp_f32 v125, v125
    v_exp_f32 v126, v126
    v_exp_f32 v127, v127
    v_cvt_pk_bf16_f32 v88, v112, v113
    v_cvt_pk_bf16_f32 v89, v114, v115
    v_cvt_pk_bf16_f32 v90, v116, v117
    v_cvt_pk_bf16_f32 v91, v118, v119
    v_cvt_pk_bf16_f32 v92, v120, v121
    v_cvt_pk_bf16_f32 v93, v122, v123
    v_cvt_pk_bf16_f32 v94, v124, v125
    v_cvt_pk_bf16_f32 v95, v126, v127
    v_mfma_f32_32x32x16_bf16 v[144:159], v[64:67], v[88:91], v[144:159]
    s_nop 0
    v_mfma_f32_32x32x16_bf16 v[144:159], v[68:71], v[92:95], v[144:159]
    s_add_u32 s66, s66, 1
    s_cmp_lt_u32 s66, 32
    s_nop 9
    s_cbranch_scc1 L_slow2
    s_nop 1
    s_branch L_slow_back
L_nz_1:
    s_mov_b32 s44, 0
L_nzl_42:
    buffer_load_dword v35, v34, s[36:39], 0 offen sc1
    s_waitcnt vmcnt(0)
    v_readfirstlane_b32 s42, v35
    s_add_u32 s44, s44, 1
    s_cmp_gt_u32 s44, 1000000
    s_cbranch_scc1 L_nzb_2
    s_cmp_eq_u32 s42, 0
    s_cbranch_scc1 L_nzl_42
    s_branch L_nzb_2
L_nz_5:
    s_mov_b32 s44, 0
L_nzl_43:
    buffer_load_dword v35, v34, s[36:39], 0 offen sc1
    s_waitcnt vmcnt(0)
    v_readfirstlane_b32 s42, v35
    s_add_u32 s44, s44, 1
    s_cmp_gt_u32 s44, 1000000
    s_cbranch_scc1 L_nzb_6
    s_cmp_eq_u32 s42, 0
    s_cbranch_scc1 L_nzl_43
    s_branch L_nzb_6
L_nz_16:
    s_mov_b32 s44, 0
L_nzl_44:
    buffer_load_dword v7, v6, s[36:39], 0 offen sc1
    s_waitcnt vmcnt(0)
    v_readfirstlane_b32 s42, v7
    s_add_u32 s44, s44, 1
    s_cmp_gt_u32 s44, 1000000
    s_cbranch_scc1 L_nzb_17
    s_cmp_eq_u32 s42, 0
    s_cbranch_scc1 L_nzl_44
    s_branch L_nzb_17
L_st_18:
    s_mov_b32 s44, 0
L_stl_45:
    buffer_load_dwordx4 v[8:11], v36, s[32:35], s80 offen offset:0 sc1
    s_waitcnt vmcnt(0)
    v_cmp_ne_u32 vcc, s42, v10
    v_cmp_ne_u32 s[46:47], s42, v10
    s_nop 0
    s_or_b64 vcc, vcc, s[46:47]
    s_cbranch_scc0 L_sto_19
    s_add_u32 s44, s44, 1
    s_cmp_gt_u32 s44, 1000000
    s_cbranch_scc0 L_stl_45
    s_branch L_sto_19
L_st_20:
    s_mov_b32 s44, 0
L_stl_46:
    buffer_load_dwordx2 v[20:21], v37, s[32:35], s81 offen offset:0 sc1
    buffer_load_dwordx2 v[24:25], v37, s[32:35], s81 offen offset:256 sc1
    s_waitcnt vmcnt(0)
    v_cmp_ne_u32 vcc, s42, v21
    v_cmp_ne_u32 s[46:47], s42, v25
    s_nop 0
    s_or_b64 vcc, vcc, s[46:47]
    s_cbranch_scc0 L_sto_21
    s_add_u32 s44, s44, 1
    s_cmp_gt_u32 s44, 1000000
    s_cbranch_scc0 L_stl_46
    s_branch L_sto_21
L_nz_22:
    s_mov_b32 s44, 0
L_nzl_47:
    buffer_load_dword v7, v6, s[36:39], 0 offen sc1
    s_waitcnt vmcnt(0)
    v_readfirstlane_b32 s42, v7
    s_add_u32 s44, s44, 1
    s_cmp_gt_u32 s44, 1000000
    s_cbranch_scc1 L_nzb_23
    s_cmp_eq_u32 s42, 0
    s_cbranch_scc1 L_nzl_47
    s_branch L_nzb_23
L_st_24:
    s_mov_b32 s44, 0
L_stl_48:
    buffer_load_dwordx4 v[8:11], v36, s[32:35], s80 offen offset:0 sc1
    buffer_load_dwordx4 v[12:15], v36, s[32:35], s80 offen offset:512 sc1
    s_waitcnt vmcnt(0)
    v_cmp_ne_u32 vcc, s42, v10
    v_cmp_ne_u32 s[46:47], s42, v14
    s_nop 0
    s_or_b64 vcc, vcc, s[46:47]
    s_cbranch_scc0 L_sto_25
    s_add_u32 s44, s44, 1
    s_cmp_gt_u32 s44, 1000000
    s_cbranch_scc0 L_stl_48
    s_branch L_sto_25
L_st_26:
    s_mov_b32 s44, 0
L_stl_49:
    buffer_load_dwordx4 v[8:11], v36, s[32:35], s81 offen offset:0 sc1
    buffer_load_dwordx4 v[12:15], v36, s[32:35], s81 offen offset:512 sc1
    s_waitcnt vmcnt(0)
    v_cmp_ne_u32 vcc, s42, v10
    v_cmp_ne_u32 s[46:47], s42, v14
    s_nop 0
    s_or_b64 vcc, vcc, s[46:47]
    s_cbranch_scc0 L_sto_27
    s_add_u32 s44, s44, 1
    s_cmp_gt_u32 s44, 1000000
    s_cbranch_scc0 L_stl_49
    s_branch L_sto_27
L_nz_28:
    s_mov_b32 s44, 0
L_nzl_50:
    buffer_load_dword v7, v6, s[36:39], 0 offen sc1
    s_waitcnt vmcnt(0)
    v_readfirstlane_b32 s42, v7
    s_add_u32 s44, s44, 1
    s_cmp_gt_u32 s44, 1000000
    s_cbranch_scc1 L_nzb_29
    s_cmp_eq_u32 s42, 0
    s_cbranch_scc1 L_nzl_50
    s_branch L_nzb_29
L_gm_32:
    buffer_store_dwordx4 v[152:155], v25, s[32:35], s54 offen sc1
    buffer_store_dwordx4 v[156:159], v25, s[32:35], s55 offen sc1
    buffer_store_dwordx2 v[230:231], v26, s[32:35], s56 offen sc1
    v_dot2_f32_bf16 v6, v152, v19, 0
    v_dot2_f32_bf16 v7, v152, v152, 0
    v_dot2_f32_bf16 v6, v153, v19, v6
    v_dot2_f32_bf16 v7, v153, v153, v7
    v_dot2_f32_bf16 v6, v154, v19, v6
    v_dot2_f32_bf16 v7, v154, v154, v7
    v_dot2_f32_bf16 v6, v155, v19, v6
    v_dot2_f32_bf16 v7, v155, v155, v7
    v_dot2_f32_bf16 v6, v156, v19, v6
    v_dot2_f32_bf16 v7, v156, v156, v7
    v_dot2_f32_bf16 v6, v157, v19, v6
    v_dot2_f32_bf16 v7, v157, v157, v7
    v_dot2_f32_bf16 v6, v158, v19, v6
    v_dot2_f32_bf16 v7, v158, v158, v7
    v_dot2_f32_bf16 v6, v159, v19, v6
    v_dot2_f32_bf16 v7, v159, v159, v7
    v_dot2_f32_bf16 v6, v230, v19, v6
    v_dot2_f32_bf16 v7, v230, v230, v7
    v_dot2_f32_bf16 v6, v231, v19, v6
    v_dot2_f32_bf16 v7, v231, v231, v7
    s_nop 1
    v_mov_b32 v2, v6
    v_mov_b32 v3, v7
    s_nop 0
    v_permlane16_swap_b32 v6, v2
    v_permlane16_swap_b32 v7, v3
    v_add_f32 v6, v6, v2
    v_add_f32 v7, v7, v3
    v_mov_b32 v2, v6
    v_mov_b32 v3, v7
    s_nop 0
    v_permlane32_swap_b32 v6, v2
    v_permlane32_swap_b32 v7, v3
    v_add_f32 v6, v6, v2
    v_add_f32 v7, v7, v3
    s_mov_b64 exec, 0xffff
    buffer_store_dwordx2 v[6:7], v24, s[32:35], s59 offen sc1
    s_mov_b64 exec, -1
    s_branch L_gmb_33
L_gm_34:
    v_mov_b32 v4, s42
    v_lshlrev_b32 v5, 2, v1
    s_mov_b32 exec_hi, 0
    buffer_store_dword v4, v5, s[32:35], s4 offen sc1
    s_mov_b32 exec_hi, -1
    s_branch L_gmb_35
L_gm_38:
    s_waitcnt lgkmcnt(3)
    s_waitcnt vmcnt(3)
    v_mfma_f32_16x16x32_bf16 v[32:35], v[88:91], v[144:147], v[32:35]
    ds_read_b128 v[116:119], v26 offset:21504
    ds_read_b128 v[120:123], v26 offset:22528
    s_waitcnt vmcnt(2)
    v_mfma_f32_16x16x32_bf16 v[36:39], v[88:91], v[148:151], v[36:39]
    ds_read_b128 v[124:127], v26 offset:23552
    ds_read_b128 v[128:131], v26 offset:24576
    v_mfma_f32_16x16x32_bf16 v[40:43], v[92:95], v[144:147], v[40:43]
    ds_read_b128 v[132:135], v26 offset:25600
    ds_read_b128 v[136:139], v26 offset:26624
    v_mfma_f32_16x16x32_bf16 v[44:47], v[92:95], v[148:151], v[44:47]
    ds_read_b128 v[140:143], v26 offset:27648
    s_waitcnt vmcnt(1) lgkmcnt(6)
    v_mfma_f32_16x16x32_bf16 v[32:35], v[116:119], v[152:155], v[32:35]
    s_waitcnt vmcnt(0)
    v_mfma_f32_16x16x32_bf16 v[36:39], v[116:119], v[156:159], v[36:39]
    v_mfma_f32_16x16x32_bf16 v[48:51], v[96:99], v[144:147], v[48:51]
    v_mfma_f32_16x16x32_bf16 v[52:55], v[96:99], v[148:151], v[52:55]
    s_waitcnt lgkmcnt(5)
    v_mfma_f32_16x16x32_bf16 v[40:43], v[120:123], v[152:155], v[40:43]
    s_nop 1
    v_fmac_f32 v32, v8, v160
    v_fmac_f32 v33, v8, v161
    v_mfma_f32_16x16x32_bf16 v[44:47], v[120:123], v[156:159], v[44:47]
    v_fmac_f32 v34, v8, v162
    v_fmac_f32 v35, v8, v163
    v_mfma_f32_16x16x32_bf16 v[56:59], v[100:103], v[144:147], v[56:59]
    v_fmac_f32 v36, v12, v160
    v_fmac_f32 v37, v12, v161
    v_mfma_f32_16x16x32_bf16 v[60:63], v[100:103], v[148:151], v[60:63]
    v_fmac_f32 v38, v12, v162
    v_fmac_f32 v39, v12, v163
    s_waitcnt lgkmcnt(4)
    v_mfma_f32_16x16x32_bf16 v[48:51], v[124:127], v[152:155], v[48:51]
    v_cvt_pk_bf16_f32 v32, v32, v33
    v_cvt_pk_bf16_f32 v33, v34, v35
    v_mfma_f32_16x16x32_bf16 v[52:55], v[124:127], v[156:159], v[52:55]
    v_cvt_pk_bf16_f32 v34, v36, v37
    v_cvt_pk_bf16_f32 v35, v38, v39
    v_mfma_f32_16x16x32_bf16 v[64:67], v[104:107], v[144:147], v[64:67]
    v_pk_max_i16 v32, v32, 0
    v_pk_max_i16 v34, v34, 0
    v_mfma_f32_16x16x32_bf16 v[68:71], v[104:107], v[148:151], v[68:71]
    v_pk_max_i16 v33, v33, 0
    v_pk_max_i16 v35, v35, 0
    s_waitcnt lgkmcnt(3)
    v_mfma_f32_16x16x32_bf16 v[56:59], v[128:131], v[152:155], v[56:59]
    v_permlane16_swap_b32 v32, v34
    v_permlane16_swap_b32 v33, v35
    v_mfma_f32_16x16x32_bf16 v[60:63], v[128:131], v[156:159], v[60:63]
    buffer_store_dwordx4 v[32:35], v31, s[32:35], s54 offen offset:0 sc1
    v_fmac_f32 v40, v8, v164
    v_mfma_f32_16x16x32_bf16 v[72:75], v[108:111], v[144:147], v[72:75]
    v_fmac_f32 v41, v8, v165
    v_fmac_f32 v42, v8, v166
    v_mfma_f32_16x16x32_bf16 v[76:79], v[108:111], v[148:151], v[76:79]
    v_fmac_f32 v43, v8, v167
    v_fmac_f32 v44, v12, v164
    s_waitcnt lgkmcnt(2)
    v_mfma_f32_16x16x32_bf16 v[64:67], v[132:135], v[152:155], v[64:67]
    v_fmac_f32 v45, v12, v165
    v_fmac_f32 v46, v12, v166
    v_mfma_f32_16x16x32_bf16 v[68:71], v[132:135], v[156:159], v[68:71]
    v_fmac_f32 v47, v12, v167
    v_cvt_pk_bf16_f32 v40, v40, v41
    v_mfma_f32_16x16x32_bf16 v[80:83], v[112:115], v[144:147], v[80:83]
    v_cvt_pk_bf16_f32 v41, v42, v43
    v_cvt_pk_bf16_f32 v42, v44, v45
    v_mfma_f32_16x16x32_bf16 v[84:87], v[112:115], v[148:151], v[84:87]
    v_cvt_pk_bf16_f32 v43, v46, v47
    v_pk_max_i16 v40, v40, 0
    s_waitcnt lgkmcnt(1)
    v_mfma_f32_16x16x32_bf16 v[72:75], v[136:139], v[152:155], v[72:75]
    v_pk_max_i16 v42, v42, 0
    v_pk_max_i16 v41, v41, 0
    v_mfma_f32_16x16x32_bf16 v[76:79], v[136:139], v[156:159], v[76:79]
    v_pk_max_i16 v43, v43, 0
    v_permlane16_swap_b32 v40, v42
    s_waitcnt lgkmcnt(0)
    v_mfma_f32_16x16x32_bf16 v[80:83], v[140:143], v[152:155], v[80:83]
    v_permlane16_swap_b32 v41, v43
    buffer_store_dwordx4 v[40:43], v31, s[32:35], s54 offen offset:2048 sc1
    v_mfma_f32_16x16x32_bf16 v[84:87], v[140:143], v[156:159], v[84:87]
    v_pk_fma_f32 v[48:49], v[168:169], v[8:9], v[48:49] op_sel:[0,0,0] op_sel_hi:[1,0,1]
    v_pk_fma_f32 v[50:51], v[170:171], v[8:9], v[50:51] op_sel:[0,0,0] op_sel_hi:[1,0,1]
    v_pk_fma_f32 v[52:53], v[168:169], v[12:13], v[52:53] op_sel:[0,0,0] op_sel_hi:[1,0,1]
    v_pk_fma_f32 v[54:55], v[170:171], v[12:13], v[54:55] op_sel:[0,0,0] op_sel_hi:[1,0,1]
    v_cvt_pk_bf16_f32 v48, v48, v49
    v_cvt_pk_bf16_f32 v49, v50, v51
    v_cvt_pk_bf16_f32 v50, v52, v53
    v_cvt_pk_bf16_f32 v51, v54, v55
    v_pk_max_i16 v48, v48, 0
    v_pk_max_i16 v50, v50, 0
    v_pk_max_i16 v49, v49, 0
    v_pk_max_i16 v51, v51, 0
    v_permlane16_swap_b32 v48, v50
    s_nop 0
    v_permlane16_swap_b32 v49, v51
    buffer_store_dwordx4 v[48:51], v31, s[32:35], s55 offen offset:0 sc1
    v_pk_fma_f32 v[56:57], v[172:173], v[8:9], v[56:57] op_sel:[0,0,0] op_sel_hi:[1,0,1]
    v_pk_fma_f32 v[58:59], v[174:175], v[8:9], v[58:59] op_sel:[0,0,0] op_sel_hi:[1,0,1]
    v_pk_fma_f32 v[60:61], v[172:173], v[12:13], v[60:61] op_sel:[0,0,0] op_sel_hi:[1,0,1]
    v_pk_fma_f32 v[62:63], v[174:175], v[12:13], v[62:63] op_sel:[0,0,0] op_sel_hi:[1,0,1]
    v_cvt_pk_bf16_f32 v56, v56, v57
    v_cvt_pk_bf16_f32 v57, v58, v59
    v_cvt_pk_bf16_f32 v58, v60, v61
    v_cvt_pk_bf16_f32 v59, v62, v63
    v_pk_max_i16 v56, v56, 0
    v_pk_max_i16 v58, v58, 0
    v_pk_max_i16 v57, v57, 0
    v_pk_max_i16 v59, v59, 0
    v_permlane16_swap_b32 v56, v58
    s_nop 0
    v_permlane16_swap_b32 v57, v59
    buffer_store_dwordx4 v[56:59], v31, s[32:35], s56 offen offset:0 sc1
    v_pk_fma_f32 v[64:65], v[176:177], v[8:9], v[64:65] op_sel:[0,0,0] op_sel_hi:[1,0,1]
    v_pk_fma_f32 v[66:67], v[178:179], v[8:9], v[66:67] op_sel:[0,0,0] op_sel_hi:[1,0,1]
    v_pk_fma_f32 v[68:69], v[176:177], v[12:13], v[68:69] op_sel:[0,0,0] op_sel_hi:[1,0,1]
    v_pk_fma_f32 v[70:71], v[178:179], v[12:13], v[70:71] op_sel:[0,0,0] op_sel_hi:[1,0,1]
    v_cvt_pk_bf16_f32 v64, v64, v65
    v_cvt_pk_bf16_f32 v65, v66, v67
    v_cvt_pk_bf16_f32 v66, v68, v69
    v_cvt_pk_bf16_f32 v67, v70, v71
    v_pk_max_i16 v64, v64, 0
    v_pk_max_i16 v66, v66, 0
    v_pk_max_i16 v65, v65, 0
    v_pk_max_i16 v67, v67, 0
    v_permlane16_swap_b32 v64, v66
    s_nop 0
    v_permlane16_swap_b32 v65, v67
    buffer_store_dwordx4 v[64:67], v31, s[32:35], s56 offen offset:2048 sc1
    v_pk_fma_f32 v[72:73], v[180:181], v[8:9], v[72:73] op_sel:[0,0,0] op_sel_hi:[1,0,1]
    v_pk_fma_f32 v[74:75], v[182:183], v[8:9], v[74:75] op_sel:[0,0,0] op_sel_hi:[1,0,1]
    v_pk_fma_f32 v[76:77], v[180:181], v[12:13], v[76:77] op_sel:[0,0,0] op_sel_hi:[1,0,1]
    v_pk_fma_f32 v[78:79], v[182:183], v[12:13], v[78:79] op_sel:[0,0,0] op_sel_hi:[1,0,1]
    v_cvt_pk_bf16_f32 v72, v72, v73
    v_cvt_pk_bf16_f32 v73, v74, v75
    v_cvt_pk_bf16_f32 v74, v76, v77
    v_cvt_pk_bf16_f32 v75, v78, v79
    v_pk_max_i16 v72, v72, 0
    v_pk_max_i16 v74, v74, 0
    v_pk_max_i16 v73, v73, 0
    v_pk_max_i16 v75, v75, 0
    v_permlane16_swap_b32 v72, v74
    s_nop 0
    v_permlane16_swap_b32 v73, v75
    buffer_store_dwordx4 v[72:75], v31, s[32:35], s57 offen offset:0 sc1
    v_pk_fma_f32 v[80:81], v[184:185], v[8:9], v[80:81] op_sel:[0,0,0] op_sel_hi:[1,0,1]
    v_pk_fma_f32 v[82:83], v[186:187], v[8:9], v[82:83] op_sel:[0,0,0] op_sel_hi:[1,0,1]
    v_pk_fma_f32 v[84:85], v[184:185], v[12:13], v[84:85] op_sel:[0,0,0] op_sel_hi:[1,0,1]
    v_pk_fma_f32 v[86:87], v[186:187], v[12:13], v[86:87] op_sel:[0,0,0] op_sel_hi:[1,0,1]
    v_cvt_pk_bf16_f32 v80, v80, v81
    v_cvt_pk_bf16_f32 v81, v82, v83
    v_cvt_pk_bf16_f32 v82, v84, v85
    v_cvt_pk_bf16_f32 v83, v86, v87
    v_pk_max_i16 v80, v80, 0
    v_pk_max_i16 v82, v82, 0
    v_pk_max_i16 v81, v81, 0
    v_pk_max_i16 v83, v83, 0
    v_permlane16_swap_b32 v80, v82
    s_nop 0
    v_permlane16_swap_b32 v81, v83
    buffer_store_dwordx4 v[80:83], v31, s[32:35], s57 offen offset:2048 sc1
    s_branch L_gmb_39
L_gm_40:
    v_mov_b32 v4, s42
    v_lshlrev_b32 v5, 2, v1
    s_mov_b32 exec_hi, 0
    buffer_store_dword v4, v5, s[32:35], s4 offen sc1
    s_mov_b32 exec_hi, -1
    s_branch L_gmb_41
L_code_end:
.set CODE_BYTES, L_code_end-sequential_preLN__mha_block__dense_activation_relu__prompt_kernel
.section .rodata,"a"
.p2align 6
.amdhsa_kernel sequential_preLN__mha_block__dense_activation_relu__prompt_kernel
  .amdhsa_next_free_vgpr 256
  .amdhsa_next_free_sgpr 102
  .amdhsa_accum_offset 256
  .amdhsa_group_segment_fixed_size 0
  .amdhsa_kernarg_size 72
  .amdhsa_user_sgpr_count 2
  .amdhsa_user_sgpr_kernarg_segment_ptr 1
  .amdhsa_system_sgpr_workgroup_id_x 1
.end_amdhsa_kernel
```
